```python
import torch

def _softmax(x, axis=-1):
    return torch.softmax(x, dim=axis)
def _gelu(x):
    return torch.nn.functional.gelu(x, approximate="tanh")
def _silu(x):
    return torch.nn.functional.silu(x)
def _sigmoid(x):
    return torch.sigmoid(x)
def _layernorm(x, axis=-1, eps=1e-5):
    m = x.mean(dim=axis, keepdim=True)
    v = x.var(dim=axis, keepdim=True, unbiased=False)
    return (x - m) / torch.sqrt(v + eps)
def _scatter_add(tgt, idx, src, axis=0):
    return tgt.clone().index_add_(axis, idx, src)
def _segment_sum(src, seg, n):
    out = torch.zeros((n,) + src.shape[1:], dtype=src.dtype)
    return out.index_add_(0, seg, src)
def _pad(x, pw):
    flat = tuple(v for pair in reversed(pw) for v in pair)
    return torch.nn.functional.pad(x, flat)

kernel_name = 'standalone__mha_block_cached__near_ridge'

def setup_inputs():

    _w = (lambda a: (lambda t: t.to(torch.bfloat16) if t.is_floating_point() else t)(torch.as_tensor(a)))
    B, Sq, D = 8, 128, 512
    H, Sk, Dh = 32, 1024, 128
    return {
        "x": _w((lambda *s: torch.randn(*s, dtype=torch.bfloat16) * 0.8)(B, Sq, D)),
        "k_cache": _w((lambda *s: torch.randn(*s, dtype=torch.bfloat16) * 0.8)(B, H, Sk, Dh)),
        "v_cache": _w((lambda *s: torch.randn(*s, dtype=torch.bfloat16) * 0.05)(B, H, Sk, Dh)),
        "wq": _w((lambda *s: torch.randn(*s, dtype=torch.bfloat16) * 0.8)(D, H * Dh) * (D ** -0.5)),
        "wo": _w((lambda *s: torch.randn(*s, dtype=torch.bfloat16) * 0.05)(H * Dh, D) * ((H * Dh) ** -0.5)),
    }

def reference(x, k_cache, v_cache, wq, wo):
    B, Sq, D = x.shape
    H, Dh = 32, 128
    q = (lambda x, *d: x.permute(*d))((x @ wq).reshape(B, Sq, H, Dh), 0, 2, 1, 3)
    scores = torch.einsum("bhqd,bhkd->bhqk", q, k_cache) * (Dh ** -0.5)
    p = _softmax(scores, axis=-1)
    o = torch.einsum("bhqk,bhkd->bhqd", p, v_cache)
    return (lambda x, *d: x.permute(*d))(o, 0, 2, 1, 3).reshape(B, Sq, H * Dh) @ wo
```

```asm
; @launch grid=(256,1,1) block=(256,1,1) lds=163840
.amdgcn_target "amdgcn-amd-amdhsa--gfx950"
.text
.globl standalone__mha_block_cached__near_ridge_kernel
.p2align 8
.type standalone__mha_block_cached__near_ridge_kernel,@function
standalone__mha_block_cached__near_ridge_kernel:
    s_load_dwordx16 s[4:19], s[0:1], 0
    s_cmp_ge_u32 s2, 256
    s_cbranch_scc1 L_end
    v_lshrrev_b32 v200, 6, v0
    v_and_b32 v246, 63, v0
    v_readfirstlane_b32 s48, v200

    s_getpc_b64 s[68:69]
L_pc:
    s_lshr_b32 s55, s2, 3
    v_lshlrev_b32 v201, 7, v200
    v_lshl_add_u32 v201, s55, 2, v201
    v_add_lshl_u32 v201, v201, v246, 7
    v_cmp_gt_u32 vcc, L_cold-L_pc, v201
    s_and_b32 s56, s2, 1
    s_and_b64 exec, vcc, 15
    s_cbranch_execz L_nopf
    global_load_dword v253, v201, s[68:69]
L_nopf:
    s_mov_b64 exec, -1

    s_bfe_u32 s51, s2, 131073
    s_lshr_b32 s53, s2, 6
    s_and_b32 s52, s55, 7
    s_lshl2_add_u32 s49, s56, s53
    s_lshl3_add_u32 s50, s51, s52
    s_lshl_b32 s60, s48, 12
    s_add_u32 s54, s53, s52
    s_lshl2_add_u32 s54, s54, s2

    v_lshrrev_b32 v201, 3, v246
    v_lshrrev_b32 v202, 4, v246
    v_and_b32 v203, 7, v246
    v_and_b32 v204, 15, v246
    v_lshl_add_u32 v236, v200, 4, v202
    v_lshlrev_b32 v242, 1, v202
    v_xor_b32 v206, v204, v242
    v_lshlrev_b32 v240, 4, v206
    v_lshl_add_u32 v164, v236, 13, v240
    v_xor_b32 v207, 128, v164
    v_add_u32 v165, 31744, v164
    v_add_u32 v166, 63488, v207
    v_add_u32 v167, 95232, v207
    s_lshr_b32 s58, s51, 1
    s_lshl_b32 s58, s58, 14
    s_sub_u32 s59, 18432, s58
    s_add_u32 s58, s58, 4096
    v_lshl_add_u32 v205, v200, 5, v201
    v_lshlrev_b32 v205, 10, v205
    v_xor_b32 v206, v203, v202
    v_lshl_add_u32 v206, v206, 4, v205
    v_xor_b32 v207, 64, v206
    v_add_u32 v207, 7168, v207
    v_add_u32 v160, s58, v206
    v_add_u32 v161, s58, v207
    v_add_u32 v162, s59, v206
    v_add_u32 v163, s59, v207
    s_lshl_b32 s56, s49, 17
    s_lshl_b32 s57, s50, 8
    s_sub_u32 s26, 4194304, s57
    s_mov_b32 s27, 0x20000
    s_mov_b32 s22, 135168
    s_mov_b32 s23, 0x20000
    s_add_u32 s58, s54, 0
    s_and_b32 s58, s58, 7
    s_add_u32 m0, s60, 49152
    s_lshl_b32 s59, s58, 19
    s_waitcnt lgkmcnt(0)
    s_add_u32 s24, s10, s57
    s_addc_u32 s25, s11, 0
    buffer_load_dwordx4 v164, s[24:27], s59 offen offset:0 lds
    buffer_load_dwordx4 v165, s[24:27], s59 offen offset:1024 lds
    buffer_load_dwordx4 v166, s[24:27], s59 offen offset:2048 lds
    buffer_load_dwordx4 v167, s[24:27], s59 offen offset:3072 lds
    s_add_u32 s20, s4, s56
    s_addc_u32 s21, s5, 0
    s_sub_u32 s20, s20, 4096
    s_subb_u32 s21, s21, 0
    s_add_u32 m0, s60, 0
    s_lshl_b32 s58, s58, 7
    buffer_load_dwordx4 v160, s[20:23], s58 offen offset:0 lds
    buffer_load_dwordx4 v161, s[20:23], s58 offen offset:1024 lds
    buffer_load_dwordx4 v162, s[20:23], s58 offen offset:2048 lds
    buffer_load_dwordx4 v163, s[20:23], s58 offen offset:3072 lds

    s_add_u32 s44, s14, s56
    s_addc_u32 s45, s15, 0
    s_mov_b32 s46, 131072
    s_mov_b32 s47, 0x20000
    s_lshl_b32 s56, s49, 5
    s_add_u32 s56, s56, s50
    s_lshl_b32 s56, s56, 18
    s_add_u32 s28, s6, s56
    s_addc_u32 s29, s7, 0
    s_mov_b32 s30, 262144
    s_mov_b32 s31, 0x20000
    s_add_u32 s32, s8, s56
    s_addc_u32 s33, s9, 0
    s_mov_b32 s34, 262144
    s_mov_b32 s35, 0x20000
    s_lshl_b32 s56, s51, 20
    s_lshl_b32 s57, s52, 7
    s_add_u32 s56, s56, s57
    s_sub_u32 s58, 1048576, s57
    s_add_u32 s36, s12, s56
    s_addc_u32 s37, s13, 0
    s_mov_b32 s38, s58
    s_mov_b32 s39, 0x20000
    s_add_u32 s40, s18, 0
    s_addc_u32 s41, s19, 0
    s_mov_b32 s42, 13631488
    s_mov_b32 s43, 0x20000
    s_mov_b32 s18, 256
    s_mov_b32 s19, 0x20000
    v_xor_b32 v207, v242, v203
    v_lshl_add_u32 v242, v207, 4, v205
    v_add_u32 v243, 7168, v242
    v_add_u32 v244, 14336, v242
    v_add_u32 v245, 21504, v242
    v_lshl_add_u32 v240, v236, 8, v240
    v_xor_b32 v241, 128, v240
    v_xor_b32 v206, v204, v202
    v_lshlrev_b32 v206, 4, v206
    v_lshl_add_u32 v236, v236, 8, v206
    v_xor_b32 v237, 64, v236
    v_xor_b32 v238, 128, v236
    v_xor_b32 v239, 192, v236
    v_lshl_add_u32 v206, v204, 8, v206
    v_add_u32 v232, 98304, v206
    v_xor_b32 v233, 64, v232
    v_xor_b32 v234, 128, v232
    v_xor_b32 v235, 192, v232
    v_subrev_u32 v192, 65536, v232
    v_subrev_u32 v193, 65536, v233
    v_subrev_u32 v194, 65536, v234
    v_subrev_u32 v195, 65536, v235
    s_mov_b32 s4, s52
    s_lshl_b32 s57, s53, 2
    s_lshr_b32 s56, 0x7531, s57
    s_add_u32 s56, s56, s52
    s_and_b32 s5, s56, 7
    s_lshr_b32 s56, 0x1642, s57
    s_add_u32 s56, s56, s52
    s_and_b32 s6, s56, 7
    s_lshr_b32 s56, 0x2753, s57
    s_add_u32 s56, s56, s52
    s_and_b32 s7, s56, 7
    s_lshr_b32 s56, 0x3164, s57
    s_add_u32 s56, s56, s52
    s_and_b32 s8, s56, 7
    s_lshr_b32 s56, 0x4275, s57
    s_add_u32 s56, s56, s52
    s_and_b32 s9, s56, 7
    s_lshr_b32 s56, 0x5316, s57
    s_add_u32 s56, s56, s52
    s_and_b32 s10, s56, 7
    s_lshr_b32 s56, 0x6427, s57
    s_add_u32 s56, s56, s52
    s_and_b32 s11, s56, 7

    s_lshl2_add_u32 s56, s49, s51
    s_lshl2_add_u32 s57, s56, s48
    s_lshl_b32 s66, s57, 16
    v_and_b32 v205, 3, v246
    v_lshlrev_b32 v251, 4, v246
    v_bfrev_b32 v207, 1
    v_add_u32 v252, 4096, v251
    s_lshl_b32 s59, s49, 5
    s_lshl2_add_u32 s57, s49, s48
    s_lshl_b32 s57, s57, 12
    s_add_u32 s57, s57, 12582912
    v_mov_b32 v255, s59
    v_add_u32 v179, s57, v251
    s_or_b32 s58, s48, s50
    s_cselect_b32 s59, 4096, s59
    v_lshl_add_u32 v178, v246, 12, s59
    s_lshl_b32 s56, s56, 12
    s_add_u32 s56, s56, 12582912
    v_lshl_add_u32 v249, v203, 9, s56
    s_lshl_b32 s58, s52, 9
    s_add_u32 s58, s58, s56
    v_max_u32 v206, 1, v205
    v_lshl_add_u32 v250, v206, 7, s58
    v_add_u32 v206, s58, v251
    v_lshl_or_b32 v247, v201, 28, v206
    v_lshl_or_b32 v247, v200, 28, v247
    v_lshlrev_b32 v248, 12, v201
    v_xor_b32 v206, v206, v248
    v_subrev_u32 v201, 1, v201
    v_cmp_gt_u32 vcc, 3, v201
    s_lshl3_add_u32 s57, s49, s52
    s_lshl4_add_u32 s57, s57, s48
    s_lshl_b32 s67, s57, 12
    s_add_u32 s67, s67, 8388608
    v_cndmask_b32 v248, v207, v206, vcc
    v_lshl_or_b32 v248, v200, 28, v248
    v_mov_b32 v180, 1

    v_lshrrev_b32 v207, 1, v204
    v_xor_b32 v207, v207, v202
    v_lshlrev_b32 v207, 4, v207
    v_lshl_add_u32 v207, v204, 7, v207
    v_add_u32 v168, s60, v207
    v_xor_b32 v169, 64, v168
    v_lshl_add_u32 v207, v200, 5, v204
    v_lshlrev_b32 v207, 10, v207
    v_lshl_add_u32 v207, v202, 3, v207
    s_lshr_b32 s56, s51, 1
    s_lshl_b32 s56, s56, 14
    s_and_b32 s58, s51, 1
    s_lshl1_add_u32 s57, s52, s58
    s_lshl_b32 s57, s57, 6
    s_add_u32 s56, s56, s57
    v_add_u32 v254, s56, v207
    s_lshl_b32 s58, s58, 1
    v_bfe_u32 v201, v246, 2, 2
    v_and_b32 v203, 31, v246
    v_lshlrev_b32 v203, 3, v203
    v_lshl_add_u32 v207, v202, 3, v201
    v_lshl_add_u32 v207, v207, 8, v203
    v_add_u32 v170, 49152, v207
    v_xor_b32 v171, 32, v170
    v_xor_b32 v172, 64, v170
    v_xor_b32 v173, 96, v170
    v_xor_b32 v174, 128, v170
    v_xor_b32 v175, 160, v170
    v_xor_b32 v176, 192, v170
    v_xor_b32 v177, 224, v170
    v_lshrrev_b32 v206, 2, v246
    v_lshl_add_u32 v207, v206, 8, v203
    v_add_u32 v224, 98304, v207
    v_xor_b32 v225, 32, v224
    v_xor_b32 v226, 64, v224
    v_xor_b32 v227, 96, v224
    v_xor_b32 v228, 128, v224
    v_xor_b32 v229, 160, v224
    v_xor_b32 v230, 192, v224
    v_xor_b32 v231, 224, v224
    v_bfe_u32 v207, v246, 3, 2
    v_xor_b32 v207, s58, v207
    v_lshl_add_u32 v207, v207, 2, v205
    v_lshlrev_b32 v207, 3, v207
    v_lshl_add_u32 v216, v206, 7, v207
    v_xor_b32 v217, 32, v216
    v_xor_b32 v218, 64, v216
    v_xor_b32 v219, 96, v216
    v_add_u32 v220, 65536, v216
    v_add_u32 v221, 65536, v217
    v_add_u32 v222, 65536, v218
    v_add_u32 v223, 65536, v219
    s_lshl_b32 s12, s53, 14
    s_mov_b32 s13, 0
    s_mov_b32 s64, 0x41000000
    s_mov_b32 s65, 0x3e0293ee
    s_cmp_lg_u32 s50, 0
    s_cbranch_scc1 L_noclr
    v_mov_b32 v184, 0
    v_mov_b32 v185, 0
    v_mov_b32 v186, 0
    v_mov_b32 v187, 0
    buffer_store_dwordx4 v[184:187], v179, s[40:43], 0 offen offset:0 sc1
    buffer_store_dwordx4 v[184:187], v179, s[40:43], 0 offen offset:1024 sc1
    buffer_store_dwordx4 v[184:187], v179, s[40:43], 0 offen offset:2048 sc1
    buffer_store_dwordx4 v[184:187], v179, s[40:43], 0 offen offset:3072 sc1
L_noclr:
    s_add_u32 s58, s54, 1
    s_and_b32 s58, s58, 7
    s_add_u32 m0, s60, 65536
    s_lshl_b32 s59, s58, 19
    buffer_load_dwordx4 v164, s[24:27], s59 offen offset:0 lds
    buffer_load_dwordx4 v165, s[24:27], s59 offen offset:1024 lds
    buffer_load_dwordx4 v166, s[24:27], s59 offen offset:2048 lds
    buffer_load_dwordx4 v167, s[24:27], s59 offen offset:3072 lds
    s_add_u32 m0, s60, 16384
    s_lshl_b32 s58, s58, 7
    buffer_load_dwordx4 v160, s[20:23], s58 offen offset:0 lds
    buffer_load_dwordx4 v161, s[20:23], s58 offen offset:1024 lds
    buffer_load_dwordx4 v162, s[20:23], s58 offen offset:2048 lds
    buffer_load_dwordx4 v163, s[20:23], s58 offen offset:3072 lds

    s_cmp_eq_u32 s50, 0
    s_cbranch_scc1 L_clw
    s_waitcnt vmcnt(8)
L_clw:
    s_waitcnt vmcnt(12) lgkmcnt(0)
    s_barrier
    ds_read_b128 a[0:3], v168 offset:0
    ds_read_b128 a[4:7], v168 offset:2048
    ds_read_b64_tr_b16 a[32:33], v170 offset:0
    ds_read_b64_tr_b16 a[34:35], v170 offset:1024
    ds_read_b64_tr_b16 a[36:37], v171 offset:0
    ds_read_b64_tr_b16 a[38:39], v171 offset:1024
    ds_read_b64_tr_b16 a[40:41], v172 offset:0
    ds_read_b64_tr_b16 a[42:43], v172 offset:1024
    ds_read_b64_tr_b16 a[44:45], v173 offset:0
    ds_read_b64_tr_b16 a[46:47], v173 offset:1024
    ds_read_b64_tr_b16 a[48:49], v174 offset:0
    ds_read_b64_tr_b16 a[50:51], v174 offset:1024
    s_waitcnt lgkmcnt(6)
    v_mfma_f32_16x16x32_bf16 v[64:67], a[32:35], a[0:3], 0
    s_add_u32 s58, s54, 2
    s_waitcnt lgkmcnt(0)
    ds_read_b64_tr_b16 a[52:53], v175 offset:0
    ds_read_b64_tr_b16 a[54:55], v175 offset:1024
    v_mfma_f32_16x16x32_bf16 v[68:71], a[32:35], a[4:7], 0
    s_and_b32 s58, s58, 7
    ds_read_b64_tr_b16 a[56:57], v176 offset:0
    v_mfma_f32_16x16x32_bf16 v[72:75], a[36:39], a[0:3], 0
    s_add_u32 m0, s60, 81920
    ds_read_b64_tr_b16 a[58:59], v176 offset:1024
    v_mfma_f32_16x16x32_bf16 v[76:79], a[36:39], a[4:7], 0
    s_lshl_b32 s59, s58, 19
    ds_read_b64_tr_b16 a[60:61], v177 offset:0
    ds_read_b64_tr_b16 a[62:63], v177 offset:1024
    v_mfma_f32_16x16x32_bf16 v[80:83], a[40:43], a[0:3], 0
    ds_read_b128 a[8:11], v169 offset:0
    buffer_load_dwordx4 v164, s[24:27], s59 offen offset:0 lds
    v_mfma_f32_16x16x32_bf16 v[84:87], a[40:43], a[4:7], 0
    ds_read_b128 a[12:15], v169 offset:2048
    v_mfma_f32_16x16x32_bf16 v[88:91], a[44:47], a[0:3], 0
    ds_read_b64_tr_b16 a[64:65], v170 offset:8192
    ds_read_b64_tr_b16 a[66:67], v170 offset:9216
    buffer_load_dwordx4 v165, s[24:27], s59 offen offset:1024 lds
    v_mfma_f32_16x16x32_bf16 v[92:95], a[44:47], a[4:7], 0
    ds_read_b64_tr_b16 a[68:69], v171 offset:8192
    buffer_load_dwordx4 v166, s[24:27], s59 offen offset:2048 lds
    v_mfma_f32_16x16x32_bf16 v[96:99], a[48:51], a[0:3], 0
    s_waitcnt lgkmcnt(5)
    ds_read_b64_tr_b16 a[70:71], v171 offset:9216
    buffer_load_dwordx4 v167, s[24:27], s59 offen offset:3072 lds
    v_mfma_f32_16x16x32_bf16 v[100:103], a[48:51], a[4:7], 0
    s_add_u32 m0, s60, 32768
    ds_read_b64_tr_b16 a[72:73], v172 offset:8192
    ds_read_b64_tr_b16 a[74:75], v172 offset:9216
    v_mfma_f32_16x16x32_bf16 v[104:107], a[52:55], a[0:3], 0
    ds_read_b64_tr_b16 a[76:77], v173 offset:8192
    v_mfma_f32_16x16x32_bf16 v[108:111], a[52:55], a[4:7], 0
    s_lshl_b32 s58, s58, 7
    ds_read_b64_tr_b16 a[78:79], v173 offset:9216
    v_mfma_f32_16x16x32_bf16 v[112:115], a[56:59], a[0:3], 0
    s_waitcnt lgkmcnt(5)
    ds_read_b64_tr_b16 a[80:81], v174 offset:8192
    ds_read_b64_tr_b16 a[82:83], v174 offset:9216
    buffer_load_dwordx4 v160, s[20:23], s58 offen offset:0 lds
    v_mfma_f32_16x16x32_bf16 v[116:119], a[56:59], a[4:7], 0
    ds_read_b64_tr_b16 a[84:85], v175 offset:8192
    buffer_load_dwordx4 v161, s[20:23], s58 offen offset:1024 lds
    v_mfma_f32_16x16x32_bf16 v[120:123], a[60:63], a[0:3], 0
    ds_read_b64_tr_b16 a[86:87], v175 offset:9216
    buffer_load_dwordx4 v162, s[20:23], s58 offen offset:2048 lds
    v_mfma_f32_16x16x32_bf16 v[124:127], a[60:63], a[4:7], 0
    ds_read_b64_tr_b16 a[88:89], v176 offset:8192
    ds_read_b64_tr_b16 a[90:91], v176 offset:9216
    buffer_load_dwordx4 v163, s[20:23], s58 offen offset:3072 lds
    v_mfma_f32_16x16x32_bf16 v[64:67], a[64:67], a[8:11], v[64:67]
    s_waitcnt lgkmcnt(6)
    ds_read_b64_tr_b16 a[92:93], v177 offset:8192
    v_mfma_f32_16x16x32_bf16 v[68:71], a[64:67], a[12:15], v[68:71]
    s_add_u32 m0, s60, 98304
    ds_read_b64_tr_b16 a[94:95], v177 offset:9216
    v_mfma_f32_16x16x32_bf16 v[72:75], a[68:71], a[8:11], v[72:75]
    s_xor_b32 s61, s12, 0
    v_mfma_f32_16x16x32_bf16 v[76:79], a[68:71], a[12:15], v[76:79]
    buffer_load_dwordx4 v236, s[28:31], s61 offen offset:0 nt lds
    v_mfma_f32_16x16x32_bf16 v[80:83], a[72:75], a[8:11], v[80:83]
    s_waitcnt lgkmcnt(2)
    buffer_load_dwordx4 v237, s[28:31], s61 offen offset:1024 nt lds
    v_mfma_f32_16x16x32_bf16 v[84:87], a[72:75], a[12:15], v[84:87]
    v_mfma_f32_16x16x32_bf16 v[88:91], a[76:79], a[8:11], v[88:91]
    s_waitcnt vmcnt(10) lgkmcnt(0)
    s_barrier
    ds_read_b128 a[16:19], v168 offset:16384
    ds_read_b128 a[20:23], v168 offset:18432
    v_mfma_f32_16x16x32_bf16 v[92:95], a[76:79], a[12:15], v[92:95]
    ds_read_b64_tr_b16 a[96:97], v170 offset:16384
    buffer_store_dword v180, v178, s[16:19], 0 offen offset:0 sc1
    v_mfma_f32_16x16x32_bf16 v[96:99], a[80:83], a[8:11], v[96:99]
    ds_read_b64_tr_b16 a[98:99], v170 offset:17408
    v_mfma_f32_16x16x32_bf16 v[100:103], a[80:83], a[12:15], v[100:103]
    s_add_u32 s58, s54, 3
    ds_read_b64_tr_b16 a[100:101], v171 offset:16384
    ds_read_b64_tr_b16 a[102:103], v171 offset:17408
    v_mfma_f32_16x16x32_bf16 v[104:107], a[84:87], a[8:11], v[104:107]
    ds_read_b64_tr_b16 a[104:105], v172 offset:16384
    v_mfma_f32_16x16x32_bf16 v[108:111], a[84:87], a[12:15], v[108:111]
    s_and_b32 s58, s58, 7
    ds_read_b64_tr_b16 a[106:107], v172 offset:17408
    v_mfma_f32_16x16x32_bf16 v[112:115], a[88:91], a[8:11], v[112:115]
    s_waitcnt lgkmcnt(5)
    ds_read_b64_tr_b16 a[108:109], v173 offset:16384
    v_mfma_f32_16x16x32_bf16 v[116:119], a[88:91], a[12:15], v[116:119]
    s_add_u32 m0, s60, 49152
    ds_read_b64_tr_b16 a[110:111], v173 offset:17408
    ds_read_b64_tr_b16 a[112:113], v174 offset:16384
    v_mfma_f32_16x16x32_bf16 v[120:123], a[92:95], a[8:11], v[120:123]
    ds_read_b64_tr_b16 a[114:115], v174 offset:17408
    v_mfma_f32_16x16x32_bf16 v[124:127], a[92:95], a[12:15], v[124:127]
    s_lshl_b32 s59, s58, 19
    ds_read_b64_tr_b16 a[116:117], v175 offset:16384
    s_waitcnt lgkmcnt(9)
    v_mfma_f32_16x16x32_bf16 v[64:67], a[96:99], a[16:19], v[64:67]
    s_waitcnt lgkmcnt(5)
    ds_read_b64_tr_b16 a[118:119], v175 offset:17408
    ds_read_b64_tr_b16 a[120:121], v176 offset:16384
    v_mfma_f32_16x16x32_bf16 v[68:71], a[96:99], a[20:23], v[68:71]
    ds_read_b64_tr_b16 a[122:123], v176 offset:17408
    buffer_load_dwordx4 v164, s[24:27], s59 offen offset:0 lds
    v_mfma_f32_16x16x32_bf16 v[72:75], a[100:103], a[16:19], v[72:75]
    ds_read_b64_tr_b16 a[124:125], v177 offset:16384
    v_mfma_f32_16x16x32_bf16 v[76:79], a[100:103], a[20:23], v[76:79]
    ds_read_b64_tr_b16 a[126:127], v177 offset:17408
    buffer_load_dwordx4 v165, s[24:27], s59 offen offset:1024 lds
    v_mfma_f32_16x16x32_bf16 v[80:83], a[104:107], a[16:19], v[80:83]
    s_waitcnt lgkmcnt(5)
    ds_read_b128 a[24:27], v169 offset:16384
    ds_read_b128 a[28:31], v169 offset:18432
    v_mfma_f32_16x16x32_bf16 v[84:87], a[104:107], a[20:23], v[84:87]
    ds_read_b64_tr_b16 a[128:129], v170 offset:24576
    buffer_load_dwordx4 v166, s[24:27], s59 offen offset:2048 lds
    v_mfma_f32_16x16x32_bf16 v[88:91], a[108:111], a[16:19], v[88:91]
    ds_read_b64_tr_b16 a[130:131], v170 offset:25600
    v_mfma_f32_16x16x32_bf16 v[92:95], a[108:111], a[20:23], v[92:95]
    ds_read_b64_tr_b16 a[132:133], v171 offset:24576
    ds_read_b64_tr_b16 a[134:135], v171 offset:25600
    buffer_load_dwordx4 v167, s[24:27], s59 offen offset:3072 lds
    v_mfma_f32_16x16x32_bf16 v[96:99], a[112:115], a[16:19], v[96:99]
    s_waitcnt lgkmcnt(6)
    ds_read_b64_tr_b16 a[136:137], v172 offset:24576
    v_mfma_f32_16x16x32_bf16 v[100:103], a[112:115], a[20:23], v[100:103]
    s_add_u32 m0, s60, 0
    ds_read_b64_tr_b16 a[138:139], v172 offset:25600
    v_mfma_f32_16x16x32_bf16 v[104:107], a[116:119], a[16:19], v[104:107]
    ds_read_b64_tr_b16 a[140:141], v173 offset:24576
    v_mfma_f32_16x16x32_bf16 v[108:111], a[116:119], a[20:23], v[108:111]
    s_lshl_b32 s58, s58, 7
    ds_read_b64_tr_b16 a[142:143], v173 offset:25600
    ds_read_b64_tr_b16 a[144:145], v174 offset:24576
    v_mfma_f32_16x16x32_bf16 v[112:115], a[120:123], a[16:19], v[112:115]
    s_waitcnt lgkmcnt(5)
    ds_read_b64_tr_b16 a[146:147], v174 offset:25600
    v_mfma_f32_16x16x32_bf16 v[116:119], a[120:123], a[20:23], v[116:119]
    ds_read_b64_tr_b16 a[148:149], v175 offset:24576
    buffer_load_dwordx4 v160, s[20:23], s58 offen offset:0 lds
    v_mfma_f32_16x16x32_bf16 v[120:123], a[124:127], a[16:19], v[120:123]
    ds_read_b64_tr_b16 a[150:151], v175 offset:25600
    ds_read_b64_tr_b16 a[152:153], v176 offset:24576
    v_mfma_f32_16x16x32_bf16 v[124:127], a[124:127], a[20:23], v[124:127]
    ds_read_b64_tr_b16 a[154:155], v176 offset:25600
    buffer_load_dwordx4 v161, s[20:23], s58 offen offset:1024 lds
    v_mfma_f32_16x16x32_bf16 v[64:67], a[128:131], a[24:27], v[64:67]
    s_waitcnt lgkmcnt(5)
    ds_read_b64_tr_b16 a[156:157], v177 offset:24576
    v_mfma_f32_16x16x32_bf16 v[68:71], a[128:131], a[28:31], v[68:71]
    ds_read_b64_tr_b16 a[158:159], v177 offset:25600
    buffer_load_dwordx4 v162, s[20:23], s58 offen offset:2048 lds
    v_mfma_f32_16x16x32_bf16 v[72:75], a[132:135], a[24:27], v[72:75]
    v_mfma_f32_16x16x32_bf16 v[76:79], a[132:135], a[28:31], v[76:79]
    buffer_load_dwordx4 v163, s[20:23], s58 offen offset:3072 lds
    v_mfma_f32_16x16x32_bf16 v[80:83], a[136:139], a[24:27], v[80:83]
    s_waitcnt lgkmcnt(2)
    v_mfma_f32_16x16x32_bf16 v[84:87], a[136:139], a[28:31], v[84:87]
    v_mfma_f32_16x16x32_bf16 v[88:91], a[140:143], a[24:27], v[88:91]
    s_waitcnt vmcnt(11) lgkmcnt(0)
    s_barrier
    ds_read_b128 a[0:3], v168 offset:32768
    ds_read_b128 a[4:7], v168 offset:34816
    v_mfma_f32_16x16x32_bf16 v[92:95], a[140:143], a[28:31], v[92:95]
    s_add_u32 s58, s54, 4
    ds_read_b64_tr_b16 a[32:33], v170 offset:32768
    v_mfma_f32_16x16x32_bf16 v[96:99], a[144:147], a[24:27], v[96:99]
    s_and_b32 s58, s58, 7
    ds_read_b64_tr_b16 a[34:35], v170 offset:33792
    v_mfma_f32_16x16x32_bf16 v[100:103], a[144:147], a[28:31], v[100:103]
    s_add_u32 m0, s60, 65536
    ds_read_b64_tr_b16 a[36:37], v171 offset:32768
    ds_read_b64_tr_b16 a[38:39], v171 offset:33792
    v_mfma_f32_16x16x32_bf16 v[104:107], a[148:151], a[24:27], v[104:107]
    ds_read_b64_tr_b16 a[40:41], v172 offset:32768
    v_mfma_f32_16x16x32_bf16 v[108:111], a[148:151], a[28:31], v[108:111]
    s_lshl_b32 s59, s58, 19
    ds_read_b64_tr_b16 a[42:43], v172 offset:33792
    v_mfma_f32_16x16x32_bf16 v[112:115], a[152:155], a[24:27], v[112:115]
    s_waitcnt lgkmcnt(5)
    ds_read_b64_tr_b16 a[44:45], v173 offset:32768
    buffer_load_dwordx4 v164, s[24:27], s59 offen offset:0 lds
    v_mfma_f32_16x16x32_bf16 v[116:119], a[152:155], a[28:31], v[116:119]
    ds_read_b64_tr_b16 a[46:47], v173 offset:33792
    ds_read_b64_tr_b16 a[48:49], v174 offset:32768
    buffer_load_dwordx4 v165, s[24:27], s59 offen offset:1024 lds
    v_mfma_f32_16x16x32_bf16 v[120:123], a[156:159], a[24:27], v[120:123]
    ds_read_b64_tr_b16 a[50:51], v174 offset:33792
    v_mfma_f32_16x16x32_bf16 v[124:127], a[156:159], a[28:31], v[124:127]
    ds_read_b64_tr_b16 a[52:53], v175 offset:32768
    buffer_load_dwordx4 v166, s[24:27], s59 offen offset:2048 lds
    s_waitcnt lgkmcnt(9)
    v_mfma_f32_16x16x32_bf16 v[64:67], a[32:35], a[0:3], v[64:67]
    s_waitcnt lgkmcnt(5)
    ds_read_b64_tr_b16 a[54:55], v175 offset:33792
    ds_read_b64_tr_b16 a[56:57], v176 offset:32768
    buffer_load_dwordx4 v167, s[24:27], s59 offen offset:3072 lds
    v_mfma_f32_16x16x32_bf16 v[68:71], a[32:35], a[4:7], v[68:71]
    s_add_u32 m0, s60, 16384
    ds_read_b64_tr_b16 a[58:59], v176 offset:33792
    v_mfma_f32_16x16x32_bf16 v[72:75], a[36:39], a[0:3], v[72:75]
    ds_read_b64_tr_b16 a[60:61], v177 offset:32768
    v_mfma_f32_16x16x32_bf16 v[76:79], a[36:39], a[4:7], v[76:79]
    s_lshl_b32 s58, s58, 7
    ds_read_b64_tr_b16 a[62:63], v177 offset:33792
    v_mfma_f32_16x16x32_bf16 v[80:83], a[40:43], a[0:3], v[80:83]
    s_waitcnt lgkmcnt(5)
    ds_read_b128 a[8:11], v169 offset:32768
    ds_read_b128 a[12:15], v169 offset:34816
    buffer_load_dwordx4 v160, s[20:23], s58 offen offset:0 lds
    v_mfma_f32_16x16x32_bf16 v[84:87], a[40:43], a[4:7], v[84:87]
    ds_read_b64_tr_b16 a[64:65], v170 offset:40960
    v_mfma_f32_16x16x32_bf16 v[88:91], a[44:47], a[0:3], v[88:91]
    ds_read_b64_tr_b16 a[66:67], v170 offset:41984
    buffer_load_dwordx4 v161, s[20:23], s58 offen offset:1024 lds
    v_mfma_f32_16x16x32_bf16 v[92:95], a[44:47], a[4:7], v[92:95]
    ds_read_b64_tr_b16 a[68:69], v171 offset:40960
    ds_read_b64_tr_b16 a[70:71], v171 offset:41984
    buffer_load_dwordx4 v162, s[20:23], s58 offen offset:2048 lds
    v_mfma_f32_16x16x32_bf16 v[96:99], a[48:51], a[0:3], v[96:99]
    s_waitcnt lgkmcnt(6)
    ds_read_b64_tr_b16 a[72:73], v172 offset:40960
    buffer_load_dwordx4 v163, s[20:23], s58 offen offset:3072 lds
    v_mfma_f32_16x16x32_bf16 v[100:103], a[48:51], a[4:7], v[100:103]
    ds_read_b64_tr_b16 a[74:75], v172 offset:41984
    v_mfma_f32_16x16x32_bf16 v[104:107], a[52:55], a[0:3], v[104:107]
    s_add_u32 m0, s60, 98304
    ds_read_b64_tr_b16 a[76:77], v173 offset:40960
    v_mfma_f32_16x16x32_bf16 v[108:111], a[52:55], a[4:7], v[108:111]
    s_xor_b32 s61, s12, 0
    ds_read_b64_tr_b16 a[78:79], v173 offset:41984
    ds_read_b64_tr_b16 a[80:81], v174 offset:40960
    v_mfma_f32_16x16x32_bf16 v[112:115], a[56:59], a[0:3], v[112:115]
    s_waitcnt lgkmcnt(5)
    ds_read_b64_tr_b16 a[82:83], v174 offset:41984
    buffer_load_dwordx4 v238, s[28:31], s61 offen offset:2048 nt lds
    v_mfma_f32_16x16x32_bf16 v[116:119], a[56:59], a[4:7], v[116:119]
    ds_read_b64_tr_b16 a[84:85], v175 offset:40960
    v_mfma_f32_16x16x32_bf16 v[120:123], a[60:63], a[0:3], v[120:123]
    ds_read_b64_tr_b16 a[86:87], v175 offset:41984
    ds_read_b64_tr_b16 a[88:89], v176 offset:40960
    buffer_load_dwordx4 v239, s[28:31], s61 offen offset:3072 nt lds
    v_mfma_f32_16x16x32_bf16 v[124:127], a[60:63], a[4:7], v[124:127]
    s_add_u32 m0, s60, 114688
    ds_read_b64_tr_b16 a[90:91], v176 offset:41984
    v_mfma_f32_16x16x32_bf16 v[64:67], a[64:67], a[8:11], v[64:67]
    s_xor_b32 s61, s12, 16384
    s_waitcnt lgkmcnt(5)
    ds_read_b64_tr_b16 a[92:93], v177 offset:40960
    v_mfma_f32_16x16x32_bf16 v[68:71], a[64:67], a[12:15], v[68:71]
    ds_read_b64_tr_b16 a[94:95], v177 offset:41984
    v_mfma_f32_16x16x32_bf16 v[72:75], a[68:71], a[8:11], v[72:75]
    buffer_load_dwordx4 v236, s[28:31], s61 offen offset:0 nt lds
    v_mfma_f32_16x16x32_bf16 v[76:79], a[68:71], a[12:15], v[76:79]
    buffer_load_dwordx4 v237, s[28:31], s61 offen offset:1024 nt lds
    v_mfma_f32_16x16x32_bf16 v[80:83], a[72:75], a[8:11], v[80:83]
    s_waitcnt lgkmcnt(2)
    v_mfma_f32_16x16x32_bf16 v[84:87], a[72:75], a[12:15], v[84:87]
    v_mfma_f32_16x16x32_bf16 v[88:91], a[76:79], a[8:11], v[88:91]
    s_waitcnt vmcnt(12) lgkmcnt(0)
    s_barrier
    ds_read_b128 a[16:19], v168 offset:0
    ds_read_b128 a[20:23], v168 offset:2048
    v_mfma_f32_16x16x32_bf16 v[92:95], a[76:79], a[12:15], v[92:95]
    s_add_u32 s58, s54, 5
    ds_read_b64_tr_b16 a[96:97], v170 offset:0
    v_mfma_f32_16x16x32_bf16 v[96:99], a[80:83], a[8:11], v[96:99]
    ds_read_b64_tr_b16 a[98:99], v170 offset:1024
    v_mfma_f32_16x16x32_bf16 v[100:103], a[80:83], a[12:15], v[100:103]
    s_and_b32 s58, s58, 7
    ds_read_b64_tr_b16 a[100:101], v171 offset:0
    ds_read_b64_tr_b16 a[102:103], v171 offset:1024
    v_mfma_f32_16x16x32_bf16 v[104:107], a[84:87], a[8:11], v[104:107]
    ds_read_b64_tr_b16 a[104:105], v172 offset:0
    v_mfma_f32_16x16x32_bf16 v[108:111], a[84:87], a[12:15], v[108:111]
    s_add_u32 m0, s60, 81920
    ds_read_b64_tr_b16 a[106:107], v172 offset:1024
    v_mfma_f32_16x16x32_bf16 v[112:115], a[88:91], a[8:11], v[112:115]
    s_waitcnt lgkmcnt(5)
    ds_read_b64_tr_b16 a[108:109], v173 offset:0
    v_mfma_f32_16x16x32_bf16 v[116:119], a[88:91], a[12:15], v[116:119]
    s_lshl_b32 s59, s58, 19
    ds_read_b64_tr_b16 a[110:111], v173 offset:1024
    ds_read_b64_tr_b16 a[112:113], v174 offset:0
    v_mfma_f32_16x16x32_bf16 v[120:123], a[92:95], a[8:11], v[120:123]
    ds_read_b64_tr_b16 a[114:115], v174 offset:1024
    v_mfma_f32_16x16x32_bf16 v[124:127], a[92:95], a[12:15], v[124:127]
    ds_read_b64_tr_b16 a[116:117], v175 offset:0
    buffer_load_dwordx4 v164, s[24:27], s59 offen offset:0 lds
    s_waitcnt lgkmcnt(9)
    v_mfma_f32_16x16x32_bf16 v[64:67], a[96:99], a[16:19], v[64:67]
    s_waitcnt lgkmcnt(5)
    ds_read_b64_tr_b16 a[118:119], v175 offset:1024
    ds_read_b64_tr_b16 a[120:121], v176 offset:0
    v_mfma_f32_16x16x32_bf16 v[68:71], a[96:99], a[20:23], v[68:71]
    ds_read_b64_tr_b16 a[122:123], v176 offset:1024
    buffer_load_dwordx4 v165, s[24:27], s59 offen offset:1024 lds
    v_mfma_f32_16x16x32_bf16 v[72:75], a[100:103], a[16:19], v[72:75]
    ds_read_b64_tr_b16 a[124:125], v177 offset:0
    v_mfma_f32_16x16x32_bf16 v[76:79], a[100:103], a[20:23], v[76:79]
    ds_read_b64_tr_b16 a[126:127], v177 offset:1024
    buffer_load_dwordx4 v166, s[24:27], s59 offen offset:2048 lds
    v_mfma_f32_16x16x32_bf16 v[80:83], a[104:107], a[16:19], v[80:83]
    s_waitcnt lgkmcnt(5)
    ds_read_b128 a[24:27], v169 offset:0
    ds_read_b128 a[28:31], v169 offset:2048
    v_mfma_f32_16x16x32_bf16 v[84:87], a[104:107], a[20:23], v[84:87]
    ds_read_b64_tr_b16 a[128:129], v170 offset:8192
    v_mfma_f32_16x16x32_bf16 v[88:91], a[108:111], a[16:19], v[88:91]
    ds_read_b64_tr_b16 a[130:131], v170 offset:9216
    buffer_load_dwordx4 v167, s[24:27], s59 offen offset:3072 lds
    v_mfma_f32_16x16x32_bf16 v[92:95], a[108:111], a[20:23], v[92:95]
    ds_read_b64_tr_b16 a[132:133], v171 offset:8192
    ds_read_b64_tr_b16 a[134:135], v171 offset:9216
    v_mfma_f32_16x16x32_bf16 v[96:99], a[112:115], a[16:19], v[96:99]
    s_add_u32 m0, s60, 32768
    s_waitcnt lgkmcnt(6)
    ds_read_b64_tr_b16 a[136:137], v172 offset:8192
    v_mfma_f32_16x16x32_bf16 v[100:103], a[112:115], a[20:23], v[100:103]
    ds_read_b64_tr_b16 a[138:139], v172 offset:9216
    v_mfma_f32_16x16x32_bf16 v[104:107], a[116:119], a[16:19], v[104:107]
    s_lshl_b32 s58, s58, 7
    ds_read_b64_tr_b16 a[140:141], v173 offset:8192
    v_mfma_f32_16x16x32_bf16 v[108:111], a[116:119], a[20:23], v[108:111]
    ds_read_b64_tr_b16 a[142:143], v173 offset:9216
    ds_read_b64_tr_b16 a[144:145], v174 offset:8192
    v_mfma_f32_16x16x32_bf16 v[112:115], a[120:123], a[16:19], v[112:115]
    s_waitcnt lgkmcnt(5)
    ds_read_b64_tr_b16 a[146:147], v174 offset:9216
    buffer_load_dwordx4 v160, s[20:23], s58 offen offset:0 lds
    v_mfma_f32_16x16x32_bf16 v[116:119], a[120:123], a[20:23], v[116:119]
    ds_read_b64_tr_b16 a[148:149], v175 offset:8192
    v_mfma_f32_16x16x32_bf16 v[120:123], a[124:127], a[16:19], v[120:123]
    ds_read_b64_tr_b16 a[150:151], v175 offset:9216
    ds_read_b64_tr_b16 a[152:153], v176 offset:8192
    buffer_load_dwordx4 v161, s[20:23], s58 offen offset:1024 lds
    v_mfma_f32_16x16x32_bf16 v[124:127], a[124:127], a[20:23], v[124:127]
    ds_read_b64_tr_b16 a[154:155], v176 offset:9216
    v_mfma_f32_16x16x32_bf16 v[64:67], a[128:131], a[24:27], v[64:67]
    s_waitcnt lgkmcnt(5)
    ds_read_b64_tr_b16 a[156:157], v177 offset:8192
    buffer_load_dwordx4 v162, s[20:23], s58 offen offset:2048 lds
    v_mfma_f32_16x16x32_bf16 v[68:71], a[128:131], a[28:31], v[68:71]
    ds_read_b64_tr_b16 a[158:159], v177 offset:9216
    v_mfma_f32_16x16x32_bf16 v[72:75], a[132:135], a[24:27], v[72:75]
    buffer_load_dwordx4 v163, s[20:23], s58 offen offset:3072 lds
    v_mfma_f32_16x16x32_bf16 v[76:79], a[132:135], a[28:31], v[76:79]
    v_mfma_f32_16x16x32_bf16 v[80:83], a[136:139], a[24:27], v[80:83]
    s_waitcnt lgkmcnt(2)
    v_mfma_f32_16x16x32_bf16 v[84:87], a[136:139], a[28:31], v[84:87]
    v_mfma_f32_16x16x32_bf16 v[88:91], a[140:143], a[24:27], v[88:91]
    s_waitcnt vmcnt(12) lgkmcnt(0)
    s_barrier
    ds_read_b128 a[0:3], v168 offset:16384
    ds_read_b128 a[4:7], v168 offset:18432
    v_mfma_f32_16x16x32_bf16 v[92:95], a[140:143], a[28:31], v[92:95]
    s_add_u32 s58, s54, 6
    ds_read_b64_tr_b16 a[32:33], v170 offset:16384
    v_mfma_f32_16x16x32_bf16 v[96:99], a[144:147], a[24:27], v[96:99]
    s_and_b32 s58, s58, 7
    ds_read_b64_tr_b16 a[34:35], v170 offset:17408
    v_mfma_f32_16x16x32_bf16 v[100:103], a[144:147], a[28:31], v[100:103]
    s_add_u32 m0, s60, 49152
    ds_read_b64_tr_b16 a[36:37], v171 offset:16384
    ds_read_b64_tr_b16 a[38:39], v171 offset:17408
    v_mfma_f32_16x16x32_bf16 v[104:107], a[148:151], a[24:27], v[104:107]
    ds_read_b64_tr_b16 a[40:41], v172 offset:16384
    v_mfma_f32_16x16x32_bf16 v[108:111], a[148:151], a[28:31], v[108:111]
    s_lshl_b32 s59, s58, 19
    ds_read_b64_tr_b16 a[42:43], v172 offset:17408
    v_mfma_f32_16x16x32_bf16 v[112:115], a[152:155], a[24:27], v[112:115]
    s_waitcnt lgkmcnt(5)
    ds_read_b64_tr_b16 a[44:45], v173 offset:16384
    buffer_load_dwordx4 v164, s[24:27], s59 offen offset:0 lds
    v_mfma_f32_16x16x32_bf16 v[116:119], a[152:155], a[28:31], v[116:119]
    ds_read_b64_tr_b16 a[46:47], v173 offset:17408
    ds_read_b64_tr_b16 a[48:49], v174 offset:16384
    buffer_load_dwordx4 v165, s[24:27], s59 offen offset:1024 lds
    v_mfma_f32_16x16x32_bf16 v[120:123], a[156:159], a[24:27], v[120:123]
    ds_read_b64_tr_b16 a[50:51], v174 offset:17408
    v_mfma_f32_16x16x32_bf16 v[124:127], a[156:159], a[28:31], v[124:127]
    ds_read_b64_tr_b16 a[52:53], v175 offset:16384
    buffer_load_dwordx4 v166, s[24:27], s59 offen offset:2048 lds
    s_waitcnt lgkmcnt(9)
    v_mfma_f32_16x16x32_bf16 v[64:67], a[32:35], a[0:3], v[64:67]
    s_waitcnt lgkmcnt(5)
    ds_read_b64_tr_b16 a[54:55], v175 offset:17408
    ds_read_b64_tr_b16 a[56:57], v176 offset:16384
    buffer_load_dwordx4 v167, s[24:27], s59 offen offset:3072 lds
    v_mfma_f32_16x16x32_bf16 v[68:71], a[32:35], a[4:7], v[68:71]
    s_add_u32 m0, s60, 0
    ds_read_b64_tr_b16 a[58:59], v176 offset:17408
    v_mfma_f32_16x16x32_bf16 v[72:75], a[36:39], a[0:3], v[72:75]
    ds_read_b64_tr_b16 a[60:61], v177 offset:16384
    v_mfma_f32_16x16x32_bf16 v[76:79], a[36:39], a[4:7], v[76:79]
    s_lshl_b32 s58, s58, 7
    ds_read_b64_tr_b16 a[62:63], v177 offset:17408
    v_mfma_f32_16x16x32_bf16 v[80:83], a[40:43], a[0:3], v[80:83]
    s_waitcnt lgkmcnt(5)
    ds_read_b128 a[8:11], v169 offset:16384
    ds_read_b128 a[12:15], v169 offset:18432
    buffer_load_dwordx4 v160, s[20:23], s58 offen offset:0 lds
    v_mfma_f32_16x16x32_bf16 v[84:87], a[40:43], a[4:7], v[84:87]
    ds_read_b64_tr_b16 a[64:65], v170 offset:24576
    v_mfma_f32_16x16x32_bf16 v[88:91], a[44:47], a[0:3], v[88:91]
    ds_read_b64_tr_b16 a[66:67], v170 offset:25600
    buffer_load_dwordx4 v161, s[20:23], s58 offen offset:1024 lds
    v_mfma_f32_16x16x32_bf16 v[92:95], a[44:47], a[4:7], v[92:95]
    ds_read_b64_tr_b16 a[68:69], v171 offset:24576
    ds_read_b64_tr_b16 a[70:71], v171 offset:25600
    buffer_load_dwordx4 v162, s[20:23], s58 offen offset:2048 lds
    v_mfma_f32_16x16x32_bf16 v[96:99], a[48:51], a[0:3], v[96:99]
    s_waitcnt lgkmcnt(6)
    ds_read_b64_tr_b16 a[72:73], v172 offset:24576
    buffer_load_dwordx4 v163, s[20:23], s58 offen offset:3072 lds
    v_mfma_f32_16x16x32_bf16 v[100:103], a[48:51], a[4:7], v[100:103]
    ds_read_b64_tr_b16 a[74:75], v172 offset:25600
    v_mfma_f32_16x16x32_bf16 v[104:107], a[52:55], a[0:3], v[104:107]
    s_add_u32 m0, s60, 114688
    ds_read_b64_tr_b16 a[76:77], v173 offset:24576
    v_mfma_f32_16x16x32_bf16 v[108:111], a[52:55], a[4:7], v[108:111]
    s_xor_b32 s61, s12, 16384
    ds_read_b64_tr_b16 a[78:79], v173 offset:25600
    ds_read_b64_tr_b16 a[80:81], v174 offset:24576
    v_mfma_f32_16x16x32_bf16 v[112:115], a[56:59], a[0:3], v[112:115]
    s_waitcnt lgkmcnt(5)
    ds_read_b64_tr_b16 a[82:83], v174 offset:25600
    buffer_load_dwordx4 v238, s[28:31], s61 offen offset:2048 nt lds
    v_mfma_f32_16x16x32_bf16 v[116:119], a[56:59], a[4:7], v[116:119]
    ds_read_b64_tr_b16 a[84:85], v175 offset:24576
    v_mfma_f32_16x16x32_bf16 v[120:123], a[60:63], a[0:3], v[120:123]
    ds_read_b64_tr_b16 a[86:87], v175 offset:25600
    ds_read_b64_tr_b16 a[88:89], v176 offset:24576
    buffer_load_dwordx4 v239, s[28:31], s61 offen offset:3072 nt lds
    v_mfma_f32_16x16x32_bf16 v[124:127], a[60:63], a[4:7], v[124:127]
    s_add_u32 m0, s60, 131072
    ds_read_b64_tr_b16 a[90:91], v176 offset:25600
    v_mfma_f32_16x16x32_bf16 v[64:67], a[64:67], a[8:11], v[64:67]
    s_xor_b32 s61, s12, 32768
    s_waitcnt lgkmcnt(5)
    ds_read_b64_tr_b16 a[92:93], v177 offset:24576
    v_mfma_f32_16x16x32_bf16 v[68:71], a[64:67], a[12:15], v[68:71]
    ds_read_b64_tr_b16 a[94:95], v177 offset:25600
    v_mfma_f32_16x16x32_bf16 v[72:75], a[68:71], a[8:11], v[72:75]
    buffer_load_dwordx4 v236, s[28:31], s61 offen offset:0 nt lds
    v_mfma_f32_16x16x32_bf16 v[76:79], a[68:71], a[12:15], v[76:79]
    buffer_load_dwordx4 v237, s[28:31], s61 offen offset:1024 nt lds
    v_mfma_f32_16x16x32_bf16 v[80:83], a[72:75], a[8:11], v[80:83]
    s_waitcnt lgkmcnt(2)
    v_mfma_f32_16x16x32_bf16 v[84:87], a[72:75], a[12:15], v[84:87]
    v_mfma_f32_16x16x32_bf16 v[88:91], a[76:79], a[8:11], v[88:91]
    s_waitcnt vmcnt(12) lgkmcnt(0)
    s_barrier
    ds_read_b128 a[16:19], v168 offset:32768
    ds_read_b128 a[20:23], v168 offset:34816
    v_mfma_f32_16x16x32_bf16 v[92:95], a[76:79], a[12:15], v[92:95]
    s_add_u32 s58, s54, 7
    ds_read_b64_tr_b16 a[96:97], v170 offset:32768
    v_mfma_f32_16x16x32_bf16 v[96:99], a[80:83], a[8:11], v[96:99]
    ds_read_b64_tr_b16 a[98:99], v170 offset:33792
    v_mfma_f32_16x16x32_bf16 v[100:103], a[80:83], a[12:15], v[100:103]
    s_and_b32 s58, s58, 7
    ds_read_b64_tr_b16 a[100:101], v171 offset:32768
    ds_read_b64_tr_b16 a[102:103], v171 offset:33792
    v_mfma_f32_16x16x32_bf16 v[104:107], a[84:87], a[8:11], v[104:107]
    ds_read_b64_tr_b16 a[104:105], v172 offset:32768
    v_mfma_f32_16x16x32_bf16 v[108:111], a[84:87], a[12:15], v[108:111]
    s_add_u32 m0, s60, 65536
    ds_read_b64_tr_b16 a[106:107], v172 offset:33792
    v_mfma_f32_16x16x32_bf16 v[112:115], a[88:91], a[8:11], v[112:115]
    s_waitcnt lgkmcnt(5)
    ds_read_b64_tr_b16 a[108:109], v173 offset:32768
    v_mfma_f32_16x16x32_bf16 v[116:119], a[88:91], a[12:15], v[116:119]
    s_lshl_b32 s59, s58, 19
    ds_read_b64_tr_b16 a[110:111], v173 offset:33792
    ds_read_b64_tr_b16 a[112:113], v174 offset:32768
    v_mfma_f32_16x16x32_bf16 v[120:123], a[92:95], a[8:11], v[120:123]
    ds_read_b64_tr_b16 a[114:115], v174 offset:33792
    v_mfma_f32_16x16x32_bf16 v[124:127], a[92:95], a[12:15], v[124:127]
    ds_read_b64_tr_b16 a[116:117], v175 offset:32768
    buffer_load_dwordx4 v164, s[24:27], s59 offen offset:0 lds
    s_waitcnt lgkmcnt(9)
    v_mfma_f32_16x16x32_bf16 v[64:67], a[96:99], a[16:19], v[64:67]
    s_waitcnt lgkmcnt(5)
    ds_read_b64_tr_b16 a[118:119], v175 offset:33792
    ds_read_b64_tr_b16 a[120:121], v176 offset:32768
    v_mfma_f32_16x16x32_bf16 v[68:71], a[96:99], a[20:23], v[68:71]
    ds_read_b64_tr_b16 a[122:123], v176 offset:33792
    buffer_load_dwordx4 v165, s[24:27], s59 offen offset:1024 lds
    v_mfma_f32_16x16x32_bf16 v[72:75], a[100:103], a[16:19], v[72:75]
    ds_read_b64_tr_b16 a[124:125], v177 offset:32768
    v_mfma_f32_16x16x32_bf16 v[76:79], a[100:103], a[20:23], v[76:79]
    ds_read_b64_tr_b16 a[126:127], v177 offset:33792
    buffer_load_dwordx4 v166, s[24:27], s59 offen offset:2048 lds
    v_mfma_f32_16x16x32_bf16 v[80:83], a[104:107], a[16:19], v[80:83]
    s_waitcnt lgkmcnt(5)
    ds_read_b128 a[24:27], v169 offset:32768
    ds_read_b128 a[28:31], v169 offset:34816
    v_mfma_f32_16x16x32_bf16 v[84:87], a[104:107], a[20:23], v[84:87]
    ds_read_b64_tr_b16 a[128:129], v170 offset:40960
    v_mfma_f32_16x16x32_bf16 v[88:91], a[108:111], a[16:19], v[88:91]
    ds_read_b64_tr_b16 a[130:131], v170 offset:41984
    buffer_load_dwordx4 v167, s[24:27], s59 offen offset:3072 lds
    v_mfma_f32_16x16x32_bf16 v[92:95], a[108:111], a[20:23], v[92:95]
    ds_read_b64_tr_b16 a[132:133], v171 offset:40960
    ds_read_b64_tr_b16 a[134:135], v171 offset:41984
    v_mfma_f32_16x16x32_bf16 v[96:99], a[112:115], a[16:19], v[96:99]
    s_add_u32 m0, s60, 16384
    s_waitcnt lgkmcnt(6)
    ds_read_b64_tr_b16 a[136:137], v172 offset:40960
    v_mfma_f32_16x16x32_bf16 v[100:103], a[112:115], a[20:23], v[100:103]
    ds_read_b64_tr_b16 a[138:139], v172 offset:41984
    v_mfma_f32_16x16x32_bf16 v[104:107], a[116:119], a[16:19], v[104:107]
    s_lshl_b32 s58, s58, 7
    ds_read_b64_tr_b16 a[140:141], v173 offset:40960
    v_mfma_f32_16x16x32_bf16 v[108:111], a[116:119], a[20:23], v[108:111]
    ds_read_b64_tr_b16 a[142:143], v173 offset:41984
    ds_read_b64_tr_b16 a[144:145], v174 offset:40960
    v_mfma_f32_16x16x32_bf16 v[112:115], a[120:123], a[16:19], v[112:115]
    s_waitcnt lgkmcnt(5)
    ds_read_b64_tr_b16 a[146:147], v174 offset:41984
    buffer_load_dwordx4 v160, s[20:23], s58 offen offset:0 lds
    v_mfma_f32_16x16x32_bf16 v[116:119], a[120:123], a[20:23], v[116:119]
    ds_read_b64_tr_b16 a[148:149], v175 offset:40960
    v_mfma_f32_16x16x32_bf16 v[120:123], a[124:127], a[16:19], v[120:123]
    ds_read_b64_tr_b16 a[150:151], v175 offset:41984
    ds_read_b64_tr_b16 a[152:153], v176 offset:40960
    buffer_load_dwordx4 v161, s[20:23], s58 offen offset:1024 lds
    v_mfma_f32_16x16x32_bf16 v[124:127], a[124:127], a[20:23], v[124:127]
    ds_read_b64_tr_b16 a[154:155], v176 offset:41984
    v_mfma_f32_16x16x32_bf16 v[64:67], a[128:131], a[24:27], v[64:67]
    s_waitcnt lgkmcnt(5)
    ds_read_b64_tr_b16 a[156:157], v177 offset:40960
    buffer_load_dwordx4 v162, s[20:23], s58 offen offset:2048 lds
    v_mfma_f32_16x16x32_bf16 v[68:71], a[128:131], a[28:31], v[68:71]
    ds_read_b64_tr_b16 a[158:159], v177 offset:41984
    v_mfma_f32_16x16x32_bf16 v[72:75], a[132:135], a[24:27], v[72:75]
    buffer_load_dwordx4 v163, s[20:23], s58 offen offset:3072 lds
    v_mfma_f32_16x16x32_bf16 v[76:79], a[132:135], a[28:31], v[76:79]
    v_mfma_f32_16x16x32_bf16 v[80:83], a[136:139], a[24:27], v[80:83]
    s_waitcnt lgkmcnt(2)
    v_mfma_f32_16x16x32_bf16 v[84:87], a[136:139], a[28:31], v[84:87]
    v_mfma_f32_16x16x32_bf16 v[88:91], a[140:143], a[24:27], v[88:91]
    s_waitcnt vmcnt(12) lgkmcnt(0)
    s_barrier
    ds_read_b128 a[0:3], v168 offset:0
    ds_read_b128 a[4:7], v168 offset:2048
    v_mfma_f32_16x16x32_bf16 v[92:95], a[140:143], a[28:31], v[92:95]
    s_add_u32 m0, s60, 131072
    ds_read_b64_tr_b16 a[32:33], v170 offset:0
    v_mfma_f32_16x16x32_bf16 v[96:99], a[144:147], a[24:27], v[96:99]
    ds_read_b64_tr_b16 a[34:35], v170 offset:1024
    v_mfma_f32_16x16x32_bf16 v[100:103], a[144:147], a[28:31], v[100:103]
    ds_read_b64_tr_b16 a[36:37], v171 offset:0
    ds_read_b64_tr_b16 a[38:39], v171 offset:1024
    v_mfma_f32_16x16x32_bf16 v[104:107], a[148:151], a[24:27], v[104:107]
    s_xor_b32 s61, s12, 32768
    ds_read_b64_tr_b16 a[40:41], v172 offset:0
    v_mfma_f32_16x16x32_bf16 v[108:111], a[148:151], a[28:31], v[108:111]
    ds_read_b64_tr_b16 a[42:43], v172 offset:1024
    v_mfma_f32_16x16x32_bf16 v[112:115], a[152:155], a[24:27], v[112:115]
    s_waitcnt lgkmcnt(5)
    ds_read_b64_tr_b16 a[44:45], v173 offset:0
    v_mfma_f32_16x16x32_bf16 v[116:119], a[152:155], a[28:31], v[116:119]
    ds_read_b64_tr_b16 a[46:47], v173 offset:1024
    ds_read_b64_tr_b16 a[48:49], v174 offset:0
    v_mfma_f32_16x16x32_bf16 v[120:123], a[156:159], a[24:27], v[120:123]
    ds_read_b64_tr_b16 a[50:51], v174 offset:1024
    buffer_load_dwordx4 v238, s[28:31], s61 offen offset:2048 nt lds
    v_mfma_f32_16x16x32_bf16 v[124:127], a[156:159], a[28:31], v[124:127]
    ds_read_b64_tr_b16 a[52:53], v175 offset:0
    s_waitcnt lgkmcnt(9)
    v_mfma_f32_16x16x32_bf16 v[64:67], a[32:35], a[0:3], v[64:67]
    s_waitcnt lgkmcnt(5)
    ds_read_b64_tr_b16 a[54:55], v175 offset:1024
    ds_read_b64_tr_b16 a[56:57], v176 offset:0
    v_mfma_f32_16x16x32_bf16 v[68:71], a[32:35], a[4:7], v[68:71]
    ds_read_b64_tr_b16 a[58:59], v176 offset:1024
    v_mfma_f32_16x16x32_bf16 v[72:75], a[36:39], a[0:3], v[72:75]
    ds_read_b64_tr_b16 a[60:61], v177 offset:0
    buffer_load_dwordx4 v239, s[28:31], s61 offen offset:3072 nt lds
    v_mfma_f32_16x16x32_bf16 v[76:79], a[36:39], a[4:7], v[76:79]
    ds_read_b64_tr_b16 a[62:63], v177 offset:1024
    v_mfma_f32_16x16x32_bf16 v[80:83], a[40:43], a[0:3], v[80:83]
    s_waitcnt lgkmcnt(5)
    ds_read_b128 a[8:11], v169 offset:0
    ds_read_b128 a[12:15], v169 offset:2048
    v_mfma_f32_16x16x32_bf16 v[84:87], a[40:43], a[4:7], v[84:87]
    ds_read_b64_tr_b16 a[64:65], v170 offset:8192
    v_mfma_f32_16x16x32_bf16 v[88:91], a[44:47], a[0:3], v[88:91]
    s_add_u32 m0, s60, 147456
    ds_read_b64_tr_b16 a[66:67], v170 offset:9216
    v_mfma_f32_16x16x32_bf16 v[92:95], a[44:47], a[4:7], v[92:95]
    ds_read_b64_tr_b16 a[68:69], v171 offset:8192
    ds_read_b64_tr_b16 a[70:71], v171 offset:9216
    v_mfma_f32_16x16x32_bf16 v[96:99], a[48:51], a[0:3], v[96:99]
    s_waitcnt lgkmcnt(6)
    ds_read_b64_tr_b16 a[72:73], v172 offset:8192
    v_mfma_f32_16x16x32_bf16 v[100:103], a[48:51], a[4:7], v[100:103]
    s_xor_b32 s61, s12, 49152
    ds_read_b64_tr_b16 a[74:75], v172 offset:9216
    v_mfma_f32_16x16x32_bf16 v[104:107], a[52:55], a[0:3], v[104:107]
    ds_read_b64_tr_b16 a[76:77], v173 offset:8192
    v_mfma_f32_16x16x32_bf16 v[108:111], a[52:55], a[4:7], v[108:111]
    ds_read_b64_tr_b16 a[78:79], v173 offset:9216
    ds_read_b64_tr_b16 a[80:81], v174 offset:8192
    v_mfma_f32_16x16x32_bf16 v[112:115], a[56:59], a[0:3], v[112:115]
    s_waitcnt lgkmcnt(5)
    ds_read_b64_tr_b16 a[82:83], v174 offset:9216
    v_mfma_f32_16x16x32_bf16 v[116:119], a[56:59], a[4:7], v[116:119]
    ds_read_b64_tr_b16 a[84:85], v175 offset:8192
    buffer_load_dwordx4 v236, s[28:31], s61 offen offset:0 nt lds
    v_mfma_f32_16x16x32_bf16 v[120:123], a[60:63], a[0:3], v[120:123]
    ds_read_b64_tr_b16 a[86:87], v175 offset:9216
    ds_read_b64_tr_b16 a[88:89], v176 offset:8192
    v_mfma_f32_16x16x32_bf16 v[124:127], a[60:63], a[4:7], v[124:127]
    ds_read_b64_tr_b16 a[90:91], v176 offset:9216
    v_mfma_f32_16x16x32_bf16 v[64:67], a[64:67], a[8:11], v[64:67]
    s_waitcnt lgkmcnt(5)
    ds_read_b64_tr_b16 a[92:93], v177 offset:8192
    v_mfma_f32_16x16x32_bf16 v[68:71], a[64:67], a[12:15], v[68:71]
    ds_read_b64_tr_b16 a[94:95], v177 offset:9216
    buffer_load_dwordx4 v237, s[28:31], s61 offen offset:1024 nt lds
    v_mfma_f32_16x16x32_bf16 v[72:75], a[68:71], a[8:11], v[72:75]
    v_mfma_f32_16x16x32_bf16 v[76:79], a[68:71], a[12:15], v[76:79]
    v_mfma_f32_16x16x32_bf16 v[80:83], a[72:75], a[8:11], v[80:83]
    s_waitcnt lgkmcnt(2)
    v_mfma_f32_16x16x32_bf16 v[84:87], a[72:75], a[12:15], v[84:87]
    v_mfma_f32_16x16x32_bf16 v[88:91], a[76:79], a[8:11], v[88:91]
    s_waitcnt vmcnt(4) lgkmcnt(0)
    s_barrier
    ds_read_b128 a[16:19], v168 offset:16384
    ds_read_b128 a[20:23], v168 offset:18432
    v_mfma_f32_16x16x32_bf16 v[92:95], a[76:79], a[12:15], v[92:95]
    s_add_u32 m0, s60, 147456
    ds_read_b64_tr_b16 a[96:97], v170 offset:16384
    v_mfma_f32_16x16x32_bf16 v[96:99], a[80:83], a[8:11], v[96:99]
    ds_read_b64_tr_b16 a[98:99], v170 offset:17408
    v_mfma_f32_16x16x32_bf16 v[100:103], a[80:83], a[12:15], v[100:103]
    ds_read_b128 a[24:27], v169 offset:16384
    ds_read_b128 a[28:31], v169 offset:18432
    v_mfma_f32_16x16x32_bf16 v[104:107], a[84:87], a[8:11], v[104:107]
    s_xor_b32 s61, s12, 49152
    ds_read_b64_tr_b16 a[100:101], v170 offset:24576
    v_mfma_f32_16x16x32_bf16 v[108:111], a[84:87], a[12:15], v[108:111]
    ds_read_b64_tr_b16 a[102:103], v170 offset:25600
    v_mfma_f32_16x16x32_bf16 v[112:115], a[88:91], a[8:11], v[112:115]
    s_waitcnt lgkmcnt(5)
    ds_read_b64_tr_b16 a[104:105], v171 offset:16384
    v_mfma_f32_16x16x32_bf16 v[116:119], a[88:91], a[12:15], v[116:119]
    ds_read_b64_tr_b16 a[106:107], v171 offset:17408
    ds_read_b64_tr_b16 a[108:109], v171 offset:24576
    v_mfma_f32_16x16x32_bf16 v[120:123], a[92:95], a[8:11], v[120:123]
    ds_read_b64_tr_b16 a[110:111], v171 offset:25600
    buffer_load_dwordx4 v238, s[28:31], s61 offen offset:2048 nt lds
    v_mfma_f32_16x16x32_bf16 v[124:127], a[92:95], a[12:15], v[124:127]
    ds_read_b64_tr_b16 a[112:113], v172 offset:16384
    s_waitcnt lgkmcnt(9)
    v_mfma_f32_16x16x32_bf16 v[64:67], a[96:99], a[16:19], v[64:67]
    s_waitcnt lgkmcnt(5)
    ds_read_b64_tr_b16 a[114:115], v172 offset:17408
    ds_read_b64_tr_b16 a[116:117], v172 offset:24576
    v_mfma_f32_16x16x32_bf16 v[68:71], a[96:99], a[20:23], v[68:71]
    ds_read_b64_tr_b16 a[118:119], v172 offset:25600
    v_mfma_f32_16x16x32_bf16 v[64:67], a[100:103], a[24:27], v[64:67]
    ds_read_b64_tr_b16 a[120:121], v173 offset:16384
    buffer_load_dwordx4 v239, s[28:31], s61 offen offset:3072 nt lds
    v_mfma_f32_16x16x32_bf16 v[68:71], a[100:103], a[28:31], v[68:71]
    ds_read_b64_tr_b16 a[122:123], v173 offset:17408

    s_waitcnt lgkmcnt(8)
    v_mfma_f32_16x16x32_bf16 v[72:75], a[104:107], a[16:19], v[72:75]
    s_waitcnt lgkmcnt(5)
    ds_read_b64_tr_b16 a[124:125], v173 offset:24576
    ds_read_b64_tr_b16 a[126:127], v173 offset:25600
    v_mfma_f32_16x16x32_bf16 v[76:79], a[104:107], a[20:23], v[76:79]
    ds_read_b64_tr_b16 a[128:129], v174 offset:16384
    v_mfma_f32_16x16x32_bf16 v[72:75], a[108:111], a[24:27], v[72:75]
    s_add_u32 m0, s60, 32768
    ds_read_b64_tr_b16 a[130:131], v174 offset:17408
    v_mul_f32 v64, s65, v64
    v_mul_f32 v65, s65, v65
    v_mul_f32 v66, s65, v66
    v_mul_f32 v67, s65, v67
    v_mfma_f32_16x16x32_bf16 v[76:79], a[108:111], a[28:31], v[76:79]
    ds_read_b64_tr_b16 a[132:133], v174 offset:24576
    ds_read_b64_tr_b16 a[134:135], v174 offset:25600
    v_cvt_pk_bf16_f32 v32, v64, v65
    v_cvt_pk_bf16_f32 v33, v66, v67
    v_mul_f32 v68, s65, v68
    s_waitcnt lgkmcnt(10)
    v_mfma_f32_16x16x32_bf16 v[80:83], a[112:115], a[16:19], v[80:83]
    s_waitcnt lgkmcnt(6)
    ds_read_b64_tr_b16 a[136:137], v175 offset:16384
    v_mul_f32 v69, s65, v69
    v_mul_f32 v70, s65, v70
    v_mul_f32 v71, s65, v71
    v_cvt_pk_bf16_f32 v36, v68, v69
    v_mfma_f32_16x16x32_bf16 v[84:87], a[112:115], a[20:23], v[84:87]
    s_xor_b32 s61, s12, 65536
    ds_read_b64_tr_b16 a[138:139], v175 offset:17408
    v_cvt_pk_bf16_f32 v37, v70, v71
    v_mfma_f32_16x16x32_bf16 v[80:83], a[116:119], a[24:27], v[80:83]
    ds_read_b64_tr_b16 a[140:141], v175 offset:24576
    v_mul_f32 v72, s65, v72
    v_mul_f32 v73, s65, v73
    v_mul_f32 v74, s65, v74
    v_mul_f32 v75, s65, v75
    v_mfma_f32_16x16x32_bf16 v[84:87], a[116:119], a[28:31], v[84:87]
    ds_read_b64_tr_b16 a[142:143], v175 offset:25600
    ds_read_b64_tr_b16 a[144:145], v176 offset:16384
    v_cvt_pk_bf16_f32 v34, v72, v73
    v_cvt_pk_bf16_f32 v35, v74, v75
    v_mul_f32 v76, s65, v76
    v_mfma_f32_16x16x32_bf16 v[88:91], a[120:123], a[16:19], v[88:91]
    s_waitcnt lgkmcnt(5)
    ds_read_b64_tr_b16 a[146:147], v176 offset:17408
    v_mul_f32 v77, s65, v77
    v_mul_f32 v78, s65, v78
    v_mul_f32 v79, s65, v79
    v_cvt_pk_bf16_f32 v38, v76, v77
    v_mfma_f32_16x16x32_bf16 v[92:95], a[120:123], a[20:23], v[92:95]
    ds_read_b64_tr_b16 a[148:149], v176 offset:24576
    buffer_load_dwordx4 v236, s[28:31], s61 offen offset:0 nt lds
    v_cvt_pk_bf16_f32 v39, v78, v79
    v_permlane32_swap_b32 v32, v34
    v_permlane32_swap_b32 v33, v35
    v_mfma_f32_16x16x32_bf16 v[88:91], a[124:127], a[24:27], v[88:91]
    ds_read_b64_tr_b16 a[150:151], v176 offset:25600
    ds_read_b64_tr_b16 a[152:153], v177 offset:16384
    v_permlane32_swap_b32 v36, v38
    v_permlane32_swap_b32 v37, v39
    v_permlane16_swap_b32 v32, v34
    v_mfma_f32_16x16x32_bf16 v[92:95], a[124:127], a[28:31], v[92:95]
    ds_read_b64_tr_b16 a[154:155], v177 offset:17408
    v_permlane16_swap_b32 v33, v35
    v_permlane16_swap_b32 v36, v38
    v_permlane16_swap_b32 v37, v39
    v_mul_f32 v80, s65, v80
    v_mfma_f32_16x16x32_bf16 v[96:99], a[128:131], a[16:19], v[96:99]
    s_waitcnt lgkmcnt(5)
    ds_read_b64_tr_b16 a[156:157], v177 offset:24576
    v_mul_f32 v81, s65, v81
    v_mul_f32 v82, s65, v82
    v_mul_f32 v83, s65, v83
    v_cvt_pk_bf16_f32 v40, v80, v81
    v_mfma_f32_16x16x32_bf16 v[100:103], a[128:131], a[20:23], v[100:103]
    ds_read_b64_tr_b16 a[158:159], v177 offset:25600
    buffer_load_dwordx4 v237, s[28:31], s61 offen offset:1024 nt lds
    v_cvt_pk_bf16_f32 v41, v82, v83
    v_mul_f32 v84, s65, v84
    v_mul_f32 v85, s65, v85
    v_mfma_f32_16x16x32_bf16 v[96:99], a[132:135], a[24:27], v[96:99]
    v_mul_f32 v86, s65, v86
    v_mul_f32 v87, s65, v87
    v_cvt_pk_bf16_f32 v44, v84, v85
    v_cvt_pk_bf16_f32 v45, v86, v87
    v_mul_f32 v88, s65, v88
    v_mfma_f32_16x16x32_bf16 v[100:103], a[132:135], a[28:31], v[100:103]
    v_mul_f32 v89, s65, v89
    v_mul_f32 v90, s65, v90
    v_mul_f32 v91, s65, v91
    v_cvt_pk_bf16_f32 v42, v88, v89
    v_cvt_pk_bf16_f32 v43, v90, v91
    v_mfma_f32_16x16x32_bf16 v[104:107], a[136:139], a[16:19], v[104:107]
    s_waitcnt lgkmcnt(2)
    v_mul_f32 v92, s65, v92
    v_mul_f32 v93, s65, v93
    v_mul_f32 v94, s65, v94
    v_mul_f32 v95, s65, v95
    v_cvt_pk_bf16_f32 v46, v92, v93
    v_mfma_f32_16x16x32_bf16 v[108:111], a[136:139], a[20:23], v[108:111]
    v_cvt_pk_bf16_f32 v47, v94, v95
    v_permlane32_swap_b32 v40, v42
    v_permlane32_swap_b32 v41, v43
    v_permlane32_swap_b32 v44, v46
    v_permlane32_swap_b32 v45, v47
    v_mfma_f32_16x16x32_bf16 v[104:107], a[140:143], a[24:27], v[104:107]
    s_waitcnt vmcnt(14)
    s_barrier
    ds_read_b128 a[160:163], v232 offset:0
    v_permlane16_swap_b32 v40, v42
    v_permlane16_swap_b32 v41, v43
    v_permlane16_swap_b32 v44, v46
    v_mfma_f32_16x16x32_bf16 v[108:111], a[140:143], a[28:31], v[108:111]
    v_permlane16_swap_b32 v45, v47
    v_mul_f32 v96, s65, v96
    v_mul_f32 v97, s65, v97
    v_mul_f32 v98, s65, v98
    v_mul_f32 v99, s65, v99
    v_mfma_f32_16x16x32_bf16 v[112:115], a[144:147], a[16:19], v[112:115]
    s_waitcnt lgkmcnt(1)
    ds_read_b128 a[176:179], v232 offset:4096
    v_cvt_pk_bf16_f32 v48, v96, v97
    v_cvt_pk_bf16_f32 v49, v98, v99
    v_mul_f32 v100, s65, v100
    v_mul_f32 v101, s65, v101
    v_mfma_f32_16x16x32_bf16 v[116:119], a[144:147], a[20:23], v[116:119]
    buffer_load_dwordx4 v238, s[28:31], s61 offen offset:2048 nt lds
    v_mul_f32 v102, s65, v102
    v_mul_f32 v103, s65, v103
    v_cvt_pk_bf16_f32 v52, v100, v101
    v_cvt_pk_bf16_f32 v53, v102, v103
    v_mfma_f32_16x16x32_bf16 v[112:115], a[148:151], a[24:27], v[112:115]
    ds_read_b128 a[164:167], v233 offset:0
    buffer_load_dwordx4 v239, s[28:31], s61 offen offset:3072 nt lds
    v_mul_f32 v104, s65, v104
    v_mul_f32 v105, s65, v105
    v_mul_f32 v106, s65, v106
    v_mfma_f32_16x16x32_bf16 v[116:119], a[148:151], a[28:31], v[116:119]
    v_mul_f32 v107, s65, v107
    v_cvt_pk_bf16_f32 v50, v104, v105
    v_cvt_pk_bf16_f32 v51, v106, v107
    v_mul_f32 v108, s65, v108
    v_mul_f32 v109, s65, v109
    v_mfma_f32_16x16x32_bf16 v[120:123], a[152:155], a[16:19], v[120:123]
    s_waitcnt lgkmcnt(2)
    ds_read_b128 a[180:183], v233 offset:4096
    v_mul_f32 v110, s65, v110
    v_mul_f32 v111, s65, v111
    v_cvt_pk_bf16_f32 v54, v108, v109
    v_cvt_pk_bf16_f32 v55, v110, v111
    v_mfma_f32_16x16x32_bf16 v[124:127], a[152:155], a[20:23], v[124:127]
    v_permlane32_swap_b32 v48, v50
    v_permlane32_swap_b32 v49, v51
    v_permlane32_swap_b32 v52, v54
    v_permlane32_swap_b32 v53, v55
    v_permlane16_swap_b32 v48, v50
    v_mfma_f32_16x16x32_bf16 v[120:123], a[156:159], a[24:27], v[120:123]
    ds_read_b128 a[168:171], v234 offset:0
    v_permlane16_swap_b32 v49, v51
    v_permlane16_swap_b32 v52, v54
    v_permlane16_swap_b32 v53, v55
    v_mul_f32 v112, s65, v112
    v_mfma_f32_16x16x32_bf16 v[124:127], a[156:159], a[28:31], v[124:127]
    v_mul_f32 v113, s65, v113
    v_mul_f32 v114, s65, v114
    v_mul_f32 v115, s65, v115
    v_cvt_pk_bf16_f32 v56, v112, v113
    v_cvt_pk_bf16_f32 v57, v114, v115
    v_mfma_f32_16x16x32_bf16 v[0:3], a[160:163], v[32:35], 0
    s_waitcnt lgkmcnt(2)
    ds_read_b128 a[184:187], v234 offset:4096
    v_mul_f32 v116, s65, v116
    v_mul_f32 v117, s65, v117
    v_mul_f32 v118, s65, v118
    v_mul_f32 v119, s65, v119
    v_mfma_f32_16x16x32_bf16 v[4:7], a[160:163], v[36:39], 0
    v_cvt_pk_bf16_f32 v60, v116, v117
    v_cvt_pk_bf16_f32 v61, v118, v119
    v_mfma_f32_16x16x32_bf16 v[8:11], a[176:179], v[32:35], 0
    ds_read_b128 a[172:175], v235 offset:0
    v_mul_f32 v120, s65, v120
    v_mul_f32 v121, s65, v121
    v_mul_f32 v122, s65, v122
    v_mul_f32 v123, s65, v123
    v_mfma_f32_16x16x32_bf16 v[12:15], a[176:179], v[36:39], 0
    v_cvt_pk_bf16_f32 v58, v120, v121
    v_cvt_pk_bf16_f32 v59, v122, v123
    v_mul_f32 v124, s65, v124
    v_mul_f32 v125, s65, v125
    v_mul_f32 v126, s65, v126
    v_mfma_f32_16x16x32_bf16 v[0:3], a[164:167], v[40:43], v[0:3]
    s_add_u32 m0, s60, 81920
    s_waitcnt lgkmcnt(2)
    ds_read_b128 a[188:191], v235 offset:4096
    v_mul_f32 v127, s65, v127
    v_cvt_pk_bf16_f32 v62, v124, v125
    v_cvt_pk_bf16_f32 v63, v126, v127
    v_mfma_f32_16x16x32_bf16 v[4:7], a[164:167], v[44:47], v[4:7]
    s_xor_b32 s61, s12, 81920
    v_permlane32_swap_b32 v56, v58
    v_permlane32_swap_b32 v57, v59
    v_permlane32_swap_b32 v60, v62
    v_permlane32_swap_b32 v61, v63
    v_permlane16_swap_b32 v56, v58
    v_mfma_f32_16x16x32_bf16 v[8:11], a[180:183], v[40:43], v[8:11]
    ds_read_b128 a[192:195], v232 offset:8192
    buffer_load_dwordx4 v236, s[28:31], s61 offen offset:0 nt lds
    v_permlane16_swap_b32 v57, v59
    v_permlane16_swap_b32 v60, v62
    v_permlane16_swap_b32 v61, v63
    v_mfma_f32_16x16x32_bf16 v[12:15], a[180:183], v[44:47], v[12:15]
    v_mfma_f32_16x16x32_bf16 v[0:3], a[168:171], v[48:51], v[0:3]
    s_waitcnt lgkmcnt(2)
    ds_read_b128 a[208:211], v232 offset:12288
    v_mfma_f32_16x16x32_bf16 v[4:7], a[168:171], v[52:55], v[4:7]
    v_mfma_f32_16x16x32_bf16 v[8:11], a[184:187], v[48:51], v[8:11]
    ds_read_b128 a[196:199], v233 offset:8192
    buffer_load_dwordx4 v237, s[28:31], s61 offen offset:1024 nt lds
    v_mfma_f32_16x16x32_bf16 v[12:15], a[184:187], v[52:55], v[12:15]
    v_mfma_f32_16x16x32_bf16 v[0:3], a[172:175], v[56:59], v[0:3]
    s_waitcnt lgkmcnt(2)
    ds_read_b128 a[212:215], v233 offset:12288
    v_mfma_f32_16x16x32_bf16 v[4:7], a[172:175], v[60:63], v[4:7]
    v_mfma_f32_16x16x32_bf16 v[8:11], a[188:191], v[56:59], v[8:11]
    ds_read_b128 a[200:203], v234 offset:8192
    v_mfma_f32_16x16x32_bf16 v[12:15], a[188:191], v[60:63], v[12:15]
    v_mfma_f32_16x16x32_bf16 v[16:19], a[192:195], v[32:35], 0
    s_waitcnt lgkmcnt(2)
    ds_read_b128 a[216:219], v234 offset:12288
    v_mfma_f32_16x16x32_bf16 v[20:23], a[192:195], v[36:39], 0
    v_mfma_f32_16x16x32_bf16 v[24:27], a[208:211], v[32:35], 0
    ds_read_b128 a[204:207], v235 offset:8192
    v_mfma_f32_16x16x32_bf16 v[28:31], a[208:211], v[36:39], 0
    v_mfma_f32_16x16x32_bf16 v[16:19], a[196:199], v[40:43], v[16:19]
    s_waitcnt lgkmcnt(2)
    ds_read_b128 a[220:223], v235 offset:12288
    v_max3_f32 v200, v0, v1, v2
    v_max3_f32 v201, v4, v5, v6
    v_max3_f32 v200, v200, v3, v8
    v_max3_f32 v201, v201, v7, v12
    v_mfma_f32_16x16x32_bf16 v[20:23], a[196:199], v[44:47], v[20:23]
    v_max3_f32 v200, v200, v9, v10
    v_max3_f32 v201, v201, v13, v14
    v_mfma_f32_16x16x32_bf16 v[24:27], a[212:215], v[40:43], v[24:27]
    s_waitcnt vmcnt(5)
    s_barrier
    ds_read_b128 a[160:163], v232 offset:16384
    v_mfma_f32_16x16x32_bf16 v[28:31], a[212:215], v[44:47], v[28:31]
    v_mfma_f32_16x16x32_bf16 v[16:19], a[200:203], v[48:51], v[16:19]
    s_waitcnt lgkmcnt(2)
    ds_read_b128 a[164:167], v233 offset:16384
    v_mfma_f32_16x16x32_bf16 v[20:23], a[200:203], v[52:55], v[20:23]
    buffer_load_dwordx4 v238, s[28:31], s61 offen offset:2048 nt lds
    v_mfma_f32_16x16x32_bf16 v[24:27], a[216:219], v[48:51], v[24:27]
    ds_read_b128 a[168:171], v234 offset:16384
    buffer_load_dwordx4 v239, s[28:31], s61 offen offset:3072 nt lds
    v_mfma_f32_16x16x32_bf16 v[28:31], a[216:219], v[52:55], v[28:31]
    v_mfma_f32_16x16x32_bf16 v[16:19], a[204:207], v[56:59], v[16:19]
    s_waitcnt lgkmcnt(2)
    ds_read_b128 a[172:175], v235 offset:16384
    v_mfma_f32_16x16x32_bf16 v[20:23], a[204:207], v[60:63], v[20:23]
    v_mfma_f32_16x16x32_bf16 v[24:27], a[220:223], v[56:59], v[24:27]
    ds_read_b128 a[176:179], v232 offset:20480
    v_mfma_f32_16x16x32_bf16 v[28:31], a[220:223], v[60:63], v[28:31]

    s_nop 1
    v_max3_f32 v200, v200, v11, v16
    s_nop 1
    v_max3_f32 v201, v201, v15, v20
    v_max3_f32 v200, v200, v17, v18
    v_max3_f32 v201, v201, v21, v22
    v_max3_f32 v200, v200, v19, v24
    v_max3_f32 v201, v201, v23, v28
    v_max3_f32 v200, v200, v25, v26
    v_max3_f32 v201, v201, v29, v30
    v_max_f32 v200, v200, v27
    v_max_f32 v201, v201, v31
    v_mov_b32 v202, v200
    v_mov_b32 v203, v201
    s_nop 0
    v_permlane16_swap_b32 v200, v202
    v_permlane16_swap_b32 v201, v203
    v_max_f32 v200, v200, v202
    v_max_f32 v201, v201, v203
    v_mov_b32 v202, v200
    v_mov_b32 v203, v201
    s_nop 0
    v_permlane32_swap_b32 v200, v202
    v_permlane32_swap_b32 v201, v203
    v_max_f32 v200, v200, v202
    v_max_f32 v201, v201, v203
    v_sub_f32 v208, 0, v200
    v_sub_f32 v209, 0, v200
    v_sub_f32 v210, 0, v200
    v_sub_f32 v211, 0, v200
    v_sub_f32 v212, 0, v201
    v_sub_f32 v213, 0, v201
    v_sub_f32 v214, 0, v201
    v_sub_f32 v215, 0, v201

    v_mfma_f32_16x16x32_bf16 v[64:67], a[160:163], v[32:35], v[208:211]
    s_waitcnt lgkmcnt(2)
    ds_read_b128 a[180:183], v233 offset:20480
    v_add_f32 v0, v0, v208
    v_add_f32 v1, v1, v208
    v_add_f32 v2, v2, v208
    v_mfma_f32_16x16x32_bf16 v[68:71], a[160:163], v[36:39], v[212:215]
    v_add_f32 v3, v3, v208
    v_add_f32 v4, v4, v212
    v_add_f32 v5, v5, v212
    v_add_f32 v6, v6, v212
    v_mfma_f32_16x16x32_bf16 v[64:67], a[164:167], v[40:43], v[64:67]
    ds_read_b128 a[184:187], v234 offset:20480
    v_add_f32 v7, v7, v212
    v_add_f32 v8, v8, v208
    v_add_f32 v9, v9, v208
    v_mfma_f32_16x16x32_bf16 v[68:71], a[164:167], v[44:47], v[68:71]
    v_add_f32 v10, v10, v208
    v_add_f32 v11, v11, v208
    v_exp_f32 v0, v0
    v_mfma_f32_16x16x32_bf16 v[64:67], a[168:171], v[48:51], v[64:67]
    s_add_u32 m0, s60, 49152
    s_waitcnt lgkmcnt(2)
    ds_read_b128 a[188:191], v235 offset:20480
    v_add_f32 v12, v12, v212
    v_exp_f32 v1, v1
    v_mfma_f32_16x16x32_bf16 v[68:71], a[168:171], v[52:55], v[68:71]
    s_xor_b32 s61, s12, 98304
    v_add_f32 v13, v13, v212
    v_exp_f32 v2, v2
    v_mfma_f32_16x16x32_bf16 v[64:67], a[172:175], v[56:59], v[64:67]
    ds_read_b128 a[192:195], v232 offset:24576
    buffer_load_dwordx4 v236, s[28:31], s61 offen offset:0 nt lds
    v_add_f32 v14, v14, v212
    v_cvt_pk_bf16_f32 v96, v0, v1
    v_mfma_f32_16x16x32_bf16 v[68:71], a[172:175], v[60:63], v[68:71]
    v_add_f32 v15, v15, v212
    v_exp_f32 v3, v3
    v_add_f32 v16, v16, v208
    v_mfma_f32_16x16x32_bf16 v[72:75], a[176:179], v[32:35], v[208:211]
    s_waitcnt lgkmcnt(2)
    ds_read_b128 a[196:199], v233 offset:24576
    v_exp_f32 v4, v4
    v_add_f32 v17, v17, v208
    v_cvt_pk_bf16_f32 v97, v2, v3
    v_mfma_f32_16x16x32_bf16 v[76:79], a[176:179], v[36:39], v[212:215]
    v_add_f32 v18, v18, v208
    v_exp_f32 v5, v5
    v_add_f32 v19, v19, v208
    v_mfma_f32_16x16x32_bf16 v[72:75], a[180:183], v[40:43], v[72:75]
    ds_read_b128 a[200:203], v234 offset:24576
    buffer_load_dwordx4 v237, s[28:31], s61 offen offset:1024 nt lds
    v_exp_f32 v6, v6
    v_mfma_f32_16x16x32_bf16 v[76:79], a[180:183], v[44:47], v[76:79]
    v_max3_f32 v200, v64, v65, v66
    v_max3_f32 v201, v68, v69, v70
    v_add_f32 v20, v20, v212
    v_cvt_pk_bf16_f32 v100, v4, v5
    v_mfma_f32_16x16x32_bf16 v[72:75], a[184:187], v[48:51], v[72:75]
    s_waitcnt lgkmcnt(2)
    ds_read_b128 a[204:207], v235 offset:24576
    v_add_f32 v21, v21, v212
    v_exp_f32 v7, v7
    v_mfma_f32_16x16x32_bf16 v[76:79], a[184:187], v[52:55], v[76:79]
    v_add_f32 v22, v22, v212
    v_exp_f32 v8, v8
    v_add_f32 v23, v23, v212
    v_mfma_f32_16x16x32_bf16 v[72:75], a[188:191], v[56:59], v[72:75]
    ds_read_b128 a[208:211], v232 offset:28672
    v_cvt_pk_bf16_f32 v101, v6, v7
    v_add_f32 v24, v24, v208
    v_mfma_f32_16x16x32_bf16 v[76:79], a[188:191], v[60:63], v[76:79]
    v_exp_f32 v9, v9
    v_add_f32 v25, v25, v208
    v_exp_f32 v10, v10
    v_mfma_f32_16x16x32_bf16 v[80:83], a[192:195], v[32:35], v[208:211]
    s_waitcnt lgkmcnt(2)
    ds_read_b128 a[212:215], v233 offset:28672
    v_add_f32 v26, v26, v208
    v_cvt_pk_bf16_f32 v98, v8, v9
    v_add_f32 v27, v27, v208
    v_mfma_f32_16x16x32_bf16 v[84:87], a[192:195], v[36:39], v[212:215]
    v_exp_f32 v11, v11
    v_add_f32 v28, v28, v212
    v_exp_f32 v12, v12
    v_mfma_f32_16x16x32_bf16 v[80:83], a[196:199], v[40:43], v[80:83]
    ds_read_b128 a[216:219], v234 offset:28672
    v_add_f32 v29, v29, v212
    v_cvt_pk_bf16_f32 v99, v10, v11
    v_mfma_f32_16x16x32_bf16 v[84:87], a[196:199], v[44:47], v[84:87]
    v_max3_f32 v200, v200, v67, v72
    v_max3_f32 v201, v201, v71, v76
    v_max3_f32 v200, v200, v73, v74
    v_add_f32 v30, v30, v212
    v_mfma_f32_16x16x32_bf16 v[80:83], a[200:203], v[48:51], v[80:83]
    s_waitcnt lgkmcnt(2)
    ds_read_b128 a[220:223], v235 offset:28672
    v_max3_f32 v201, v201, v77, v78
    v_exp_f32 v13, v13
    v_mfma_f32_16x16x32_bf16 v[84:87], a[200:203], v[52:55], v[84:87]
    v_add_f32 v31, v31, v212
    v_exp_f32 v14, v14
    v_cvt_pk_bf16_f32 v102, v12, v13
    v_mfma_f32_16x16x32_bf16 v[80:83], a[204:207], v[56:59], v[80:83]
    s_waitcnt vmcnt(5)
    s_barrier
    ds_read_b128 a[160:163], v232 offset:32768
    v_exp_f32 v15, v15
    v_mfma_f32_16x16x32_bf16 v[84:87], a[204:207], v[60:63], v[84:87]
    v_exp_f32 v16, v16
    v_cvt_pk_bf16_f32 v103, v14, v15
    v_exp_f32 v17, v17
    v_mfma_f32_16x16x32_bf16 v[88:91], a[208:211], v[32:35], v[208:211]
    s_waitcnt lgkmcnt(2)
    ds_read_b128 a[164:167], v233 offset:32768
    v_exp_f32 v18, v18
    v_cvt_pk_bf16_f32 v104, v16, v17
    v_mfma_f32_16x16x32_bf16 v[92:95], a[208:211], v[36:39], v[212:215]
    buffer_load_dwordx4 v238, s[28:31], s61 offen offset:2048 nt lds
    v_exp_f32 v19, v19
    v_mfma_f32_16x16x32_bf16 v[88:91], a[212:215], v[40:43], v[88:91]
    ds_read_b128 a[168:171], v234 offset:32768
    buffer_load_dwordx4 v239, s[28:31], s61 offen offset:3072 nt lds
    v_exp_f32 v20, v20
    v_cvt_pk_bf16_f32 v105, v18, v19
    v_mfma_f32_16x16x32_bf16 v[92:95], a[212:215], v[44:47], v[92:95]
    v_max3_f32 v200, v200, v75, v80
    v_max3_f32 v201, v201, v79, v84
    v_max3_f32 v200, v200, v81, v82
    v_mfma_f32_16x16x32_bf16 v[88:91], a[216:219], v[48:51], v[88:91]
    s_waitcnt lgkmcnt(2)
    ds_read_b128 a[172:175], v235 offset:32768
    v_max3_f32 v201, v201, v85, v86
    v_exp_f32 v21, v21
    v_mfma_f32_16x16x32_bf16 v[92:95], a[216:219], v[52:55], v[92:95]
    v_exp_f32 v22, v22
    v_cvt_pk_bf16_f32 v108, v20, v21
    v_exp_f32 v23, v23
    v_mfma_f32_16x16x32_bf16 v[88:91], a[220:223], v[56:59], v[88:91]
    ds_read_b128 a[176:179], v232 offset:36864
    v_exp_f32 v24, v24
    v_cvt_pk_bf16_f32 v109, v22, v23
    v_mfma_f32_16x16x32_bf16 v[92:95], a[220:223], v[60:63], v[92:95]
    v_exp_f32 v25, v25
    v_exp_f32 v26, v26
    v_mfma_f32_16x16x32_bf16 v[0:3], a[160:163], v[32:35], v[208:211]
    s_waitcnt lgkmcnt(2)
    ds_read_b128 a[180:183], v233 offset:36864
    v_cvt_pk_bf16_f32 v106, v24, v25
    v_exp_f32 v27, v27
    v_mfma_f32_16x16x32_bf16 v[4:7], a[160:163], v[36:39], v[212:215]
    v_exp_f32 v28, v28
    v_cvt_pk_bf16_f32 v107, v26, v27
    v_exp_f32 v29, v29
    v_mfma_f32_16x16x32_bf16 v[0:3], a[164:167], v[40:43], v[0:3]
    ds_read_b128 a[184:187], v234 offset:36864
    v_exp_f32 v30, v30
    v_cvt_pk_bf16_f32 v110, v28, v29
    v_mfma_f32_16x16x32_bf16 v[4:7], a[164:167], v[44:47], v[4:7]
    v_exp_f32 v31, v31
    s_nop 0
    v_cvt_pk_bf16_f32 v111, v30, v31
    v_max3_f32 v200, v200, v83, v88
    v_mfma_f32_16x16x32_bf16 v[0:3], a[168:171], v[48:51], v[0:3]
    s_add_u32 m0, s60, 65536
    s_waitcnt lgkmcnt(2)
    ds_read_b128 a[188:191], v235 offset:36864
    v_max3_f32 v201, v201, v87, v92
    v_max3_f32 v200, v200, v89, v90
    v_mfma_f32_16x16x32_bf16 v[4:7], a[168:171], v[52:55], v[4:7]
    s_xor_b32 s61, s12, 114688
    v_max3_f32 v201, v201, v93, v94
    v_max3_f32 v202, v200, v201, v91
    v_max_f32 v202, v202, v95
    v_cmp_lt_f32 vcc, s64, v202
    s_cbranch_vccnz L_rare1
L_back1:
    v_mfma_f32_16x16x32_bf16 v[0:3], a[172:175], v[56:59], v[0:3]
    ds_read_b128 a[192:195], v232 offset:40960
    buffer_load_dwordx4 v236, s[28:31], s61 offen offset:0 nt lds
    v_exp_f32 v64, v64
    v_mfma_f32_16x16x32_bf16 v[4:7], a[172:175], v[60:63], v[4:7]
    v_exp_f32 v65, v65
    v_exp_f32 v66, v66
    v_cvt_pk_bf16_f32 v206, v64, v65
    v_mfma_f32_16x16x32_bf16 v[8:11], a[176:179], v[32:35], v[208:211]
    s_waitcnt lgkmcnt(2)
    ds_read_b128 a[196:199], v233 offset:40960
    v_exp_f32 v67, v67
    v_mfma_f32_16x16x32_bf16 v[12:15], a[176:179], v[36:39], v[212:215]
    v_exp_f32 v68, v68
    v_cvt_pk_bf16_f32 v207, v66, v67
    v_exp_f32 v69, v69
    v_mfma_f32_16x16x32_bf16 v[8:11], a[180:183], v[40:43], v[8:11]
    ds_read_b128 a[200:203], v234 offset:40960
    buffer_load_dwordx4 v237, s[28:31], s61 offen offset:1024 nt lds
    v_accvgpr_write_b32 a0, v206
    v_exp_f32 v70, v70
    v_mfma_f32_16x16x32_bf16 v[12:15], a[180:183], v[44:47], v[12:15]
    v_max3_f32 v200, v0, v1, v2
    v_max3_f32 v201, v4, v5, v6
    v_cvt_pk_bf16_f32 v206, v68, v69
    v_mfma_f32_16x16x32_bf16 v[8:11], a[184:187], v[48:51], v[8:11]
    s_waitcnt lgkmcnt(2)
    ds_read_b128 a[204:207], v235 offset:40960
    v_exp_f32 v71, v71
    v_accvgpr_write_b32 a1, v207
    v_mfma_f32_16x16x32_bf16 v[12:15], a[184:187], v[52:55], v[12:15]
    v_exp_f32 v72, v72
    v_cvt_pk_bf16_f32 v207, v70, v71
    v_exp_f32 v73, v73
    v_mfma_f32_16x16x32_bf16 v[8:11], a[188:191], v[56:59], v[8:11]
    ds_read_b128 a[208:211], v232 offset:45056
    v_accvgpr_write_b32 a4, v206
    v_exp_f32 v74, v74
    v_cvt_pk_bf16_f32 v206, v72, v73
    v_mfma_f32_16x16x32_bf16 v[12:15], a[188:191], v[60:63], v[12:15]
    v_exp_f32 v75, v75
    v_accvgpr_write_b32 a5, v207
    v_exp_f32 v76, v76
    v_mfma_f32_16x16x32_bf16 v[16:19], a[192:195], v[32:35], v[208:211]
    s_waitcnt lgkmcnt(2)
    ds_read_b128 a[212:215], v233 offset:45056
    v_cvt_pk_bf16_f32 v207, v74, v75
    v_exp_f32 v77, v77
    v_mfma_f32_16x16x32_bf16 v[20:23], a[192:195], v[36:39], v[212:215]
    v_accvgpr_write_b32 a2, v206
    v_exp_f32 v78, v78
    v_cvt_pk_bf16_f32 v206, v76, v77
    v_mfma_f32_16x16x32_bf16 v[16:19], a[196:199], v[40:43], v[16:19]
    ds_read_b128 a[216:219], v234 offset:45056
    v_exp_f32 v79, v79
    v_accvgpr_write_b32 a3, v207
    v_mfma_f32_16x16x32_bf16 v[20:23], a[196:199], v[44:47], v[20:23]
    v_max3_f32 v200, v200, v3, v8
    v_max3_f32 v201, v201, v7, v12
    v_max3_f32 v200, v200, v9, v10
    v_exp_f32 v80, v80
    v_mfma_f32_16x16x32_bf16 v[16:19], a[200:203], v[48:51], v[16:19]
    s_waitcnt lgkmcnt(2)
    ds_read_b128 a[220:223], v235 offset:45056
    v_max3_f32 v201, v201, v13, v14
    v_cvt_pk_bf16_f32 v207, v78, v79
    v_mfma_f32_16x16x32_bf16 v[20:23], a[200:203], v[52:55], v[20:23]
    v_exp_f32 v81, v81
    v_accvgpr_write_b32 a6, v206
    v_exp_f32 v82, v82
    v_mfma_f32_16x16x32_bf16 v[16:19], a[204:207], v[56:59], v[16:19]
    s_waitcnt vmcnt(5)
    s_barrier
    ds_read_b128 a[160:163], v232 offset:49152
    v_cvt_pk_bf16_f32 v206, v80, v81
    v_exp_f32 v83, v83
    v_mfma_f32_16x16x32_bf16 v[20:23], a[204:207], v[60:63], v[20:23]
    v_accvgpr_write_b32 a7, v207
    v_exp_f32 v84, v84
    v_cvt_pk_bf16_f32 v207, v82, v83
    v_mfma_f32_16x16x32_bf16 v[24:27], a[208:211], v[32:35], v[208:211]
    s_waitcnt lgkmcnt(2)
    ds_read_b128 a[164:167], v233 offset:49152
    v_exp_f32 v85, v85
    v_accvgpr_write_b32 a8, v206
    v_mfma_f32_16x16x32_bf16 v[28:31], a[208:211], v[36:39], v[212:215]
    buffer_load_dwordx4 v238, s[28:31], s61 offen offset:2048 nt lds
    v_exp_f32 v86, v86
    v_cvt_pk_bf16_f32 v206, v84, v85
    v_mfma_f32_16x16x32_bf16 v[24:27], a[212:215], v[40:43], v[24:27]
    ds_read_b128 a[168:171], v234 offset:49152
    buffer_load_dwordx4 v239, s[28:31], s61 offen offset:3072 nt lds
    v_exp_f32 v87, v87
    v_mfma_f32_16x16x32_bf16 v[28:31], a[212:215], v[44:47], v[28:31]
    v_max3_f32 v200, v200, v11, v16
    v_max3_f32 v201, v201, v15, v20
    v_max3_f32 v200, v200, v17, v18
    v_accvgpr_write_b32 a9, v207
    v_mfma_f32_16x16x32_bf16 v[24:27], a[216:219], v[48:51], v[24:27]
    s_waitcnt lgkmcnt(2)
    ds_read_b128 a[172:175], v235 offset:49152
    v_max3_f32 v201, v201, v21, v22
    v_exp_f32 v88, v88
    v_cvt_pk_bf16_f32 v207, v86, v87
    v_mfma_f32_16x16x32_bf16 v[28:31], a[216:219], v[52:55], v[28:31]
    v_exp_f32 v89, v89
    v_accvgpr_write_b32 a12, v206
    v_exp_f32 v90, v90
    v_mfma_f32_16x16x32_bf16 v[24:27], a[220:223], v[56:59], v[24:27]
    ds_read_b128 a[176:179], v232 offset:53248
    v_cvt_pk_bf16_f32 v206, v88, v89
    v_exp_f32 v91, v91
    v_mfma_f32_16x16x32_bf16 v[28:31], a[220:223], v[60:63], v[28:31]
    v_accvgpr_write_b32 a13, v207
    v_exp_f32 v92, v92
    v_cvt_pk_bf16_f32 v207, v90, v91
    v_mfma_f32_16x16x32_bf16 v[64:67], a[160:163], v[32:35], v[208:211]
    s_waitcnt lgkmcnt(2)
    ds_read_b128 a[180:183], v233 offset:53248
    v_exp_f32 v93, v93
    v_accvgpr_write_b32 a10, v206
    v_mfma_f32_16x16x32_bf16 v[68:71], a[160:163], v[36:39], v[212:215]
    v_exp_f32 v94, v94
    v_cvt_pk_bf16_f32 v206, v92, v93
    v_mfma_f32_16x16x32_bf16 v[64:67], a[164:167], v[40:43], v[64:67]
    ds_read_b128 a[184:187], v234 offset:53248
    v_exp_f32 v95, v95
    v_accvgpr_write_b32 a11, v207
    v_cvt_pk_bf16_f32 v207, v94, v95
    v_mfma_f32_16x16x32_bf16 v[68:71], a[164:167], v[44:47], v[68:71]
    v_accvgpr_write_b32 a14, v206
    v_accvgpr_write_b32 a15, v207
    v_max3_f32 v200, v200, v19, v24
    v_mfma_f32_16x16x32_bf16 v[64:67], a[168:171], v[48:51], v[64:67]
    s_add_u32 m0, s60, 98304
    s_waitcnt lgkmcnt(2)
    ds_read_b128 a[188:191], v235 offset:53248
    v_max3_f32 v201, v201, v23, v28
    v_max3_f32 v200, v200, v25, v26
    v_mfma_f32_16x16x32_bf16 v[68:71], a[168:171], v[52:55], v[68:71]
    s_xor_b32 s61, s12, 131072
    v_max3_f32 v201, v201, v29, v30
    v_max3_f32 v202, v200, v201, v27
    v_max_f32 v202, v202, v31
    v_cmp_lt_f32 vcc, s64, v202
    s_cbranch_vccnz L_rare2
L_back2:
    v_mfma_f32_16x16x32_bf16 v[64:67], a[172:175], v[56:59], v[64:67]
    ds_read_b128 a[192:195], v232 offset:57344
    buffer_load_dwordx4 v236, s[28:31], s61 offen offset:0 nt lds
    v_exp_f32 v0, v0
    v_mfma_f32_16x16x32_bf16 v[68:71], a[172:175], v[60:63], v[68:71]
    v_exp_f32 v1, v1
    v_exp_f32 v2, v2
    v_cvt_pk_bf16_f32 v206, v0, v1
    v_mfma_f32_16x16x32_bf16 v[72:75], a[176:179], v[32:35], v[208:211]
    s_waitcnt lgkmcnt(2)
    ds_read_b128 a[196:199], v233 offset:57344
    v_exp_f32 v3, v3
    v_mfma_f32_16x16x32_bf16 v[76:79], a[176:179], v[36:39], v[212:215]
    v_exp_f32 v4, v4
    v_cvt_pk_bf16_f32 v207, v2, v3
    v_exp_f32 v5, v5
    v_mfma_f32_16x16x32_bf16 v[72:75], a[180:183], v[40:43], v[72:75]
    ds_read_b128 a[200:203], v234 offset:57344
    buffer_load_dwordx4 v237, s[28:31], s61 offen offset:1024 nt lds
    v_accvgpr_write_b32 a16, v206
    v_exp_f32 v6, v6
    v_mfma_f32_16x16x32_bf16 v[76:79], a[180:183], v[44:47], v[76:79]
    v_max3_f32 v200, v64, v65, v66
    v_max3_f32 v201, v68, v69, v70
    v_cvt_pk_bf16_f32 v206, v4, v5
    v_mfma_f32_16x16x32_bf16 v[72:75], a[184:187], v[48:51], v[72:75]
    s_waitcnt lgkmcnt(2)
    ds_read_b128 a[204:207], v235 offset:57344
    v_exp_f32 v7, v7
    v_accvgpr_write_b32 a17, v207
    v_mfma_f32_16x16x32_bf16 v[76:79], a[184:187], v[52:55], v[76:79]
    v_exp_f32 v8, v8
    v_cvt_pk_bf16_f32 v207, v6, v7
    v_exp_f32 v9, v9
    v_mfma_f32_16x16x32_bf16 v[72:75], a[188:191], v[56:59], v[72:75]
    ds_read_b128 a[208:211], v232 offset:61440
    v_accvgpr_write_b32 a20, v206
    v_exp_f32 v10, v10
    v_cvt_pk_bf16_f32 v206, v8, v9
    v_mfma_f32_16x16x32_bf16 v[76:79], a[188:191], v[60:63], v[76:79]
    v_exp_f32 v11, v11
    v_accvgpr_write_b32 a21, v207
    v_exp_f32 v12, v12
    v_mfma_f32_16x16x32_bf16 v[80:83], a[192:195], v[32:35], v[208:211]
    s_waitcnt lgkmcnt(2)
    ds_read_b128 a[212:215], v233 offset:61440
    v_cvt_pk_bf16_f32 v207, v10, v11
    v_exp_f32 v13, v13
    v_mfma_f32_16x16x32_bf16 v[84:87], a[192:195], v[36:39], v[212:215]
    v_accvgpr_write_b32 a18, v206
    v_exp_f32 v14, v14
    v_cvt_pk_bf16_f32 v206, v12, v13
    v_mfma_f32_16x16x32_bf16 v[80:83], a[196:199], v[40:43], v[80:83]
    ds_read_b128 a[216:219], v234 offset:61440
    v_exp_f32 v15, v15
    v_accvgpr_write_b32 a19, v207
    v_mfma_f32_16x16x32_bf16 v[84:87], a[196:199], v[44:47], v[84:87]
    v_max3_f32 v200, v200, v67, v72
    v_max3_f32 v201, v201, v71, v76
    v_max3_f32 v200, v200, v73, v74
    v_exp_f32 v16, v16
    v_mfma_f32_16x16x32_bf16 v[80:83], a[200:203], v[48:51], v[80:83]
    s_waitcnt lgkmcnt(2)
    ds_read_b128 a[220:223], v235 offset:61440
    v_max3_f32 v201, v201, v77, v78
    v_cvt_pk_bf16_f32 v207, v14, v15
    v_mfma_f32_16x16x32_bf16 v[84:87], a[200:203], v[52:55], v[84:87]
    v_exp_f32 v17, v17
    v_accvgpr_write_b32 a22, v206
    v_exp_f32 v18, v18
    v_mfma_f32_16x16x32_bf16 v[80:83], a[204:207], v[56:59], v[80:83]
    s_waitcnt vmcnt(5)
    s_barrier
    ds_read_b128 a[160:163], v192 offset:0
    v_cvt_pk_bf16_f32 v206, v16, v17
    v_exp_f32 v19, v19
    v_mfma_f32_16x16x32_bf16 v[84:87], a[204:207], v[60:63], v[84:87]
    v_accvgpr_write_b32 a23, v207
    v_exp_f32 v20, v20
    v_cvt_pk_bf16_f32 v207, v18, v19
    v_mfma_f32_16x16x32_bf16 v[88:91], a[208:211], v[32:35], v[208:211]
    s_waitcnt lgkmcnt(2)
    ds_read_b128 a[164:167], v193 offset:0
    v_exp_f32 v21, v21
    v_accvgpr_write_b32 a24, v206
    v_mfma_f32_16x16x32_bf16 v[92:95], a[208:211], v[36:39], v[212:215]
    buffer_load_dwordx4 v238, s[28:31], s61 offen offset:2048 nt lds
    v_exp_f32 v22, v22
    v_cvt_pk_bf16_f32 v206, v20, v21
    v_mfma_f32_16x16x32_bf16 v[88:91], a[212:215], v[40:43], v[88:91]
    ds_read_b128 a[168:171], v194 offset:0
    buffer_load_dwordx4 v239, s[28:31], s61 offen offset:3072 nt lds
    v_exp_f32 v23, v23
    v_mfma_f32_16x16x32_bf16 v[92:95], a[212:215], v[44:47], v[92:95]
    v_max3_f32 v200, v200, v75, v80
    v_max3_f32 v201, v201, v79, v84
    v_max3_f32 v200, v200, v81, v82
    v_accvgpr_write_b32 a25, v207
    v_mfma_f32_16x16x32_bf16 v[88:91], a[216:219], v[48:51], v[88:91]
    s_waitcnt lgkmcnt(2)
    ds_read_b128 a[172:175], v195 offset:0
    v_max3_f32 v201, v201, v85, v86
    v_exp_f32 v24, v24
    v_cvt_pk_bf16_f32 v207, v22, v23
    v_mfma_f32_16x16x32_bf16 v[92:95], a[216:219], v[52:55], v[92:95]
    v_exp_f32 v25, v25
    v_accvgpr_write_b32 a28, v206
    v_exp_f32 v26, v26
    v_mfma_f32_16x16x32_bf16 v[88:91], a[220:223], v[56:59], v[88:91]
    ds_read_b128 a[176:179], v192 offset:4096
    v_cvt_pk_bf16_f32 v206, v24, v25
    v_exp_f32 v27, v27
    v_mfma_f32_16x16x32_bf16 v[92:95], a[220:223], v[60:63], v[92:95]
    v_accvgpr_write_b32 a29, v207
    v_exp_f32 v28, v28
    v_cvt_pk_bf16_f32 v207, v26, v27
    v_mfma_f32_16x16x32_bf16 v[0:3], a[160:163], v[32:35], v[208:211]
    s_waitcnt lgkmcnt(2)
    ds_read_b128 a[180:183], v193 offset:4096
    v_exp_f32 v29, v29
    v_accvgpr_write_b32 a26, v206
    v_mfma_f32_16x16x32_bf16 v[4:7], a[160:163], v[36:39], v[212:215]
    v_exp_f32 v30, v30
    v_cvt_pk_bf16_f32 v206, v28, v29
    v_mfma_f32_16x16x32_bf16 v[0:3], a[164:167], v[40:43], v[0:3]
    ds_read_b128 a[184:187], v194 offset:4096
    v_exp_f32 v31, v31
    v_accvgpr_write_b32 a27, v207
    v_cvt_pk_bf16_f32 v207, v30, v31
    v_mfma_f32_16x16x32_bf16 v[4:7], a[164:167], v[44:47], v[4:7]
    v_accvgpr_write_b32 a30, v206
    v_accvgpr_write_b32 a31, v207
    v_max3_f32 v200, v200, v83, v88
    v_mfma_f32_16x16x32_bf16 v[0:3], a[168:171], v[48:51], v[0:3]
    s_add_u32 m0, s60, 114688
    s_waitcnt lgkmcnt(2)
    ds_read_b128 a[188:191], v195 offset:4096
    v_max3_f32 v201, v201, v87, v92
    v_max3_f32 v200, v200, v89, v90
    v_mfma_f32_16x16x32_bf16 v[4:7], a[168:171], v[52:55], v[4:7]
    s_xor_b32 s61, s12, 147456
    v_max3_f32 v201, v201, v93, v94
    v_max3_f32 v202, v200, v201, v91
    v_max_f32 v202, v202, v95
    v_cmp_lt_f32 vcc, s64, v202
    s_cbranch_vccnz L_rare3
L_back3:
    v_mfma_f32_16x16x32_bf16 v[0:3], a[172:175], v[56:59], v[0:3]
    ds_read_b128 a[192:195], v192 offset:8192
    buffer_load_dwordx4 v236, s[28:31], s61 offen offset:0 nt lds
    v_exp_f32 v64, v64
    v_mfma_f32_16x16x32_bf16 v[4:7], a[172:175], v[60:63], v[4:7]
    v_exp_f32 v65, v65
    v_exp_f32 v66, v66
    v_cvt_pk_bf16_f32 v206, v64, v65
    v_mfma_f32_16x16x32_bf16 v[8:11], a[176:179], v[32:35], v[208:211]
    s_waitcnt lgkmcnt(2)
    ds_read_b128 a[196:199], v193 offset:8192
    v_exp_f32 v67, v67
    v_mfma_f32_16x16x32_bf16 v[12:15], a[176:179], v[36:39], v[212:215]
    v_exp_f32 v68, v68
    v_cvt_pk_bf16_f32 v207, v66, v67
    v_exp_f32 v69, v69
    v_mfma_f32_16x16x32_bf16 v[8:11], a[180:183], v[40:43], v[8:11]
    ds_read_b128 a[200:203], v194 offset:8192
    buffer_load_dwordx4 v237, s[28:31], s61 offen offset:1024 nt lds
    v_accvgpr_write_b32 a32, v206
    v_exp_f32 v70, v70
    v_mfma_f32_16x16x32_bf16 v[12:15], a[180:183], v[44:47], v[12:15]
    v_max3_f32 v200, v0, v1, v2
    v_max3_f32 v201, v4, v5, v6
    v_cvt_pk_bf16_f32 v206, v68, v69
    v_mfma_f32_16x16x32_bf16 v[8:11], a[184:187], v[48:51], v[8:11]
    s_waitcnt lgkmcnt(2)
    ds_read_b128 a[204:207], v195 offset:8192
    v_exp_f32 v71, v71
    v_accvgpr_write_b32 a33, v207
    v_mfma_f32_16x16x32_bf16 v[12:15], a[184:187], v[52:55], v[12:15]
    v_exp_f32 v72, v72
    v_cvt_pk_bf16_f32 v207, v70, v71
    v_exp_f32 v73, v73
    v_mfma_f32_16x16x32_bf16 v[8:11], a[188:191], v[56:59], v[8:11]
    ds_read_b128 a[208:211], v192 offset:12288
    v_accvgpr_write_b32 a36, v206
    v_exp_f32 v74, v74
    v_cvt_pk_bf16_f32 v206, v72, v73
    v_mfma_f32_16x16x32_bf16 v[12:15], a[188:191], v[60:63], v[12:15]
    v_exp_f32 v75, v75
    v_accvgpr_write_b32 a37, v207
    v_exp_f32 v76, v76
    v_mfma_f32_16x16x32_bf16 v[16:19], a[192:195], v[32:35], v[208:211]
    s_waitcnt lgkmcnt(2)
    ds_read_b128 a[212:215], v193 offset:12288
    v_cvt_pk_bf16_f32 v207, v74, v75
    v_exp_f32 v77, v77
    v_mfma_f32_16x16x32_bf16 v[20:23], a[192:195], v[36:39], v[212:215]
    v_accvgpr_write_b32 a34, v206
    v_exp_f32 v78, v78
    v_cvt_pk_bf16_f32 v206, v76, v77
    v_mfma_f32_16x16x32_bf16 v[16:19], a[196:199], v[40:43], v[16:19]
    ds_read_b128 a[216:219], v194 offset:12288
    v_exp_f32 v79, v79
    v_accvgpr_write_b32 a35, v207
    v_mfma_f32_16x16x32_bf16 v[20:23], a[196:199], v[44:47], v[20:23]
    v_max3_f32 v200, v200, v3, v8
    v_max3_f32 v201, v201, v7, v12
    v_max3_f32 v200, v200, v9, v10
    v_exp_f32 v80, v80
    v_mfma_f32_16x16x32_bf16 v[16:19], a[200:203], v[48:51], v[16:19]
    s_waitcnt lgkmcnt(2)
    ds_read_b128 a[220:223], v195 offset:12288
    v_max3_f32 v201, v201, v13, v14
    v_cvt_pk_bf16_f32 v207, v78, v79
    v_mfma_f32_16x16x32_bf16 v[20:23], a[200:203], v[52:55], v[20:23]
    v_exp_f32 v81, v81
    v_accvgpr_write_b32 a38, v206
    v_exp_f32 v82, v82
    v_mfma_f32_16x16x32_bf16 v[16:19], a[204:207], v[56:59], v[16:19]
    s_waitcnt vmcnt(5)
    s_barrier
    ds_read_b128 a[160:163], v192 offset:49152
    v_cvt_pk_bf16_f32 v206, v80, v81
    v_exp_f32 v83, v83
    v_mfma_f32_16x16x32_bf16 v[20:23], a[204:207], v[60:63], v[20:23]
    v_accvgpr_write_b32 a39, v207
    v_exp_f32 v84, v84
    v_cvt_pk_bf16_f32 v207, v82, v83
    v_mfma_f32_16x16x32_bf16 v[24:27], a[208:211], v[32:35], v[208:211]
    s_waitcnt lgkmcnt(2)
    ds_read_b128 a[164:167], v193 offset:49152
    v_exp_f32 v85, v85
    v_accvgpr_write_b32 a40, v206
    v_mfma_f32_16x16x32_bf16 v[28:31], a[208:211], v[36:39], v[212:215]
    buffer_load_dwordx4 v238, s[28:31], s61 offen offset:2048 nt lds
    v_exp_f32 v86, v86
    v_cvt_pk_bf16_f32 v206, v84, v85
    v_mfma_f32_16x16x32_bf16 v[24:27], a[212:215], v[40:43], v[24:27]
    ds_read_b128 a[168:171], v194 offset:49152
    buffer_load_dwordx4 v239, s[28:31], s61 offen offset:3072 nt lds
    v_exp_f32 v87, v87
    v_mfma_f32_16x16x32_bf16 v[28:31], a[212:215], v[44:47], v[28:31]
    v_max3_f32 v200, v200, v11, v16
    v_max3_f32 v201, v201, v15, v20
    v_max3_f32 v200, v200, v17, v18
    v_accvgpr_write_b32 a41, v207
    v_mfma_f32_16x16x32_bf16 v[24:27], a[216:219], v[48:51], v[24:27]
    s_waitcnt lgkmcnt(2)
    ds_read_b128 a[172:175], v195 offset:49152
    v_max3_f32 v201, v201, v21, v22
    v_exp_f32 v88, v88
    v_cvt_pk_bf16_f32 v207, v86, v87
    v_mfma_f32_16x16x32_bf16 v[28:31], a[216:219], v[52:55], v[28:31]
    v_exp_f32 v89, v89
    v_accvgpr_write_b32 a44, v206
    v_exp_f32 v90, v90
    v_mfma_f32_16x16x32_bf16 v[24:27], a[220:223], v[56:59], v[24:27]
    ds_read_b128 a[176:179], v192 offset:53248
    v_cvt_pk_bf16_f32 v206, v88, v89
    v_exp_f32 v91, v91
    v_mfma_f32_16x16x32_bf16 v[28:31], a[220:223], v[60:63], v[28:31]
    v_accvgpr_write_b32 a45, v207
    v_exp_f32 v92, v92
    v_cvt_pk_bf16_f32 v207, v90, v91
    v_mfma_f32_16x16x32_bf16 v[64:67], a[160:163], v[32:35], v[208:211]
    s_waitcnt lgkmcnt(2)
    ds_read_b128 a[180:183], v193 offset:53248
    v_exp_f32 v93, v93
    v_accvgpr_write_b32 a42, v206
    v_mfma_f32_16x16x32_bf16 v[68:71], a[160:163], v[36:39], v[212:215]
    v_exp_f32 v94, v94
    v_cvt_pk_bf16_f32 v206, v92, v93
    v_mfma_f32_16x16x32_bf16 v[64:67], a[164:167], v[40:43], v[64:67]
    ds_read_b128 a[184:187], v194 offset:53248
    v_exp_f32 v95, v95
    v_accvgpr_write_b32 a43, v207
    v_cvt_pk_bf16_f32 v207, v94, v95
    v_mfma_f32_16x16x32_bf16 v[68:71], a[164:167], v[44:47], v[68:71]
    v_accvgpr_write_b32 a46, v206
    v_accvgpr_write_b32 a47, v207
    v_max3_f32 v200, v200, v19, v24
    v_mfma_f32_16x16x32_bf16 v[64:67], a[168:171], v[48:51], v[64:67]
    s_add_u32 m0, s60, 131072
    s_waitcnt lgkmcnt(2)
    ds_read_b128 a[188:191], v195 offset:53248
    v_max3_f32 v201, v201, v23, v28
    v_max3_f32 v200, v200, v25, v26
    v_mfma_f32_16x16x32_bf16 v[68:71], a[168:171], v[52:55], v[68:71]
    s_xor_b32 s61, s12, 163840
    v_max3_f32 v201, v201, v29, v30
    v_max3_f32 v202, v200, v201, v27
    v_max_f32 v202, v202, v31
    v_cmp_lt_f32 vcc, s64, v202
    s_cbranch_vccnz L_rare4
L_back4:
    v_mfma_f32_16x16x32_bf16 v[64:67], a[172:175], v[56:59], v[64:67]
    ds_read_b128 a[192:195], v192 offset:57344
    buffer_load_dwordx4 v236, s[28:31], s61 offen offset:0 nt lds
    v_exp_f32 v0, v0
    v_mfma_f32_16x16x32_bf16 v[68:71], a[172:175], v[60:63], v[68:71]
    v_exp_f32 v1, v1
    v_exp_f32 v2, v2
    v_cvt_pk_bf16_f32 v206, v0, v1
    v_mfma_f32_16x16x32_bf16 v[72:75], a[176:179], v[32:35], v[208:211]
    s_waitcnt lgkmcnt(2)
    ds_read_b128 a[196:199], v193 offset:57344
    v_exp_f32 v3, v3
    v_mfma_f32_16x16x32_bf16 v[76:79], a[176:179], v[36:39], v[212:215]
    v_exp_f32 v4, v4
    v_cvt_pk_bf16_f32 v207, v2, v3
    v_exp_f32 v5, v5
    v_mfma_f32_16x16x32_bf16 v[72:75], a[180:183], v[40:43], v[72:75]
    ds_read_b128 a[200:203], v194 offset:57344
    buffer_load_dwordx4 v237, s[28:31], s61 offen offset:1024 nt lds
    v_accvgpr_write_b32 a48, v206
    v_exp_f32 v6, v6
    v_mfma_f32_16x16x32_bf16 v[76:79], a[180:183], v[44:47], v[76:79]
    v_max3_f32 v200, v64, v65, v66
    v_max3_f32 v201, v68, v69, v70
    v_cvt_pk_bf16_f32 v206, v4, v5
    v_mfma_f32_16x16x32_bf16 v[72:75], a[184:187], v[48:51], v[72:75]
    s_waitcnt lgkmcnt(2)
    ds_read_b128 a[204:207], v195 offset:57344
    v_exp_f32 v7, v7
    v_accvgpr_write_b32 a49, v207
    v_mfma_f32_16x16x32_bf16 v[76:79], a[184:187], v[52:55], v[76:79]
    v_exp_f32 v8, v8
    v_cvt_pk_bf16_f32 v207, v6, v7
    v_exp_f32 v9, v9
    v_mfma_f32_16x16x32_bf16 v[72:75], a[188:191], v[56:59], v[72:75]
    ds_read_b128 a[208:211], v192 offset:61440
    v_accvgpr_write_b32 a52, v206
    v_exp_f32 v10, v10
    v_cvt_pk_bf16_f32 v206, v8, v9
    v_mfma_f32_16x16x32_bf16 v[76:79], a[188:191], v[60:63], v[76:79]
    v_exp_f32 v11, v11
    v_accvgpr_write_b32 a53, v207
    v_exp_f32 v12, v12
    v_mfma_f32_16x16x32_bf16 v[80:83], a[192:195], v[32:35], v[208:211]
    s_waitcnt lgkmcnt(2)
    ds_read_b128 a[212:215], v193 offset:61440
    v_cvt_pk_bf16_f32 v207, v10, v11
    v_exp_f32 v13, v13
    v_mfma_f32_16x16x32_bf16 v[84:87], a[192:195], v[36:39], v[212:215]
    v_accvgpr_write_b32 a50, v206
    v_exp_f32 v14, v14
    v_cvt_pk_bf16_f32 v206, v12, v13
    v_mfma_f32_16x16x32_bf16 v[80:83], a[196:199], v[40:43], v[80:83]
    ds_read_b128 a[216:219], v194 offset:61440
    v_exp_f32 v15, v15
    v_accvgpr_write_b32 a51, v207
    v_mfma_f32_16x16x32_bf16 v[84:87], a[196:199], v[44:47], v[84:87]
    v_max3_f32 v200, v200, v67, v72
    v_max3_f32 v201, v201, v71, v76
    v_max3_f32 v200, v200, v73, v74
    v_exp_f32 v16, v16
    v_mfma_f32_16x16x32_bf16 v[80:83], a[200:203], v[48:51], v[80:83]
    s_waitcnt lgkmcnt(2)
    ds_read_b128 a[220:223], v195 offset:61440
    v_max3_f32 v201, v201, v77, v78
    v_cvt_pk_bf16_f32 v207, v14, v15
    v_mfma_f32_16x16x32_bf16 v[84:87], a[200:203], v[52:55], v[84:87]
    v_exp_f32 v17, v17
    v_accvgpr_write_b32 a54, v206
    v_exp_f32 v18, v18
    v_mfma_f32_16x16x32_bf16 v[80:83], a[204:207], v[56:59], v[80:83]
    s_waitcnt vmcnt(5)
    s_barrier
    ds_read_b128 a[160:163], v192 offset:16384
    v_cvt_pk_bf16_f32 v206, v16, v17
    v_exp_f32 v19, v19
    v_mfma_f32_16x16x32_bf16 v[84:87], a[204:207], v[60:63], v[84:87]
    v_accvgpr_write_b32 a55, v207
    v_exp_f32 v20, v20
    v_cvt_pk_bf16_f32 v207, v18, v19
    v_mfma_f32_16x16x32_bf16 v[88:91], a[208:211], v[32:35], v[208:211]
    s_waitcnt lgkmcnt(2)
    ds_read_b128 a[164:167], v193 offset:16384
    v_exp_f32 v21, v21
    v_accvgpr_write_b32 a56, v206
    v_mfma_f32_16x16x32_bf16 v[92:95], a[208:211], v[36:39], v[212:215]
    buffer_load_dwordx4 v238, s[28:31], s61 offen offset:2048 nt lds
    v_exp_f32 v22, v22
    v_cvt_pk_bf16_f32 v206, v20, v21
    v_mfma_f32_16x16x32_bf16 v[88:91], a[212:215], v[40:43], v[88:91]
    ds_read_b128 a[168:171], v194 offset:16384
    buffer_load_dwordx4 v239, s[28:31], s61 offen offset:3072 nt lds
    v_exp_f32 v23, v23
    v_mfma_f32_16x16x32_bf16 v[92:95], a[212:215], v[44:47], v[92:95]
    v_max3_f32 v200, v200, v75, v80
    v_max3_f32 v201, v201, v79, v84
    v_max3_f32 v200, v200, v81, v82
    v_accvgpr_write_b32 a57, v207
    v_mfma_f32_16x16x32_bf16 v[88:91], a[216:219], v[48:51], v[88:91]
    s_waitcnt lgkmcnt(2)
    ds_read_b128 a[172:175], v195 offset:16384
    v_max3_f32 v201, v201, v85, v86
    v_exp_f32 v24, v24
    v_cvt_pk_bf16_f32 v207, v22, v23
    v_mfma_f32_16x16x32_bf16 v[92:95], a[216:219], v[52:55], v[92:95]
    v_exp_f32 v25, v25
    v_accvgpr_write_b32 a60, v206
    v_exp_f32 v26, v26
    v_mfma_f32_16x16x32_bf16 v[88:91], a[220:223], v[56:59], v[88:91]
    ds_read_b128 a[176:179], v192 offset:20480
    v_cvt_pk_bf16_f32 v206, v24, v25
    v_exp_f32 v27, v27
    v_mfma_f32_16x16x32_bf16 v[92:95], a[220:223], v[60:63], v[92:95]
    v_accvgpr_write_b32 a61, v207
    v_exp_f32 v28, v28
    v_cvt_pk_bf16_f32 v207, v26, v27
    v_mfma_f32_16x16x32_bf16 v[0:3], a[160:163], v[32:35], v[208:211]
    s_waitcnt lgkmcnt(2)
    ds_read_b128 a[180:183], v193 offset:20480
    v_exp_f32 v29, v29
    v_accvgpr_write_b32 a58, v206
    v_mfma_f32_16x16x32_bf16 v[4:7], a[160:163], v[36:39], v[212:215]
    v_exp_f32 v30, v30
    v_cvt_pk_bf16_f32 v206, v28, v29
    v_mfma_f32_16x16x32_bf16 v[0:3], a[164:167], v[40:43], v[0:3]
    ds_read_b128 a[184:187], v194 offset:20480
    v_exp_f32 v31, v31
    v_accvgpr_write_b32 a59, v207
    v_cvt_pk_bf16_f32 v207, v30, v31
    v_mfma_f32_16x16x32_bf16 v[4:7], a[164:167], v[44:47], v[4:7]
    v_accvgpr_write_b32 a62, v206
    v_accvgpr_write_b32 a63, v207
    v_max3_f32 v200, v200, v83, v88
    v_mfma_f32_16x16x32_bf16 v[0:3], a[168:171], v[48:51], v[0:3]
    s_add_u32 m0, s60, 147456
    s_waitcnt lgkmcnt(2)
    ds_read_b128 a[188:191], v195 offset:20480
    v_max3_f32 v201, v201, v87, v92
    v_max3_f32 v200, v200, v89, v90
    v_mfma_f32_16x16x32_bf16 v[4:7], a[168:171], v[52:55], v[4:7]
    s_xor_b32 s61, s12, 180224
    v_max3_f32 v201, v201, v93, v94
    v_max3_f32 v202, v200, v201, v91
    v_max_f32 v202, v202, v95
    v_cmp_lt_f32 vcc, s64, v202
    s_cbranch_vccnz L_rare5
L_back5:
    v_mfma_f32_16x16x32_bf16 v[0:3], a[172:175], v[56:59], v[0:3]
    ds_read_b128 a[192:195], v192 offset:24576
    buffer_load_dwordx4 v236, s[28:31], s61 offen offset:0 nt lds
    v_exp_f32 v64, v64
    v_mfma_f32_16x16x32_bf16 v[4:7], a[172:175], v[60:63], v[4:7]
    v_exp_f32 v65, v65
    v_exp_f32 v66, v66
    v_cvt_pk_bf16_f32 v206, v64, v65
    v_mfma_f32_16x16x32_bf16 v[8:11], a[176:179], v[32:35], v[208:211]
    s_waitcnt lgkmcnt(2)
    ds_read_b128 a[196:199], v193 offset:24576
    v_exp_f32 v67, v67
    v_mfma_f32_16x16x32_bf16 v[12:15], a[176:179], v[36:39], v[212:215]
    v_exp_f32 v68, v68
    v_cvt_pk_bf16_f32 v207, v66, v67
    v_exp_f32 v69, v69
    v_mfma_f32_16x16x32_bf16 v[8:11], a[180:183], v[40:43], v[8:11]
    ds_read_b128 a[200:203], v194 offset:24576
    buffer_load_dwordx4 v237, s[28:31], s61 offen offset:1024 nt lds
    v_accvgpr_write_b32 a64, v206
    v_exp_f32 v70, v70
    v_mfma_f32_16x16x32_bf16 v[12:15], a[180:183], v[44:47], v[12:15]
    v_max3_f32 v200, v0, v1, v2
    v_max3_f32 v201, v4, v5, v6
    v_cvt_pk_bf16_f32 v206, v68, v69
    v_mfma_f32_16x16x32_bf16 v[8:11], a[184:187], v[48:51], v[8:11]
    s_waitcnt lgkmcnt(2)
    ds_read_b128 a[204:207], v195 offset:24576
    v_exp_f32 v71, v71
    v_accvgpr_write_b32 a65, v207
    v_mfma_f32_16x16x32_bf16 v[12:15], a[184:187], v[52:55], v[12:15]
    v_exp_f32 v72, v72
    v_cvt_pk_bf16_f32 v207, v70, v71
    v_exp_f32 v73, v73
    v_mfma_f32_16x16x32_bf16 v[8:11], a[188:191], v[56:59], v[8:11]
    ds_read_b128 a[208:211], v192 offset:28672
    v_accvgpr_write_b32 a68, v206
    v_exp_f32 v74, v74
    v_cvt_pk_bf16_f32 v206, v72, v73
    v_mfma_f32_16x16x32_bf16 v[12:15], a[188:191], v[60:63], v[12:15]
    v_exp_f32 v75, v75
    v_accvgpr_write_b32 a69, v207
    v_exp_f32 v76, v76
    v_mfma_f32_16x16x32_bf16 v[16:19], a[192:195], v[32:35], v[208:211]
    s_waitcnt lgkmcnt(2)
    ds_read_b128 a[212:215], v193 offset:28672
    v_cvt_pk_bf16_f32 v207, v74, v75
    v_exp_f32 v77, v77
    v_mfma_f32_16x16x32_bf16 v[20:23], a[192:195], v[36:39], v[212:215]
    v_accvgpr_write_b32 a66, v206
    v_exp_f32 v78, v78
    v_cvt_pk_bf16_f32 v206, v76, v77
    v_mfma_f32_16x16x32_bf16 v[16:19], a[196:199], v[40:43], v[16:19]
    ds_read_b128 a[216:219], v194 offset:28672
    v_exp_f32 v79, v79
    v_accvgpr_write_b32 a67, v207
    v_mfma_f32_16x16x32_bf16 v[20:23], a[196:199], v[44:47], v[20:23]
    v_max3_f32 v200, v200, v3, v8
    v_max3_f32 v201, v201, v7, v12
    v_max3_f32 v200, v200, v9, v10
    v_exp_f32 v80, v80
    v_mfma_f32_16x16x32_bf16 v[16:19], a[200:203], v[48:51], v[16:19]
    s_waitcnt lgkmcnt(2)
    ds_read_b128 a[220:223], v195 offset:28672
    v_max3_f32 v201, v201, v13, v14
    v_cvt_pk_bf16_f32 v207, v78, v79
    v_mfma_f32_16x16x32_bf16 v[20:23], a[200:203], v[52:55], v[20:23]
    v_exp_f32 v81, v81
    v_accvgpr_write_b32 a70, v206
    v_exp_f32 v82, v82
    v_mfma_f32_16x16x32_bf16 v[16:19], a[204:207], v[56:59], v[16:19]
    s_waitcnt vmcnt(5)
    s_barrier
    ds_read_b128 a[160:163], v192 offset:32768
    v_cvt_pk_bf16_f32 v206, v80, v81
    v_exp_f32 v83, v83
    v_mfma_f32_16x16x32_bf16 v[20:23], a[204:207], v[60:63], v[20:23]
    v_accvgpr_write_b32 a71, v207
    v_exp_f32 v84, v84
    v_cvt_pk_bf16_f32 v207, v82, v83
    v_mfma_f32_16x16x32_bf16 v[24:27], a[208:211], v[32:35], v[208:211]
    s_waitcnt lgkmcnt(2)
    ds_read_b128 a[164:167], v193 offset:32768
    v_exp_f32 v85, v85
    v_accvgpr_write_b32 a72, v206
    v_mfma_f32_16x16x32_bf16 v[28:31], a[208:211], v[36:39], v[212:215]
    buffer_load_dwordx4 v238, s[28:31], s61 offen offset:2048 nt lds
    v_exp_f32 v86, v86
    v_cvt_pk_bf16_f32 v206, v84, v85
    v_mfma_f32_16x16x32_bf16 v[24:27], a[212:215], v[40:43], v[24:27]
    ds_read_b128 a[168:171], v194 offset:32768
    buffer_load_dwordx4 v239, s[28:31], s61 offen offset:3072 nt lds
    v_exp_f32 v87, v87
    v_mfma_f32_16x16x32_bf16 v[28:31], a[212:215], v[44:47], v[28:31]
    v_max3_f32 v200, v200, v11, v16
    v_max3_f32 v201, v201, v15, v20
    v_max3_f32 v200, v200, v17, v18
    v_accvgpr_write_b32 a73, v207
    v_mfma_f32_16x16x32_bf16 v[24:27], a[216:219], v[48:51], v[24:27]
    s_waitcnt lgkmcnt(2)
    ds_read_b128 a[172:175], v195 offset:32768
    v_max3_f32 v201, v201, v21, v22
    v_exp_f32 v88, v88
    v_cvt_pk_bf16_f32 v207, v86, v87
    v_mfma_f32_16x16x32_bf16 v[28:31], a[216:219], v[52:55], v[28:31]
    v_exp_f32 v89, v89
    v_accvgpr_write_b32 a76, v206
    v_exp_f32 v90, v90
    v_mfma_f32_16x16x32_bf16 v[24:27], a[220:223], v[56:59], v[24:27]
    ds_read_b128 a[176:179], v192 offset:36864
    v_cvt_pk_bf16_f32 v206, v88, v89
    v_exp_f32 v91, v91
    v_mfma_f32_16x16x32_bf16 v[28:31], a[220:223], v[60:63], v[28:31]
    v_accvgpr_write_b32 a77, v207
    v_exp_f32 v92, v92
    v_cvt_pk_bf16_f32 v207, v90, v91
    v_mfma_f32_16x16x32_bf16 v[64:67], a[160:163], v[32:35], v[208:211]
    s_waitcnt lgkmcnt(2)
    ds_read_b128 a[180:183], v193 offset:36864
    v_exp_f32 v93, v93
    v_accvgpr_write_b32 a74, v206
    v_mfma_f32_16x16x32_bf16 v[68:71], a[160:163], v[36:39], v[212:215]
    v_exp_f32 v94, v94
    v_cvt_pk_bf16_f32 v206, v92, v93
    v_mfma_f32_16x16x32_bf16 v[64:67], a[164:167], v[40:43], v[64:67]
    ds_read_b128 a[184:187], v194 offset:36864
    v_exp_f32 v95, v95
    v_accvgpr_write_b32 a75, v207
    v_cvt_pk_bf16_f32 v207, v94, v95
    v_mfma_f32_16x16x32_bf16 v[68:71], a[164:167], v[44:47], v[68:71]
    v_accvgpr_write_b32 a78, v206
    v_accvgpr_write_b32 a79, v207
    v_max3_f32 v200, v200, v19, v24
    v_mfma_f32_16x16x32_bf16 v[64:67], a[168:171], v[48:51], v[64:67]
    s_add_u32 m0, s60, 32768
    s_waitcnt lgkmcnt(2)
    ds_read_b128 a[188:191], v195 offset:36864
    v_max3_f32 v201, v201, v23, v28
    v_max3_f32 v200, v200, v25, v26
    v_mfma_f32_16x16x32_bf16 v[68:71], a[168:171], v[52:55], v[68:71]
    s_xor_b32 s61, s12, 196608
    v_max3_f32 v201, v201, v29, v30
    v_max3_f32 v202, v200, v201, v27
    v_max_f32 v202, v202, v31
    v_cmp_lt_f32 vcc, s64, v202
    s_cbranch_vccnz L_rare6
L_back6:
    v_mfma_f32_16x16x32_bf16 v[64:67], a[172:175], v[56:59], v[64:67]
    ds_read_b128 a[192:195], v192 offset:40960
    buffer_load_dwordx4 v236, s[28:31], s61 offen offset:0 nt lds
    v_exp_f32 v0, v0
    v_mfma_f32_16x16x32_bf16 v[68:71], a[172:175], v[60:63], v[68:71]
    v_exp_f32 v1, v1
    v_exp_f32 v2, v2
    v_cvt_pk_bf16_f32 v206, v0, v1
    v_mfma_f32_16x16x32_bf16 v[72:75], a[176:179], v[32:35], v[208:211]
    s_waitcnt lgkmcnt(2)
    ds_read_b128 a[196:199], v193 offset:40960
    v_exp_f32 v3, v3
    v_mfma_f32_16x16x32_bf16 v[76:79], a[176:179], v[36:39], v[212:215]
    v_exp_f32 v4, v4
    v_cvt_pk_bf16_f32 v207, v2, v3
    v_exp_f32 v5, v5
    v_mfma_f32_16x16x32_bf16 v[72:75], a[180:183], v[40:43], v[72:75]
    ds_read_b128 a[200:203], v194 offset:40960
    buffer_load_dwordx4 v237, s[28:31], s61 offen offset:1024 nt lds
    v_accvgpr_write_b32 a80, v206
    v_exp_f32 v6, v6
    v_mfma_f32_16x16x32_bf16 v[76:79], a[180:183], v[44:47], v[76:79]
    v_max3_f32 v200, v64, v65, v66
    v_max3_f32 v201, v68, v69, v70
    v_cvt_pk_bf16_f32 v206, v4, v5
    v_mfma_f32_16x16x32_bf16 v[72:75], a[184:187], v[48:51], v[72:75]
    s_waitcnt lgkmcnt(2)
    ds_read_b128 a[204:207], v195 offset:40960
    v_exp_f32 v7, v7
    v_accvgpr_write_b32 a81, v207
    v_mfma_f32_16x16x32_bf16 v[76:79], a[184:187], v[52:55], v[76:79]
    v_exp_f32 v8, v8
    v_cvt_pk_bf16_f32 v207, v6, v7
    v_exp_f32 v9, v9
    v_mfma_f32_16x16x32_bf16 v[72:75], a[188:191], v[56:59], v[72:75]
    ds_read_b128 a[208:211], v192 offset:45056
    v_accvgpr_write_b32 a84, v206
    v_exp_f32 v10, v10
    v_cvt_pk_bf16_f32 v206, v8, v9
    v_mfma_f32_16x16x32_bf16 v[76:79], a[188:191], v[60:63], v[76:79]
    v_exp_f32 v11, v11
    v_accvgpr_write_b32 a85, v207
    v_exp_f32 v12, v12
    v_mfma_f32_16x16x32_bf16 v[80:83], a[192:195], v[32:35], v[208:211]
    s_waitcnt lgkmcnt(2)
    ds_read_b128 a[212:215], v193 offset:45056
    v_cvt_pk_bf16_f32 v207, v10, v11
    v_exp_f32 v13, v13
    v_mfma_f32_16x16x32_bf16 v[84:87], a[192:195], v[36:39], v[212:215]
    v_accvgpr_write_b32 a82, v206
    v_exp_f32 v14, v14
    v_cvt_pk_bf16_f32 v206, v12, v13
    v_mfma_f32_16x16x32_bf16 v[80:83], a[196:199], v[40:43], v[80:83]
    ds_read_b128 a[216:219], v194 offset:45056
    v_exp_f32 v15, v15
    v_accvgpr_write_b32 a83, v207
    v_mfma_f32_16x16x32_bf16 v[84:87], a[196:199], v[44:47], v[84:87]
    v_max3_f32 v200, v200, v67, v72
    v_max3_f32 v201, v201, v71, v76
    v_max3_f32 v200, v200, v73, v74
    v_exp_f32 v16, v16
    v_mfma_f32_16x16x32_bf16 v[80:83], a[200:203], v[48:51], v[80:83]
    s_waitcnt lgkmcnt(2)
    ds_read_b128 a[220:223], v195 offset:45056
    v_max3_f32 v201, v201, v77, v78
    v_cvt_pk_bf16_f32 v207, v14, v15
    v_mfma_f32_16x16x32_bf16 v[84:87], a[200:203], v[52:55], v[84:87]
    v_exp_f32 v17, v17
    v_accvgpr_write_b32 a86, v206
    v_exp_f32 v18, v18
    v_mfma_f32_16x16x32_bf16 v[80:83], a[204:207], v[56:59], v[80:83]
    s_waitcnt vmcnt(5)
    s_barrier
    ds_read_b128 a[160:163], v232 offset:0
    v_cvt_pk_bf16_f32 v206, v16, v17
    v_exp_f32 v19, v19
    v_mfma_f32_16x16x32_bf16 v[84:87], a[204:207], v[60:63], v[84:87]
    v_accvgpr_write_b32 a87, v207
    v_exp_f32 v20, v20
    v_cvt_pk_bf16_f32 v207, v18, v19
    v_mfma_f32_16x16x32_bf16 v[88:91], a[208:211], v[32:35], v[208:211]
    s_waitcnt lgkmcnt(2)
    ds_read_b128 a[164:167], v233 offset:0
    v_exp_f32 v21, v21
    v_accvgpr_write_b32 a88, v206
    v_mfma_f32_16x16x32_bf16 v[92:95], a[208:211], v[36:39], v[212:215]
    buffer_load_dwordx4 v238, s[28:31], s61 offen offset:2048 nt lds
    v_exp_f32 v22, v22
    v_cvt_pk_bf16_f32 v206, v20, v21
    v_mfma_f32_16x16x32_bf16 v[88:91], a[212:215], v[40:43], v[88:91]
    ds_read_b128 a[168:171], v234 offset:0
    buffer_load_dwordx4 v239, s[28:31], s61 offen offset:3072 nt lds
    v_exp_f32 v23, v23
    v_mfma_f32_16x16x32_bf16 v[92:95], a[212:215], v[44:47], v[92:95]
    v_max3_f32 v200, v200, v75, v80
    v_max3_f32 v201, v201, v79, v84
    v_max3_f32 v200, v200, v81, v82
    v_accvgpr_write_b32 a89, v207
    v_mfma_f32_16x16x32_bf16 v[88:91], a[216:219], v[48:51], v[88:91]
    s_waitcnt lgkmcnt(2)
    ds_read_b128 a[172:175], v235 offset:0
    v_max3_f32 v201, v201, v85, v86
    v_exp_f32 v24, v24
    v_cvt_pk_bf16_f32 v207, v22, v23
    v_mfma_f32_16x16x32_bf16 v[92:95], a[216:219], v[52:55], v[92:95]
    v_exp_f32 v25, v25
    v_accvgpr_write_b32 a92, v206
    v_exp_f32 v26, v26
    v_mfma_f32_16x16x32_bf16 v[88:91], a[220:223], v[56:59], v[88:91]
    ds_read_b128 a[176:179], v232 offset:4096
    v_cvt_pk_bf16_f32 v206, v24, v25
    v_exp_f32 v27, v27
    v_mfma_f32_16x16x32_bf16 v[92:95], a[220:223], v[60:63], v[92:95]
    v_accvgpr_write_b32 a93, v207
    v_exp_f32 v28, v28
    v_cvt_pk_bf16_f32 v207, v26, v27
    v_mfma_f32_16x16x32_bf16 v[0:3], a[160:163], v[32:35], v[208:211]
    s_waitcnt lgkmcnt(2)
    ds_read_b128 a[180:183], v233 offset:4096
    v_exp_f32 v29, v29
    v_accvgpr_write_b32 a90, v206
    v_mfma_f32_16x16x32_bf16 v[4:7], a[160:163], v[36:39], v[212:215]
    v_exp_f32 v30, v30
    v_cvt_pk_bf16_f32 v206, v28, v29
    v_mfma_f32_16x16x32_bf16 v[0:3], a[164:167], v[40:43], v[0:3]
    ds_read_b128 a[184:187], v234 offset:4096
    v_exp_f32 v31, v31
    v_accvgpr_write_b32 a91, v207
    v_cvt_pk_bf16_f32 v207, v30, v31
    v_mfma_f32_16x16x32_bf16 v[4:7], a[164:167], v[44:47], v[4:7]
    v_accvgpr_write_b32 a94, v206
    v_accvgpr_write_b32 a95, v207
    v_max3_f32 v200, v200, v83, v88
    v_mfma_f32_16x16x32_bf16 v[0:3], a[168:171], v[48:51], v[0:3]
    s_add_u32 m0, s60, 81920
    s_waitcnt lgkmcnt(2)
    ds_read_b128 a[188:191], v235 offset:4096
    v_max3_f32 v201, v201, v87, v92
    v_max3_f32 v200, v200, v89, v90
    v_mfma_f32_16x16x32_bf16 v[4:7], a[168:171], v[52:55], v[4:7]
    s_xor_b32 s61, s12, 212992
    v_max3_f32 v201, v201, v93, v94
    v_max3_f32 v202, v200, v201, v91
    v_max_f32 v202, v202, v95
    v_cmp_lt_f32 vcc, s64, v202
    s_cbranch_vccnz L_rare7
L_back7:
    v_mfma_f32_16x16x32_bf16 v[0:3], a[172:175], v[56:59], v[0:3]
    ds_read_b128 a[192:195], v232 offset:8192
    buffer_load_dwordx4 v236, s[28:31], s61 offen offset:0 nt lds
    v_exp_f32 v64, v64
    v_mfma_f32_16x16x32_bf16 v[4:7], a[172:175], v[60:63], v[4:7]
    v_exp_f32 v65, v65
    v_exp_f32 v66, v66
    v_cvt_pk_bf16_f32 v206, v64, v65
    v_mfma_f32_16x16x32_bf16 v[8:11], a[176:179], v[32:35], v[208:211]
    s_waitcnt lgkmcnt(2)
    ds_read_b128 a[196:199], v233 offset:8192
    v_exp_f32 v67, v67
    v_mfma_f32_16x16x32_bf16 v[12:15], a[176:179], v[36:39], v[212:215]
    v_exp_f32 v68, v68
    v_cvt_pk_bf16_f32 v207, v66, v67
    v_exp_f32 v69, v69
    v_mfma_f32_16x16x32_bf16 v[8:11], a[180:183], v[40:43], v[8:11]
    ds_read_b128 a[200:203], v234 offset:8192
    buffer_load_dwordx4 v237, s[28:31], s61 offen offset:1024 nt lds
    v_accvgpr_write_b32 a96, v206
    v_exp_f32 v70, v70
    v_mfma_f32_16x16x32_bf16 v[12:15], a[180:183], v[44:47], v[12:15]
    v_max3_f32 v200, v0, v1, v2
    v_max3_f32 v201, v4, v5, v6
    v_cvt_pk_bf16_f32 v206, v68, v69
    v_mfma_f32_16x16x32_bf16 v[8:11], a[184:187], v[48:51], v[8:11]
    s_waitcnt lgkmcnt(2)
    ds_read_b128 a[204:207], v235 offset:8192
    v_exp_f32 v71, v71
    v_accvgpr_write_b32 a97, v207
    v_mfma_f32_16x16x32_bf16 v[12:15], a[184:187], v[52:55], v[12:15]
    v_exp_f32 v72, v72
    v_cvt_pk_bf16_f32 v207, v70, v71
    v_exp_f32 v73, v73
    v_mfma_f32_16x16x32_bf16 v[8:11], a[188:191], v[56:59], v[8:11]
    ds_read_b128 a[208:211], v232 offset:12288
    v_accvgpr_write_b32 a100, v206
    v_exp_f32 v74, v74
    v_cvt_pk_bf16_f32 v206, v72, v73
    v_mfma_f32_16x16x32_bf16 v[12:15], a[188:191], v[60:63], v[12:15]
    v_exp_f32 v75, v75
    v_accvgpr_write_b32 a101, v207
    v_exp_f32 v76, v76
    v_mfma_f32_16x16x32_bf16 v[16:19], a[192:195], v[32:35], v[208:211]
    s_waitcnt lgkmcnt(2)
    ds_read_b128 a[212:215], v233 offset:12288
    v_cvt_pk_bf16_f32 v207, v74, v75
    v_exp_f32 v77, v77
    v_mfma_f32_16x16x32_bf16 v[20:23], a[192:195], v[36:39], v[212:215]
    v_accvgpr_write_b32 a98, v206
    v_exp_f32 v78, v78
    v_cvt_pk_bf16_f32 v206, v76, v77
    v_mfma_f32_16x16x32_bf16 v[16:19], a[196:199], v[40:43], v[16:19]
    ds_read_b128 a[216:219], v234 offset:12288
    v_exp_f32 v79, v79
    v_accvgpr_write_b32 a99, v207
    v_mfma_f32_16x16x32_bf16 v[20:23], a[196:199], v[44:47], v[20:23]
    v_max3_f32 v200, v200, v3, v8
    v_max3_f32 v201, v201, v7, v12
    v_max3_f32 v200, v200, v9, v10
    v_exp_f32 v80, v80
    v_mfma_f32_16x16x32_bf16 v[16:19], a[200:203], v[48:51], v[16:19]
    s_waitcnt lgkmcnt(2)
    ds_read_b128 a[220:223], v235 offset:12288
    v_max3_f32 v201, v201, v13, v14
    v_cvt_pk_bf16_f32 v207, v78, v79
    v_mfma_f32_16x16x32_bf16 v[20:23], a[200:203], v[52:55], v[20:23]
    v_exp_f32 v81, v81
    v_accvgpr_write_b32 a102, v206
    v_exp_f32 v82, v82
    v_mfma_f32_16x16x32_bf16 v[16:19], a[204:207], v[56:59], v[16:19]
    s_waitcnt vmcnt(5)
    s_barrier
    ds_read_b128 a[160:163], v232 offset:16384
    v_cvt_pk_bf16_f32 v206, v80, v81
    v_exp_f32 v83, v83
    v_mfma_f32_16x16x32_bf16 v[20:23], a[204:207], v[60:63], v[20:23]
    v_accvgpr_write_b32 a103, v207
    v_exp_f32 v84, v84
    v_cvt_pk_bf16_f32 v207, v82, v83
    v_mfma_f32_16x16x32_bf16 v[24:27], a[208:211], v[32:35], v[208:211]
    s_waitcnt lgkmcnt(2)
    ds_read_b128 a[164:167], v233 offset:16384
    v_exp_f32 v85, v85
    v_accvgpr_write_b32 a104, v206
    v_mfma_f32_16x16x32_bf16 v[28:31], a[208:211], v[36:39], v[212:215]
    buffer_load_dwordx4 v238, s[28:31], s61 offen offset:2048 nt lds
    v_exp_f32 v86, v86
    v_cvt_pk_bf16_f32 v206, v84, v85
    v_mfma_f32_16x16x32_bf16 v[24:27], a[212:215], v[40:43], v[24:27]
    ds_read_b128 a[168:171], v234 offset:16384
    buffer_load_dwordx4 v239, s[28:31], s61 offen offset:3072 nt lds
    v_exp_f32 v87, v87
    v_mfma_f32_16x16x32_bf16 v[28:31], a[212:215], v[44:47], v[28:31]
    v_max3_f32 v200, v200, v11, v16
    v_max3_f32 v201, v201, v15, v20
    v_max3_f32 v200, v200, v17, v18
    v_accvgpr_write_b32 a105, v207
    v_mfma_f32_16x16x32_bf16 v[24:27], a[216:219], v[48:51], v[24:27]
    s_waitcnt lgkmcnt(2)
    ds_read_b128 a[172:175], v235 offset:16384
    v_max3_f32 v201, v201, v21, v22
    v_exp_f32 v88, v88
    v_cvt_pk_bf16_f32 v207, v86, v87
    v_mfma_f32_16x16x32_bf16 v[28:31], a[216:219], v[52:55], v[28:31]
    v_exp_f32 v89, v89
    v_accvgpr_write_b32 a108, v206
    v_exp_f32 v90, v90
    v_mfma_f32_16x16x32_bf16 v[24:27], a[220:223], v[56:59], v[24:27]
    ds_read_b128 a[176:179], v232 offset:20480
    v_cvt_pk_bf16_f32 v206, v88, v89
    v_exp_f32 v91, v91
    v_mfma_f32_16x16x32_bf16 v[28:31], a[220:223], v[60:63], v[28:31]
    v_accvgpr_write_b32 a109, v207
    v_exp_f32 v92, v92
    v_cvt_pk_bf16_f32 v207, v90, v91
    v_mfma_f32_16x16x32_bf16 v[64:67], a[160:163], v[32:35], v[208:211]
    s_waitcnt lgkmcnt(2)
    ds_read_b128 a[180:183], v233 offset:20480
    v_exp_f32 v93, v93
    v_accvgpr_write_b32 a106, v206
    v_mfma_f32_16x16x32_bf16 v[68:71], a[160:163], v[36:39], v[212:215]
    v_exp_f32 v94, v94
    v_cvt_pk_bf16_f32 v206, v92, v93
    v_mfma_f32_16x16x32_bf16 v[64:67], a[164:167], v[40:43], v[64:67]
    ds_read_b128 a[184:187], v234 offset:20480
    v_exp_f32 v95, v95
    v_accvgpr_write_b32 a107, v207
    v_cvt_pk_bf16_f32 v207, v94, v95
    v_mfma_f32_16x16x32_bf16 v[68:71], a[164:167], v[44:47], v[68:71]
    v_accvgpr_write_b32 a110, v206
    v_accvgpr_write_b32 a111, v207
    v_max3_f32 v200, v200, v19, v24
    v_mfma_f32_16x16x32_bf16 v[64:67], a[168:171], v[48:51], v[64:67]
    s_add_u32 m0, s60, 49152
    s_waitcnt lgkmcnt(2)
    ds_read_b128 a[188:191], v235 offset:20480
    v_max3_f32 v201, v201, v23, v28
    v_max3_f32 v200, v200, v25, v26
    v_mfma_f32_16x16x32_bf16 v[68:71], a[168:171], v[52:55], v[68:71]
    s_xor_b32 s61, s12, 229376
    v_max3_f32 v201, v201, v29, v30
    v_max3_f32 v202, v200, v201, v27
    v_max_f32 v202, v202, v31
    v_cmp_lt_f32 vcc, s64, v202
    s_cbranch_vccnz L_rare8
L_back8:
    v_mfma_f32_16x16x32_bf16 v[64:67], a[172:175], v[56:59], v[64:67]
    ds_read_b128 a[192:195], v232 offset:24576
    buffer_load_dwordx4 v236, s[28:31], s61 offen offset:0 nt lds
    v_exp_f32 v0, v0
    v_mfma_f32_16x16x32_bf16 v[68:71], a[172:175], v[60:63], v[68:71]
    v_exp_f32 v1, v1
    v_exp_f32 v2, v2
    v_cvt_pk_bf16_f32 v206, v0, v1
    v_mfma_f32_16x16x32_bf16 v[72:75], a[176:179], v[32:35], v[208:211]
    s_waitcnt lgkmcnt(2)
    ds_read_b128 a[196:199], v233 offset:24576
    v_exp_f32 v3, v3
    v_mfma_f32_16x16x32_bf16 v[76:79], a[176:179], v[36:39], v[212:215]
    v_exp_f32 v4, v4
    v_cvt_pk_bf16_f32 v207, v2, v3
    v_exp_f32 v5, v5
    v_mfma_f32_16x16x32_bf16 v[72:75], a[180:183], v[40:43], v[72:75]
    ds_read_b128 a[200:203], v234 offset:24576
    buffer_load_dwordx4 v237, s[28:31], s61 offen offset:1024 nt lds
    v_accvgpr_write_b32 a112, v206
    v_exp_f32 v6, v6
    v_mfma_f32_16x16x32_bf16 v[76:79], a[180:183], v[44:47], v[76:79]
    v_max3_f32 v200, v64, v65, v66
    v_max3_f32 v201, v68, v69, v70
    v_cvt_pk_bf16_f32 v206, v4, v5
    v_mfma_f32_16x16x32_bf16 v[72:75], a[184:187], v[48:51], v[72:75]
    s_waitcnt lgkmcnt(2)
    ds_read_b128 a[204:207], v235 offset:24576
    v_exp_f32 v7, v7
    v_accvgpr_write_b32 a113, v207
    v_mfma_f32_16x16x32_bf16 v[76:79], a[184:187], v[52:55], v[76:79]
    v_exp_f32 v8, v8
    v_cvt_pk_bf16_f32 v207, v6, v7
    v_exp_f32 v9, v9
    v_mfma_f32_16x16x32_bf16 v[72:75], a[188:191], v[56:59], v[72:75]
    ds_read_b128 a[208:211], v232 offset:28672
    v_accvgpr_write_b32 a116, v206
    v_exp_f32 v10, v10
    v_cvt_pk_bf16_f32 v206, v8, v9
    v_mfma_f32_16x16x32_bf16 v[76:79], a[188:191], v[60:63], v[76:79]
    v_exp_f32 v11, v11
    v_accvgpr_write_b32 a117, v207
    v_exp_f32 v12, v12
    v_mfma_f32_16x16x32_bf16 v[80:83], a[192:195], v[32:35], v[208:211]
    s_waitcnt lgkmcnt(2)
    ds_read_b128 a[212:215], v233 offset:28672
    v_cvt_pk_bf16_f32 v207, v10, v11
    v_exp_f32 v13, v13
    v_mfma_f32_16x16x32_bf16 v[84:87], a[192:195], v[36:39], v[212:215]
    v_accvgpr_write_b32 a114, v206
    v_exp_f32 v14, v14
    v_cvt_pk_bf16_f32 v206, v12, v13
    v_mfma_f32_16x16x32_bf16 v[80:83], a[196:199], v[40:43], v[80:83]
    ds_read_b128 a[216:219], v234 offset:28672
    v_exp_f32 v15, v15
    v_accvgpr_write_b32 a115, v207
    v_mfma_f32_16x16x32_bf16 v[84:87], a[196:199], v[44:47], v[84:87]
    v_max3_f32 v200, v200, v67, v72
    v_max3_f32 v201, v201, v71, v76
    v_max3_f32 v200, v200, v73, v74
    v_exp_f32 v16, v16
    v_mfma_f32_16x16x32_bf16 v[80:83], a[200:203], v[48:51], v[80:83]
    s_waitcnt lgkmcnt(2)
    ds_read_b128 a[220:223], v235 offset:28672
    v_max3_f32 v201, v201, v77, v78
    v_cvt_pk_bf16_f32 v207, v14, v15
    v_mfma_f32_16x16x32_bf16 v[84:87], a[200:203], v[52:55], v[84:87]
    v_exp_f32 v17, v17
    v_accvgpr_write_b32 a118, v206
    v_exp_f32 v18, v18
    v_mfma_f32_16x16x32_bf16 v[80:83], a[204:207], v[56:59], v[80:83]
    s_waitcnt vmcnt(5)
    s_barrier
    ds_read_b128 a[160:163], v232 offset:32768
    v_cvt_pk_bf16_f32 v206, v16, v17
    v_exp_f32 v19, v19
    v_mfma_f32_16x16x32_bf16 v[84:87], a[204:207], v[60:63], v[84:87]
    v_accvgpr_write_b32 a119, v207
    v_exp_f32 v20, v20
    v_cvt_pk_bf16_f32 v207, v18, v19
    v_mfma_f32_16x16x32_bf16 v[88:91], a[208:211], v[32:35], v[208:211]
    s_waitcnt lgkmcnt(2)
    ds_read_b128 a[164:167], v233 offset:32768
    v_exp_f32 v21, v21
    v_accvgpr_write_b32 a120, v206
    v_mfma_f32_16x16x32_bf16 v[92:95], a[208:211], v[36:39], v[212:215]
    buffer_load_dwordx4 v238, s[28:31], s61 offen offset:2048 nt lds
    v_exp_f32 v22, v22
    v_cvt_pk_bf16_f32 v206, v20, v21
    v_mfma_f32_16x16x32_bf16 v[88:91], a[212:215], v[40:43], v[88:91]
    ds_read_b128 a[168:171], v234 offset:32768
    buffer_load_dwordx4 v239, s[28:31], s61 offen offset:3072 nt lds
    v_exp_f32 v23, v23
    v_mfma_f32_16x16x32_bf16 v[92:95], a[212:215], v[44:47], v[92:95]
    v_max3_f32 v200, v200, v75, v80
    v_max3_f32 v201, v201, v79, v84
    v_max3_f32 v200, v200, v81, v82
    v_accvgpr_write_b32 a121, v207
    v_mfma_f32_16x16x32_bf16 v[88:91], a[216:219], v[48:51], v[88:91]
    s_waitcnt lgkmcnt(2)
    ds_read_b128 a[172:175], v235 offset:32768
    v_max3_f32 v201, v201, v85, v86
    v_exp_f32 v24, v24
    v_cvt_pk_bf16_f32 v207, v22, v23
    v_mfma_f32_16x16x32_bf16 v[92:95], a[216:219], v[52:55], v[92:95]
    v_exp_f32 v25, v25
    v_accvgpr_write_b32 a124, v206
    v_exp_f32 v26, v26
    v_mfma_f32_16x16x32_bf16 v[88:91], a[220:223], v[56:59], v[88:91]
    ds_read_b128 a[176:179], v232 offset:36864
    v_cvt_pk_bf16_f32 v206, v24, v25
    v_exp_f32 v27, v27
    v_mfma_f32_16x16x32_bf16 v[92:95], a[220:223], v[60:63], v[92:95]
    v_accvgpr_write_b32 a125, v207
    v_exp_f32 v28, v28
    v_cvt_pk_bf16_f32 v207, v26, v27
    v_mfma_f32_16x16x32_bf16 v[0:3], a[160:163], v[32:35], v[208:211]
    s_waitcnt lgkmcnt(2)
    ds_read_b128 a[180:183], v233 offset:36864
    v_exp_f32 v29, v29
    v_accvgpr_write_b32 a122, v206
    v_mfma_f32_16x16x32_bf16 v[4:7], a[160:163], v[36:39], v[212:215]
    v_exp_f32 v30, v30
    v_cvt_pk_bf16_f32 v206, v28, v29
    v_mfma_f32_16x16x32_bf16 v[0:3], a[164:167], v[40:43], v[0:3]
    ds_read_b128 a[184:187], v234 offset:36864
    v_exp_f32 v31, v31
    v_accvgpr_write_b32 a123, v207
    v_cvt_pk_bf16_f32 v207, v30, v31
    v_mfma_f32_16x16x32_bf16 v[4:7], a[164:167], v[44:47], v[4:7]
    v_accvgpr_write_b32 a126, v206
    v_accvgpr_write_b32 a127, v207
    v_max3_f32 v200, v200, v83, v88
    v_mfma_f32_16x16x32_bf16 v[0:3], a[168:171], v[48:51], v[0:3]
    s_add_u32 m0, s60, 65536
    s_waitcnt lgkmcnt(2)
    ds_read_b128 a[188:191], v235 offset:36864
    v_max3_f32 v201, v201, v87, v92
    v_max3_f32 v200, v200, v89, v90
    v_mfma_f32_16x16x32_bf16 v[4:7], a[168:171], v[52:55], v[4:7]
    s_xor_b32 s61, s12, 245760
    v_max3_f32 v201, v201, v93, v94
    v_max3_f32 v202, v200, v201, v91
    v_max_f32 v202, v202, v95
    v_cmp_lt_f32 vcc, s64, v202
    s_cbranch_vccnz L_rare9
L_back9:
    v_mfma_f32_16x16x32_bf16 v[0:3], a[172:175], v[56:59], v[0:3]
    ds_read_b128 a[192:195], v232 offset:40960
    buffer_load_dwordx4 v236, s[28:31], s61 offen offset:0 nt lds
    v_exp_f32 v64, v64
    v_mfma_f32_16x16x32_bf16 v[4:7], a[172:175], v[60:63], v[4:7]
    v_exp_f32 v65, v65
    v_exp_f32 v66, v66
    v_cvt_pk_bf16_f32 v206, v64, v65
    v_mfma_f32_16x16x32_bf16 v[8:11], a[176:179], v[32:35], v[208:211]
    s_waitcnt lgkmcnt(2)
    ds_read_b128 a[196:199], v233 offset:40960
    v_exp_f32 v67, v67
    v_mfma_f32_16x16x32_bf16 v[12:15], a[176:179], v[36:39], v[212:215]
    v_exp_f32 v68, v68
    v_cvt_pk_bf16_f32 v207, v66, v67
    v_exp_f32 v69, v69
    v_mfma_f32_16x16x32_bf16 v[8:11], a[180:183], v[40:43], v[8:11]
    ds_read_b128 a[200:203], v234 offset:40960
    buffer_load_dwordx4 v237, s[28:31], s61 offen offset:1024 nt lds
    v_accvgpr_write_b32 a128, v206
    v_exp_f32 v70, v70
    v_mfma_f32_16x16x32_bf16 v[12:15], a[180:183], v[44:47], v[12:15]
    v_max3_f32 v200, v0, v1, v2
    v_max3_f32 v201, v4, v5, v6
    v_cvt_pk_bf16_f32 v206, v68, v69
    v_mfma_f32_16x16x32_bf16 v[8:11], a[184:187], v[48:51], v[8:11]
    s_waitcnt lgkmcnt(2)
    ds_read_b128 a[204:207], v235 offset:40960
    v_exp_f32 v71, v71
    v_accvgpr_write_b32 a129, v207
    v_mfma_f32_16x16x32_bf16 v[12:15], a[184:187], v[52:55], v[12:15]
    v_exp_f32 v72, v72
    v_cvt_pk_bf16_f32 v207, v70, v71
    v_exp_f32 v73, v73
    v_mfma_f32_16x16x32_bf16 v[8:11], a[188:191], v[56:59], v[8:11]
    ds_read_b128 a[208:211], v232 offset:45056
    v_accvgpr_write_b32 a132, v206
    v_exp_f32 v74, v74
    v_cvt_pk_bf16_f32 v206, v72, v73
    v_mfma_f32_16x16x32_bf16 v[12:15], a[188:191], v[60:63], v[12:15]
    v_exp_f32 v75, v75
    v_accvgpr_write_b32 a133, v207
    v_exp_f32 v76, v76
    v_mfma_f32_16x16x32_bf16 v[16:19], a[192:195], v[32:35], v[208:211]
    s_waitcnt lgkmcnt(2)
    ds_read_b128 a[212:215], v233 offset:45056
    v_cvt_pk_bf16_f32 v207, v74, v75
    v_exp_f32 v77, v77
    v_mfma_f32_16x16x32_bf16 v[20:23], a[192:195], v[36:39], v[212:215]
    v_accvgpr_write_b32 a130, v206
    v_exp_f32 v78, v78
    v_cvt_pk_bf16_f32 v206, v76, v77
    v_mfma_f32_16x16x32_bf16 v[16:19], a[196:199], v[40:43], v[16:19]
    ds_read_b128 a[216:219], v234 offset:45056
    v_exp_f32 v79, v79
    v_accvgpr_write_b32 a131, v207
    v_mfma_f32_16x16x32_bf16 v[20:23], a[196:199], v[44:47], v[20:23]
    v_max3_f32 v200, v200, v3, v8
    v_max3_f32 v201, v201, v7, v12
    v_max3_f32 v200, v200, v9, v10
    v_exp_f32 v80, v80
    v_mfma_f32_16x16x32_bf16 v[16:19], a[200:203], v[48:51], v[16:19]
    s_waitcnt lgkmcnt(2)
    ds_read_b128 a[220:223], v235 offset:45056
    v_max3_f32 v201, v201, v13, v14
    v_cvt_pk_bf16_f32 v207, v78, v79
    v_mfma_f32_16x16x32_bf16 v[20:23], a[200:203], v[52:55], v[20:23]
    v_exp_f32 v81, v81
    v_accvgpr_write_b32 a134, v206
    v_exp_f32 v82, v82
    v_mfma_f32_16x16x32_bf16 v[16:19], a[204:207], v[56:59], v[16:19]
    s_waitcnt vmcnt(5)
    s_barrier
    ds_read_b128 a[160:163], v232 offset:49152
    v_cvt_pk_bf16_f32 v206, v80, v81
    v_exp_f32 v83, v83
    v_mfma_f32_16x16x32_bf16 v[20:23], a[204:207], v[60:63], v[20:23]
    v_accvgpr_write_b32 a135, v207
    v_exp_f32 v84, v84
    v_cvt_pk_bf16_f32 v207, v82, v83
    v_mfma_f32_16x16x32_bf16 v[24:27], a[208:211], v[32:35], v[208:211]
    s_waitcnt lgkmcnt(2)
    ds_read_b128 a[164:167], v233 offset:49152
    v_exp_f32 v85, v85
    v_accvgpr_write_b32 a136, v206
    v_mfma_f32_16x16x32_bf16 v[28:31], a[208:211], v[36:39], v[212:215]
    buffer_load_dwordx4 v238, s[28:31], s61 offen offset:2048 nt lds
    v_exp_f32 v86, v86
    v_cvt_pk_bf16_f32 v206, v84, v85
    v_mfma_f32_16x16x32_bf16 v[24:27], a[212:215], v[40:43], v[24:27]
    ds_read_b128 a[168:171], v234 offset:49152
    buffer_load_dwordx4 v239, s[28:31], s61 offen offset:3072 nt lds
    v_exp_f32 v87, v87
    v_mfma_f32_16x16x32_bf16 v[28:31], a[212:215], v[44:47], v[28:31]
    v_max3_f32 v200, v200, v11, v16
    v_max3_f32 v201, v201, v15, v20
    v_max3_f32 v200, v200, v17, v18
    v_accvgpr_write_b32 a137, v207
    v_mfma_f32_16x16x32_bf16 v[24:27], a[216:219], v[48:51], v[24:27]
    s_waitcnt lgkmcnt(2)
    ds_read_b128 a[172:175], v235 offset:49152
    v_max3_f32 v201, v201, v21, v22
    v_exp_f32 v88, v88
    v_cvt_pk_bf16_f32 v207, v86, v87
    v_mfma_f32_16x16x32_bf16 v[28:31], a[216:219], v[52:55], v[28:31]
    v_exp_f32 v89, v89
    v_accvgpr_write_b32 a140, v206
    v_exp_f32 v90, v90
    v_mfma_f32_16x16x32_bf16 v[24:27], a[220:223], v[56:59], v[24:27]
    ds_read_b128 a[176:179], v232 offset:53248
    v_cvt_pk_bf16_f32 v206, v88, v89
    v_exp_f32 v91, v91
    v_mfma_f32_16x16x32_bf16 v[28:31], a[220:223], v[60:63], v[28:31]
    v_accvgpr_write_b32 a141, v207
    v_exp_f32 v92, v92
    v_cvt_pk_bf16_f32 v207, v90, v91
    v_mfma_f32_16x16x32_bf16 v[64:67], a[160:163], v[32:35], v[208:211]
    s_waitcnt lgkmcnt(2)
    ds_read_b128 a[180:183], v233 offset:53248
    v_exp_f32 v93, v93
    v_accvgpr_write_b32 a138, v206
    v_mfma_f32_16x16x32_bf16 v[68:71], a[160:163], v[36:39], v[212:215]
    v_exp_f32 v94, v94
    v_cvt_pk_bf16_f32 v206, v92, v93
    v_mfma_f32_16x16x32_bf16 v[64:67], a[164:167], v[40:43], v[64:67]
    ds_read_b128 a[184:187], v234 offset:53248
    v_exp_f32 v95, v95
    v_accvgpr_write_b32 a139, v207
    v_cvt_pk_bf16_f32 v207, v94, v95
    v_mfma_f32_16x16x32_bf16 v[68:71], a[164:167], v[44:47], v[68:71]
    v_accvgpr_write_b32 a142, v206
    v_accvgpr_write_b32 a143, v207
    v_max3_f32 v200, v200, v19, v24
    v_mfma_f32_16x16x32_bf16 v[64:67], a[168:171], v[48:51], v[64:67]
    s_add_u32 m0, s60, 98304
    s_waitcnt lgkmcnt(2)
    ds_read_b128 a[188:191], v235 offset:53248
    v_max3_f32 v201, v201, v23, v28
    v_max3_f32 v200, v200, v25, v26
    v_mfma_f32_16x16x32_bf16 v[68:71], a[168:171], v[52:55], v[68:71]
    s_xor_b32 s61, s12, 0
    v_max3_f32 v201, v201, v29, v30
    v_max3_f32 v202, v200, v201, v27
    v_max_f32 v202, v202, v31
    v_cmp_lt_f32 vcc, s64, v202
    s_cbranch_vccnz L_rare10
L_back10:
    v_mfma_f32_16x16x32_bf16 v[64:67], a[172:175], v[56:59], v[64:67]
    ds_read_b128 a[192:195], v232 offset:57344
    buffer_load_dwordx4 v240, s[32:35], s61 offen offset:0 nt lds
    v_exp_f32 v0, v0
    v_mfma_f32_16x16x32_bf16 v[68:71], a[172:175], v[60:63], v[68:71]
    v_exp_f32 v1, v1
    v_exp_f32 v2, v2
    v_cvt_pk_bf16_f32 v206, v0, v1
    v_mfma_f32_16x16x32_bf16 v[72:75], a[176:179], v[32:35], v[208:211]
    s_waitcnt lgkmcnt(2)
    ds_read_b128 a[196:199], v233 offset:57344
    v_exp_f32 v3, v3
    v_mfma_f32_16x16x32_bf16 v[76:79], a[176:179], v[36:39], v[212:215]
    v_exp_f32 v4, v4
    v_cvt_pk_bf16_f32 v207, v2, v3
    v_exp_f32 v5, v5
    v_mfma_f32_16x16x32_bf16 v[72:75], a[180:183], v[40:43], v[72:75]
    ds_read_b128 a[200:203], v234 offset:57344
    buffer_load_dwordx4 v241, s[32:35], s61 offen offset:1024 nt lds
    v_accvgpr_write_b32 a144, v206
    v_exp_f32 v6, v6
    v_mfma_f32_16x16x32_bf16 v[76:79], a[180:183], v[44:47], v[76:79]
    v_max3_f32 v200, v64, v65, v66
    v_max3_f32 v201, v68, v69, v70
    v_cvt_pk_bf16_f32 v206, v4, v5
    v_mfma_f32_16x16x32_bf16 v[72:75], a[184:187], v[48:51], v[72:75]
    s_waitcnt lgkmcnt(2)
    ds_read_b128 a[204:207], v235 offset:57344
    v_exp_f32 v7, v7
    v_accvgpr_write_b32 a145, v207
    v_mfma_f32_16x16x32_bf16 v[76:79], a[184:187], v[52:55], v[76:79]
    v_exp_f32 v8, v8
    v_cvt_pk_bf16_f32 v207, v6, v7
    v_exp_f32 v9, v9
    v_mfma_f32_16x16x32_bf16 v[72:75], a[188:191], v[56:59], v[72:75]
    ds_read_b128 a[208:211], v232 offset:61440
    v_accvgpr_write_b32 a148, v206
    v_exp_f32 v10, v10
    v_cvt_pk_bf16_f32 v206, v8, v9
    v_mfma_f32_16x16x32_bf16 v[76:79], a[188:191], v[60:63], v[76:79]
    v_exp_f32 v11, v11
    v_accvgpr_write_b32 a149, v207
    v_exp_f32 v12, v12
    v_mfma_f32_16x16x32_bf16 v[80:83], a[192:195], v[32:35], v[208:211]
    s_waitcnt lgkmcnt(2)
    ds_read_b128 a[212:215], v233 offset:61440
    v_cvt_pk_bf16_f32 v207, v10, v11
    v_exp_f32 v13, v13
    v_mfma_f32_16x16x32_bf16 v[84:87], a[192:195], v[36:39], v[212:215]
    v_accvgpr_write_b32 a146, v206
    v_exp_f32 v14, v14
    v_cvt_pk_bf16_f32 v206, v12, v13
    v_mfma_f32_16x16x32_bf16 v[80:83], a[196:199], v[40:43], v[80:83]
    ds_read_b128 a[216:219], v234 offset:61440
    v_exp_f32 v15, v15
    v_accvgpr_write_b32 a147, v207
    v_mfma_f32_16x16x32_bf16 v[84:87], a[196:199], v[44:47], v[84:87]
    v_max3_f32 v200, v200, v67, v72
    v_max3_f32 v201, v201, v71, v76
    v_max3_f32 v200, v200, v73, v74
    v_exp_f32 v16, v16
    v_mfma_f32_16x16x32_bf16 v[80:83], a[200:203], v[48:51], v[80:83]
    s_waitcnt lgkmcnt(2)
    ds_read_b128 a[220:223], v235 offset:61440
    v_max3_f32 v201, v201, v77, v78
    v_cvt_pk_bf16_f32 v207, v14, v15
    v_mfma_f32_16x16x32_bf16 v[84:87], a[200:203], v[52:55], v[84:87]
    v_exp_f32 v17, v17
    v_accvgpr_write_b32 a150, v206
    v_exp_f32 v18, v18
    v_mfma_f32_16x16x32_bf16 v[80:83], a[204:207], v[56:59], v[80:83]
    s_waitcnt vmcnt(5)
    s_barrier
    ds_read_b128 a[160:163], v192 offset:0
    v_cvt_pk_bf16_f32 v206, v16, v17
    v_exp_f32 v19, v19
    v_mfma_f32_16x16x32_bf16 v[84:87], a[204:207], v[60:63], v[84:87]
    v_accvgpr_write_b32 a151, v207
    v_exp_f32 v20, v20
    v_cvt_pk_bf16_f32 v207, v18, v19
    v_mfma_f32_16x16x32_bf16 v[88:91], a[208:211], v[32:35], v[208:211]
    s_waitcnt lgkmcnt(2)
    ds_read_b128 a[164:167], v193 offset:0
    v_exp_f32 v21, v21
    v_accvgpr_write_b32 a152, v206
    v_mfma_f32_16x16x32_bf16 v[92:95], a[208:211], v[36:39], v[212:215]
    buffer_load_dwordx4 v240, s[32:35], s61 offen offset:2048 nt lds
    v_exp_f32 v22, v22
    v_cvt_pk_bf16_f32 v206, v20, v21
    v_mfma_f32_16x16x32_bf16 v[88:91], a[212:215], v[40:43], v[88:91]
    ds_read_b128 a[168:171], v194 offset:0
    buffer_load_dwordx4 v241, s[32:35], s61 offen offset:3072 nt lds
    v_exp_f32 v23, v23
    v_mfma_f32_16x16x32_bf16 v[92:95], a[212:215], v[44:47], v[92:95]
    v_max3_f32 v200, v200, v75, v80
    v_max3_f32 v201, v201, v79, v84
    v_max3_f32 v200, v200, v81, v82
    v_accvgpr_write_b32 a153, v207
    v_mfma_f32_16x16x32_bf16 v[88:91], a[216:219], v[48:51], v[88:91]
    s_waitcnt lgkmcnt(2)
    ds_read_b128 a[172:175], v195 offset:0
    v_max3_f32 v201, v201, v85, v86
    v_exp_f32 v24, v24
    v_cvt_pk_bf16_f32 v207, v22, v23
    v_mfma_f32_16x16x32_bf16 v[92:95], a[216:219], v[52:55], v[92:95]
    v_exp_f32 v25, v25
    v_accvgpr_write_b32 a156, v206
    v_exp_f32 v26, v26
    v_mfma_f32_16x16x32_bf16 v[88:91], a[220:223], v[56:59], v[88:91]
    ds_read_b128 a[176:179], v192 offset:4096
    v_cvt_pk_bf16_f32 v206, v24, v25
    v_exp_f32 v27, v27
    v_mfma_f32_16x16x32_bf16 v[92:95], a[220:223], v[60:63], v[92:95]
    v_accvgpr_write_b32 a157, v207
    v_exp_f32 v28, v28
    v_cvt_pk_bf16_f32 v207, v26, v27
    v_mfma_f32_16x16x32_bf16 v[0:3], a[160:163], v[32:35], v[208:211]
    s_waitcnt lgkmcnt(2)
    ds_read_b128 a[180:183], v193 offset:4096
    v_exp_f32 v29, v29
    v_accvgpr_write_b32 a154, v206
    v_mfma_f32_16x16x32_bf16 v[4:7], a[160:163], v[36:39], v[212:215]
    v_exp_f32 v30, v30
    v_cvt_pk_bf16_f32 v206, v28, v29
    v_mfma_f32_16x16x32_bf16 v[0:3], a[164:167], v[40:43], v[0:3]
    ds_read_b128 a[184:187], v194 offset:4096
    v_exp_f32 v31, v31
    v_accvgpr_write_b32 a155, v207
    v_cvt_pk_bf16_f32 v207, v30, v31
    v_mfma_f32_16x16x32_bf16 v[4:7], a[164:167], v[44:47], v[4:7]
    v_accvgpr_write_b32 a158, v206
    v_accvgpr_write_b32 a159, v207
    v_max3_f32 v200, v200, v83, v88
    v_mfma_f32_16x16x32_bf16 v[0:3], a[168:171], v[48:51], v[0:3]
    s_add_u32 m0, s60, 114688
    s_waitcnt lgkmcnt(2)
    ds_read_b128 a[188:191], v195 offset:4096
    v_max3_f32 v201, v201, v87, v92
    v_max3_f32 v200, v200, v89, v90
    v_mfma_f32_16x16x32_bf16 v[4:7], a[168:171], v[52:55], v[4:7]
    s_xor_b32 s61, s12, 16384
    v_max3_f32 v201, v201, v93, v94
    v_max3_f32 v202, v200, v201, v91
    v_max_f32 v202, v202, v95
    v_cmp_lt_f32 vcc, s64, v202
    s_cbranch_vccnz L_rare11
L_back11:
    v_mfma_f32_16x16x32_bf16 v[0:3], a[172:175], v[56:59], v[0:3]
    ds_read_b128 a[192:195], v192 offset:8192
    buffer_load_dwordx4 v240, s[32:35], s61 offen offset:0 nt lds
    v_exp_f32 v64, v64
    v_mfma_f32_16x16x32_bf16 v[4:7], a[172:175], v[60:63], v[4:7]
    v_exp_f32 v65, v65
    v_exp_f32 v66, v66
    v_mfma_f32_16x16x32_bf16 v[8:11], a[176:179], v[32:35], v[208:211]
    s_waitcnt lgkmcnt(2)
    ds_read_b128 a[196:199], v193 offset:8192
    v_cvt_pk_bf16_f32 v112, v64, v65
    v_mfma_f32_16x16x32_bf16 v[12:15], a[176:179], v[36:39], v[212:215]
    v_exp_f32 v67, v67
    v_exp_f32 v68, v68
    v_mfma_f32_16x16x32_bf16 v[8:11], a[180:183], v[40:43], v[8:11]
    ds_read_b128 a[200:203], v194 offset:8192
    buffer_load_dwordx4 v241, s[32:35], s61 offen offset:1024 nt lds
    v_cvt_pk_bf16_f32 v113, v66, v67
    v_exp_f32 v69, v69
    v_mfma_f32_16x16x32_bf16 v[12:15], a[180:183], v[44:47], v[12:15]
    v_max3_f32 v200, v0, v1, v2
    v_max3_f32 v201, v4, v5, v6
    v_mfma_f32_16x16x32_bf16 v[8:11], a[184:187], v[48:51], v[8:11]
    s_waitcnt lgkmcnt(2)
    ds_read_b128 a[204:207], v195 offset:8192
    v_exp_f32 v70, v70
    v_cvt_pk_bf16_f32 v116, v68, v69
    v_mfma_f32_16x16x32_bf16 v[12:15], a[184:187], v[52:55], v[12:15]
    v_exp_f32 v71, v71
    v_exp_f32 v72, v72
    v_mfma_f32_16x16x32_bf16 v[8:11], a[188:191], v[56:59], v[8:11]
    ds_read_b128 a[208:211], v192 offset:12288
    v_cvt_pk_bf16_f32 v117, v70, v71
    v_exp_f32 v73, v73
    v_mfma_f32_16x16x32_bf16 v[12:15], a[188:191], v[60:63], v[12:15]
    v_exp_f32 v74, v74
    v_cvt_pk_bf16_f32 v114, v72, v73
    v_mfma_f32_16x16x32_bf16 v[16:19], a[192:195], v[32:35], v[208:211]
    s_waitcnt lgkmcnt(2)
    ds_read_b128 a[212:215], v193 offset:12288
    v_exp_f32 v75, v75
    v_mfma_f32_16x16x32_bf16 v[20:23], a[192:195], v[36:39], v[212:215]
    v_exp_f32 v76, v76
    v_cvt_pk_bf16_f32 v115, v74, v75
    v_exp_f32 v77, v77
    v_mfma_f32_16x16x32_bf16 v[16:19], a[196:199], v[40:43], v[16:19]
    ds_read_b128 a[216:219], v194 offset:12288
    v_exp_f32 v78, v78
    v_mfma_f32_16x16x32_bf16 v[20:23], a[196:199], v[44:47], v[20:23]
    v_max3_f32 v200, v200, v3, v8
    v_max3_f32 v201, v201, v7, v12
    v_max3_f32 v200, v200, v9, v10
    v_cvt_pk_bf16_f32 v118, v76, v77
    v_mfma_f32_16x16x32_bf16 v[16:19], a[200:203], v[48:51], v[16:19]
    s_waitcnt lgkmcnt(2)
    ds_read_b128 a[220:223], v195 offset:12288
    v_max3_f32 v201, v201, v13, v14
    v_exp_f32 v79, v79
    v_mfma_f32_16x16x32_bf16 v[20:23], a[200:203], v[52:55], v[20:23]
    v_exp_f32 v80, v80
    v_cvt_pk_bf16_f32 v119, v78, v79
    v_mfma_f32_16x16x32_bf16 v[16:19], a[204:207], v[56:59], v[16:19]
    s_waitcnt vmcnt(5)
    s_barrier
    ds_read_b128 a[160:163], v192 offset:49152
    v_exp_f32 v81, v81
    v_mfma_f32_16x16x32_bf16 v[20:23], a[204:207], v[60:63], v[20:23]
    v_exp_f32 v82, v82
    v_cvt_pk_bf16_f32 v120, v80, v81
    v_mfma_f32_16x16x32_bf16 v[24:27], a[208:211], v[32:35], v[208:211]
    s_waitcnt lgkmcnt(2)
    ds_read_b128 a[164:167], v193 offset:49152
    v_exp_f32 v83, v83
    v_mfma_f32_16x16x32_bf16 v[28:31], a[208:211], v[36:39], v[212:215]
    buffer_load_dwordx4 v240, s[32:35], s61 offen offset:2048 nt lds
    v_exp_f32 v84, v84
    v_cvt_pk_bf16_f32 v121, v82, v83
    v_mfma_f32_16x16x32_bf16 v[24:27], a[212:215], v[40:43], v[24:27]
    ds_read_b128 a[168:171], v194 offset:49152
    buffer_load_dwordx4 v241, s[32:35], s61 offen offset:3072 nt lds
    v_exp_f32 v85, v85
    v_mfma_f32_16x16x32_bf16 v[28:31], a[212:215], v[44:47], v[28:31]
    v_max3_f32 v200, v200, v11, v16
    v_max3_f32 v201, v201, v15, v20
    v_max3_f32 v200, v200, v17, v18
    v_mfma_f32_16x16x32_bf16 v[24:27], a[216:219], v[48:51], v[24:27]
    s_waitcnt lgkmcnt(2)
    ds_read_b128 a[172:175], v195 offset:49152
    v_max3_f32 v201, v201, v21, v22
    v_exp_f32 v86, v86
    v_mfma_f32_16x16x32_bf16 v[28:31], a[216:219], v[52:55], v[28:31]
    v_cvt_pk_bf16_f32 v124, v84, v85
    v_exp_f32 v87, v87
    v_mfma_f32_16x16x32_bf16 v[24:27], a[220:223], v[56:59], v[24:27]
    ds_read_b128 a[176:179], v192 offset:53248
    v_exp_f32 v88, v88
    v_cvt_pk_bf16_f32 v125, v86, v87
    v_mfma_f32_16x16x32_bf16 v[28:31], a[220:223], v[60:63], v[28:31]
    v_exp_f32 v89, v89
    v_exp_f32 v90, v90
    v_mfma_f32_16x16x32_bf16 v[64:67], a[160:163], v[32:35], v[208:211]
    s_waitcnt lgkmcnt(2)
    ds_read_b128 a[180:183], v193 offset:53248
    v_cvt_pk_bf16_f32 v122, v88, v89
    v_exp_f32 v91, v91
    v_mfma_f32_16x16x32_bf16 v[68:71], a[160:163], v[36:39], v[212:215]
    v_exp_f32 v92, v92
    v_cvt_pk_bf16_f32 v123, v90, v91
    v_exp_f32 v93, v93
    v_mfma_f32_16x16x32_bf16 v[64:67], a[164:167], v[40:43], v[64:67]
    ds_read_b128 a[184:187], v194 offset:53248
    v_exp_f32 v94, v94
    v_cvt_pk_bf16_f32 v126, v92, v93
    v_mfma_f32_16x16x32_bf16 v[68:71], a[164:167], v[44:47], v[68:71]
    v_exp_f32 v95, v95
    s_nop 0
    v_cvt_pk_bf16_f32 v127, v94, v95
    v_max3_f32 v200, v200, v19, v24
    v_mfma_f32_16x16x32_bf16 v[64:67], a[168:171], v[48:51], v[64:67]
    s_add_u32 m0, s60, 131072
    s_waitcnt lgkmcnt(2)
    ds_read_b128 a[188:191], v195 offset:53248
    v_max3_f32 v201, v201, v23, v28
    v_max3_f32 v200, v200, v25, v26
    v_mfma_f32_16x16x32_bf16 v[68:71], a[168:171], v[52:55], v[68:71]
    s_xor_b32 s61, s12, 32768
    v_max3_f32 v201, v201, v29, v30
    v_max3_f32 v202, v200, v201, v27
    v_max_f32 v202, v202, v31
    v_cmp_lt_f32 vcc, s64, v202
    s_cbranch_vccnz L_rare12
L_back12:
    v_mfma_f32_16x16x32_bf16 v[64:67], a[172:175], v[56:59], v[64:67]
    ds_read_b128 a[192:195], v192 offset:57344
    buffer_load_dwordx4 v240, s[32:35], s61 offen offset:0 nt lds
    v_exp_f32 v0, v0
    v_mfma_f32_16x16x32_bf16 v[68:71], a[172:175], v[60:63], v[68:71]
    v_exp_f32 v1, v1
    v_exp_f32 v2, v2
    v_mfma_f32_16x16x32_bf16 v[72:75], a[176:179], v[32:35], v[208:211]
    s_waitcnt lgkmcnt(2)
    ds_read_b128 a[196:199], v193 offset:57344
    v_cvt_pk_bf16_f32 v128, v0, v1
    v_mfma_f32_16x16x32_bf16 v[76:79], a[176:179], v[36:39], v[212:215]
    v_exp_f32 v3, v3
    v_exp_f32 v4, v4
    v_mfma_f32_16x16x32_bf16 v[72:75], a[180:183], v[40:43], v[72:75]
    ds_read_b128 a[200:203], v194 offset:57344
    v_cvt_pk_bf16_f32 v129, v2, v3
    v_exp_f32 v5, v5
    v_mfma_f32_16x16x32_bf16 v[76:79], a[180:183], v[44:47], v[76:79]
    v_max3_f32 v200, v64, v65, v66
    v_max3_f32 v201, v68, v69, v70
    v_exp_f32 v6, v6
    v_mfma_f32_16x16x32_bf16 v[72:75], a[184:187], v[48:51], v[72:75]
    s_waitcnt lgkmcnt(2)
    ds_read_b128 a[204:207], v195 offset:57344
    v_cvt_pk_bf16_f32 v132, v4, v5
    v_exp_f32 v7, v7
    v_mfma_f32_16x16x32_bf16 v[76:79], a[184:187], v[52:55], v[76:79]
    v_exp_f32 v8, v8
    v_cvt_pk_bf16_f32 v133, v6, v7
    v_mfma_f32_16x16x32_bf16 v[72:75], a[188:191], v[56:59], v[72:75]
    ds_read_b128 a[208:211], v192 offset:61440
    v_exp_f32 v9, v9
    v_mfma_f32_16x16x32_bf16 v[76:79], a[188:191], v[60:63], v[76:79]
    v_exp_f32 v10, v10
    v_cvt_pk_bf16_f32 v130, v8, v9
    v_mfma_f32_16x16x32_bf16 v[80:83], a[192:195], v[32:35], v[208:211]
    s_waitcnt lgkmcnt(2)
    ds_read_b128 a[212:215], v193 offset:61440
    v_exp_f32 v11, v11
    v_exp_f32 v12, v12
    v_mfma_f32_16x16x32_bf16 v[84:87], a[192:195], v[36:39], v[212:215]
    v_cvt_pk_bf16_f32 v131, v10, v11
    v_exp_f32 v13, v13
    v_mfma_f32_16x16x32_bf16 v[80:83], a[196:199], v[40:43], v[80:83]
    ds_read_b128 a[216:219], v194 offset:61440
    v_exp_f32 v14, v14
    v_cvt_pk_bf16_f32 v134, v12, v13
    v_mfma_f32_16x16x32_bf16 v[84:87], a[196:199], v[44:47], v[84:87]
    v_max3_f32 v200, v200, v67, v72
    v_max3_f32 v201, v201, v71, v76
    v_max3_f32 v200, v200, v73, v74
    v_mfma_f32_16x16x32_bf16 v[80:83], a[200:203], v[48:51], v[80:83]
    s_waitcnt lgkmcnt(2)
    ds_read_b128 a[220:223], v195 offset:61440
    v_max3_f32 v201, v201, v77, v78
    v_exp_f32 v15, v15
    v_mfma_f32_16x16x32_bf16 v[84:87], a[200:203], v[52:55], v[84:87]
    v_exp_f32 v16, v16
    v_cvt_pk_bf16_f32 v135, v14, v15
    v_mfma_f32_16x16x32_bf16 v[80:83], a[204:207], v[56:59], v[80:83]
    s_waitcnt vmcnt(5)
    s_barrier
    ds_read_b128 a[160:163], v192 offset:16384
    v_exp_f32 v17, v17
    v_mfma_f32_16x16x32_bf16 v[84:87], a[204:207], v[60:63], v[84:87]
    v_exp_f32 v18, v18
    v_cvt_pk_bf16_f32 v136, v16, v17
    v_mfma_f32_16x16x32_bf16 v[88:91], a[208:211], v[32:35], v[208:211]
    s_waitcnt lgkmcnt(2)
    ds_read_b128 a[164:167], v193 offset:16384
    v_exp_f32 v19, v19
    v_mfma_f32_16x16x32_bf16 v[92:95], a[208:211], v[36:39], v[212:215]
    buffer_load_dwordx4 v241, s[32:35], s61 offen offset:1024 nt lds
    v_exp_f32 v20, v20
    v_cvt_pk_bf16_f32 v137, v18, v19
    v_mfma_f32_16x16x32_bf16 v[88:91], a[212:215], v[40:43], v[88:91]
    ds_read_b128 a[168:171], v194 offset:16384
    buffer_load_dwordx4 v240, s[32:35], s61 offen offset:2048 nt lds
    v_exp_f32 v21, v21
    v_mfma_f32_16x16x32_bf16 v[92:95], a[212:215], v[44:47], v[92:95]
    v_max3_f32 v200, v200, v75, v80
    v_max3_f32 v201, v201, v79, v84
    v_max3_f32 v200, v200, v81, v82
    v_mfma_f32_16x16x32_bf16 v[88:91], a[216:219], v[48:51], v[88:91]
    s_waitcnt lgkmcnt(2)
    ds_read_b128 a[172:175], v195 offset:16384
    v_max3_f32 v201, v201, v85, v86
    v_exp_f32 v22, v22
    v_mfma_f32_16x16x32_bf16 v[92:95], a[216:219], v[52:55], v[92:95]
    v_cvt_pk_bf16_f32 v140, v20, v21
    v_exp_f32 v23, v23
    v_mfma_f32_16x16x32_bf16 v[88:91], a[220:223], v[56:59], v[88:91]
    ds_read_b128 a[176:179], v192 offset:20480
    v_exp_f32 v24, v24
    v_cvt_pk_bf16_f32 v141, v22, v23
    v_mfma_f32_16x16x32_bf16 v[92:95], a[220:223], v[60:63], v[92:95]
    v_exp_f32 v25, v25
    v_exp_f32 v26, v26
    v_mfma_f32_16x16x32_bf16 v[0:3], a[160:163], v[32:35], v[208:211]
    s_waitcnt lgkmcnt(2)
    ds_read_b128 a[180:183], v193 offset:20480
    v_cvt_pk_bf16_f32 v138, v24, v25
    v_exp_f32 v27, v27
    v_mfma_f32_16x16x32_bf16 v[4:7], a[160:163], v[36:39], v[212:215]
    v_exp_f32 v28, v28
    v_cvt_pk_bf16_f32 v139, v26, v27
    v_exp_f32 v29, v29
    v_mfma_f32_16x16x32_bf16 v[0:3], a[164:167], v[40:43], v[0:3]
    ds_read_b128 a[184:187], v194 offset:20480
    v_exp_f32 v30, v30
    v_mfma_f32_16x16x32_bf16 v[4:7], a[164:167], v[44:47], v[4:7]
    v_cvt_pk_bf16_f32 v142, v28, v29
    v_exp_f32 v31, v31
    s_nop 0
    v_cvt_pk_bf16_f32 v143, v30, v31
    v_mfma_f32_16x16x32_bf16 v[0:3], a[168:171], v[48:51], v[0:3]
    s_waitcnt lgkmcnt(2)
    ds_read_b128 a[188:191], v195 offset:20480
    v_max3_f32 v200, v200, v83, v88
    v_max3_f32 v201, v201, v87, v92
    v_max3_f32 v200, v200, v89, v90
    v_mfma_f32_16x16x32_bf16 v[4:7], a[168:171], v[52:55], v[4:7]
    v_max3_f32 v201, v201, v93, v94
    v_max3_f32 v202, v200, v201, v91
    v_max_f32 v202, v202, v95
    v_cmp_lt_f32 vcc, s64, v202
    s_cbranch_vccnz L_rare13
L_back13:
    v_mfma_f32_16x16x32_bf16 v[0:3], a[172:175], v[56:59], v[0:3]
    ds_read_b128 a[192:195], v192 offset:24576
    buffer_load_dwordx4 v241, s[32:35], s61 offen offset:3072 nt lds
    v_exp_f32 v64, v64
    v_mfma_f32_16x16x32_bf16 v[4:7], a[172:175], v[60:63], v[4:7]
    v_exp_f32 v65, v65
    v_exp_f32 v66, v66
    v_mfma_f32_16x16x32_bf16 v[8:11], a[176:179], v[32:35], v[208:211]
    s_add_u32 m0, s60, 147456
    s_waitcnt lgkmcnt(2)
    ds_read_b128 a[196:199], v193 offset:24576
    v_cvt_pk_bf16_f32 v144, v64, v65
    v_mfma_f32_16x16x32_bf16 v[12:15], a[176:179], v[36:39], v[212:215]
    s_xor_b32 s61, s12, 49152
    v_exp_f32 v67, v67
    v_exp_f32 v68, v68
    v_mfma_f32_16x16x32_bf16 v[8:11], a[180:183], v[40:43], v[8:11]
    ds_read_b128 a[200:203], v194 offset:24576
    buffer_load_dwordx4 v240, s[32:35], s61 offen offset:0 nt lds
    v_cvt_pk_bf16_f32 v145, v66, v67
    v_mfma_f32_16x16x32_bf16 v[12:15], a[180:183], v[44:47], v[12:15]
    v_max3_f32 v200, v0, v1, v2
    v_max3_f32 v201, v4, v5, v6
    v_exp_f32 v69, v69
    v_mfma_f32_16x16x32_bf16 v[8:11], a[184:187], v[48:51], v[8:11]
    s_waitcnt lgkmcnt(2)
    ds_read_b128 a[204:207], v195 offset:24576
    v_exp_f32 v70, v70
    v_cvt_pk_bf16_f32 v148, v68, v69
    v_mfma_f32_16x16x32_bf16 v[12:15], a[184:187], v[52:55], v[12:15]
    v_exp_f32 v71, v71
    v_exp_f32 v72, v72
    v_mfma_f32_16x16x32_bf16 v[8:11], a[188:191], v[56:59], v[8:11]
    ds_read_b128 a[208:211], v192 offset:28672
    v_cvt_pk_bf16_f32 v149, v70, v71
    v_mfma_f32_16x16x32_bf16 v[12:15], a[188:191], v[60:63], v[12:15]
    v_exp_f32 v73, v73
    v_exp_f32 v74, v74
    v_cvt_pk_bf16_f32 v146, v72, v73
    v_mfma_f32_16x16x32_bf16 v[16:19], a[192:195], v[32:35], v[208:211]
    s_waitcnt lgkmcnt(2)
    ds_read_b128 a[212:215], v193 offset:28672
    v_exp_f32 v75, v75
    v_mfma_f32_16x16x32_bf16 v[20:23], a[192:195], v[36:39], v[212:215]
    v_exp_f32 v76, v76
    v_cvt_pk_bf16_f32 v147, v74, v75
    v_mfma_f32_16x16x32_bf16 v[16:19], a[196:199], v[40:43], v[16:19]
    ds_read_b128 a[216:219], v194 offset:28672
    v_exp_f32 v77, v77
    v_exp_f32 v78, v78
    v_mfma_f32_16x16x32_bf16 v[20:23], a[196:199], v[44:47], v[20:23]
    v_max3_f32 v200, v200, v3, v8
    v_max3_f32 v201, v201, v7, v12
    v_max3_f32 v200, v200, v9, v10
    v_mfma_f32_16x16x32_bf16 v[16:19], a[200:203], v[48:51], v[16:19]
    s_waitcnt lgkmcnt(2)
    ds_read_b128 a[220:223], v195 offset:28672
    v_max3_f32 v201, v201, v13, v14
    v_cvt_pk_bf16_f32 v150, v76, v77
    v_mfma_f32_16x16x32_bf16 v[20:23], a[200:203], v[52:55], v[20:23]
    v_exp_f32 v79, v79
    v_exp_f32 v80, v80
    v_mfma_f32_16x16x32_bf16 v[16:19], a[204:207], v[56:59], v[16:19]
    s_waitcnt vmcnt(5)
    s_barrier
    ds_read_b128 a[160:163], v192 offset:32768
    v_cvt_pk_bf16_f32 v151, v78, v79
    v_exp_f32 v81, v81
    v_mfma_f32_16x16x32_bf16 v[20:23], a[204:207], v[60:63], v[20:23]
    v_exp_f32 v82, v82
    v_cvt_pk_bf16_f32 v152, v80, v81
    v_mfma_f32_16x16x32_bf16 v[24:27], a[208:211], v[32:35], v[208:211]
    s_waitcnt lgkmcnt(2)
    ds_read_b128 a[164:167], v193 offset:32768
    v_exp_f32 v83, v83
    v_mfma_f32_16x16x32_bf16 v[28:31], a[208:211], v[36:39], v[212:215]
    buffer_load_dwordx4 v241, s[32:35], s61 offen offset:1024 nt lds
    v_exp_f32 v84, v84
    v_cvt_pk_bf16_f32 v153, v82, v83
    v_mfma_f32_16x16x32_bf16 v[24:27], a[212:215], v[40:43], v[24:27]
    ds_read_b128 a[168:171], v194 offset:32768
    buffer_load_dwordx4 v240, s[32:35], s61 offen offset:2048 nt lds
    v_exp_f32 v85, v85
    v_mfma_f32_16x16x32_bf16 v[28:31], a[212:215], v[44:47], v[28:31]
    v_max3_f32 v200, v200, v11, v16
    v_max3_f32 v201, v201, v15, v20
    v_max3_f32 v200, v200, v17, v18
    v_mfma_f32_16x16x32_bf16 v[24:27], a[216:219], v[48:51], v[24:27]
    s_waitcnt lgkmcnt(2)
    ds_read_b128 a[172:175], v195 offset:32768
    v_max3_f32 v201, v201, v21, v22
    v_exp_f32 v86, v86
    v_mfma_f32_16x16x32_bf16 v[28:31], a[216:219], v[52:55], v[28:31]
    v_cvt_pk_bf16_f32 v156, v84, v85
    v_exp_f32 v87, v87
    v_mfma_f32_16x16x32_bf16 v[24:27], a[220:223], v[56:59], v[24:27]
    ds_read_b128 a[176:179], v192 offset:36864
    v_exp_f32 v88, v88
    v_cvt_pk_bf16_f32 v157, v86, v87
    v_mfma_f32_16x16x32_bf16 v[28:31], a[220:223], v[60:63], v[28:31]
    v_exp_f32 v89, v89
    v_exp_f32 v90, v90
    v_mfma_f32_16x16x32_bf16 v[64:67], a[160:163], v[32:35], v[208:211]
    s_waitcnt lgkmcnt(2)
    ds_read_b128 a[180:183], v193 offset:36864
    v_cvt_pk_bf16_f32 v154, v88, v89
    v_exp_f32 v91, v91
    v_mfma_f32_16x16x32_bf16 v[68:71], a[160:163], v[36:39], v[212:215]
    v_exp_f32 v92, v92
    v_cvt_pk_bf16_f32 v155, v90, v91
    v_exp_f32 v93, v93
    v_mfma_f32_16x16x32_bf16 v[64:67], a[164:167], v[40:43], v[64:67]
    ds_read_b128 a[184:187], v194 offset:36864
    v_exp_f32 v94, v94
    v_mfma_f32_16x16x32_bf16 v[68:71], a[164:167], v[44:47], v[68:71]
    v_cvt_pk_bf16_f32 v158, v92, v93
    v_exp_f32 v95, v95
    s_nop 0
    v_cvt_pk_bf16_f32 v159, v94, v95
    v_mfma_f32_16x16x32_bf16 v[64:67], a[168:171], v[48:51], v[64:67]
    s_waitcnt lgkmcnt(2)
    ds_read_b128 a[188:191], v195 offset:36864
    v_max3_f32 v200, v200, v19, v24
    v_max3_f32 v201, v201, v23, v28
    v_max3_f32 v200, v200, v25, v26
    v_mfma_f32_16x16x32_bf16 v[68:71], a[168:171], v[52:55], v[68:71]
    v_max3_f32 v201, v201, v29, v30
    v_max3_f32 v202, v200, v201, v27
    v_max_f32 v202, v202, v31
    v_cmp_lt_f32 vcc, s64, v202
    s_cbranch_vccnz L_rare14
L_back14:
    v_mfma_f32_16x16x32_bf16 v[64:67], a[172:175], v[56:59], v[64:67]
    ds_read_b128 a[192:195], v192 offset:40960
    buffer_load_dwordx4 v241, s[32:35], s61 offen offset:3072 nt lds
    v_mov_b32 v236, 0x3f803f80
    v_mov_b32 v237, 0x3f803f80
    v_mfma_f32_16x16x32_bf16 v[68:71], a[172:175], v[60:63], v[68:71]
    v_mov_b32 v238, 0x3f803f80
    v_mov_b32 v239, 0x3f803f80
    v_exp_f32 v0, v0
    v_mfma_f32_16x16x32_bf16 v[72:75], a[176:179], v[32:35], v[208:211]
    s_waitcnt lgkmcnt(2)
    ds_read_b128 a[196:199], v193 offset:40960
    v_exp_f32 v1, v1
    v_mfma_f32_16x16x32_bf16 v[76:79], a[176:179], v[36:39], v[212:215]
    v_exp_f32 v2, v2
    v_cvt_pk_bf16_f32 v160, v0, v1
    v_exp_f32 v3, v3
    v_mfma_f32_16x16x32_bf16 v[72:75], a[180:183], v[40:43], v[72:75]
    ds_read_b128 a[200:203], v194 offset:40960
    v_exp_f32 v4, v4
    v_mfma_f32_16x16x32_bf16 v[76:79], a[180:183], v[44:47], v[76:79]
    v_max3_f32 v200, v64, v65, v66
    v_max3_f32 v201, v68, v69, v70
    v_cvt_pk_bf16_f32 v161, v2, v3
    v_mfma_f32_16x16x32_bf16 v[72:75], a[184:187], v[48:51], v[72:75]
    s_waitcnt lgkmcnt(2)
    ds_read_b128 a[204:207], v195 offset:40960
    v_exp_f32 v5, v5
    v_exp_f32 v6, v6
    v_mfma_f32_16x16x32_bf16 v[76:79], a[184:187], v[52:55], v[76:79]
    v_cvt_pk_bf16_f32 v164, v4, v5
    v_exp_f32 v7, v7
    v_mfma_f32_16x16x32_bf16 v[72:75], a[188:191], v[56:59], v[72:75]
    ds_read_b128 a[208:211], v192 offset:45056
    v_exp_f32 v8, v8
    v_cvt_pk_bf16_f32 v165, v6, v7
    v_mfma_f32_16x16x32_bf16 v[76:79], a[188:191], v[60:63], v[76:79]
    v_exp_f32 v9, v9
    v_exp_f32 v10, v10
    v_mfma_f32_16x16x32_bf16 v[80:83], a[192:195], v[32:35], v[208:211]
    s_waitcnt lgkmcnt(2)
    ds_read_b128 a[212:215], v193 offset:45056
    v_cvt_pk_bf16_f32 v162, v8, v9
    v_exp_f32 v11, v11
    v_mfma_f32_16x16x32_bf16 v[84:87], a[192:195], v[36:39], v[212:215]
    v_exp_f32 v12, v12
    v_cvt_pk_bf16_f32 v163, v10, v11
    v_mfma_f32_16x16x32_bf16 v[80:83], a[196:199], v[40:43], v[80:83]
    ds_read_b128 a[216:219], v194 offset:45056
    v_exp_f32 v13, v13
    v_exp_f32 v14, v14
    v_mfma_f32_16x16x32_bf16 v[84:87], a[196:199], v[44:47], v[84:87]
    v_max3_f32 v200, v200, v67, v72
    v_max3_f32 v201, v201, v71, v76
    v_max3_f32 v200, v200, v73, v74
    v_mfma_f32_16x16x32_bf16 v[80:83], a[200:203], v[48:51], v[80:83]
    s_waitcnt lgkmcnt(2)
    ds_read_b128 a[220:223], v195 offset:45056
    v_max3_f32 v201, v201, v77, v78
    v_cvt_pk_bf16_f32 v166, v12, v13
    v_exp_f32 v15, v15
    v_mfma_f32_16x16x32_bf16 v[84:87], a[200:203], v[52:55], v[84:87]
    v_exp_f32 v16, v16
    v_cvt_pk_bf16_f32 v167, v14, v15
    v_mfma_f32_16x16x32_bf16 v[80:83], a[204:207], v[56:59], v[80:83]
    v_exp_f32 v17, v17
    v_exp_f32 v18, v18
    v_mfma_f32_16x16x32_bf16 v[84:87], a[204:207], v[60:63], v[84:87]
    v_cvt_pk_bf16_f32 v168, v16, v17
    v_exp_f32 v19, v19
    v_mfma_f32_16x16x32_bf16 v[88:91], a[208:211], v[32:35], v[208:211]
    s_waitcnt lgkmcnt(1)
    v_exp_f32 v20, v20
    v_cvt_pk_bf16_f32 v169, v18, v19
    v_exp_f32 v21, v21
    v_mfma_f32_16x16x32_bf16 v[92:95], a[208:211], v[36:39], v[212:215]
    v_exp_f32 v22, v22
    v_cvt_pk_bf16_f32 v172, v20, v21
    v_mfma_f32_16x16x32_bf16 v[88:91], a[212:215], v[40:43], v[88:91]
    s_waitcnt vmcnt(6)
    s_barrier
    ds_read_b64_tr_b16 a[160:161], v224 offset:0
    v_exp_f32 v23, v23
    v_mfma_f32_16x16x32_bf16 v[92:95], a[212:215], v[44:47], v[92:95]
    s_add_u32 m0, s60, 32768
    ds_read_b64_tr_b16 a[162:163], v224 offset:4096
    v_max3_f32 v200, v200, v75, v80
    v_max3_f32 v201, v201, v79, v84
    v_mfma_f32_16x16x32_bf16 v[88:91], a[216:219], v[48:51], v[88:91]
    s_xor_b32 s61, s12, 65536
    s_waitcnt lgkmcnt(2)
    ds_read_b64_tr_b16 a[164:165], v225 offset:0
    v_max3_f32 v200, v200, v81, v82
    v_exp_f32 v24, v24
    v_mfma_f32_16x16x32_bf16 v[92:95], a[216:219], v[52:55], v[92:95]
    ds_read_b64_tr_b16 a[166:167], v225 offset:4096
    buffer_load_dwordx4 v240, s[32:35], s61 offen offset:0 nt lds
    v_max3_f32 v201, v201, v85, v86
    v_mfma_f32_16x16x32_bf16 v[88:91], a[220:223], v[56:59], v[88:91]
    ds_read_b64_tr_b16 a[168:169], v226 offset:0
    buffer_load_dwordx4 v241, s[32:35], s61 offen offset:1024 nt lds
    v_cvt_pk_bf16_f32 v173, v22, v23
    v_exp_f32 v25, v25
    v_mfma_f32_16x16x32_bf16 v[92:95], a[220:223], v[60:63], v[92:95]
    ds_read_b64_tr_b16 a[170:171], v226 offset:4096
    v_exp_f32 v26, v26

    v_mfma_f32_16x16x32_bf16 v[192:195], v[236:239], v[96:99], 0
    s_waitcnt lgkmcnt(4)
    ds_read_b64_tr_b16 a[172:173], v227 offset:0
    v_cvt_pk_bf16_f32 v170, v24, v25
    v_exp_f32 v27, v27
    v_mfma_f32_16x16x32_bf16 v[196:199], v[236:239], v[100:103], 0
    ds_read_b64_tr_b16 a[174:175], v227 offset:4096
    v_exp_f32 v28, v28
    v_cvt_pk_bf16_f32 v171, v26, v27
    v_mfma_f32_16x16x32_bf16 v[192:195], v[236:239], v[104:107], v[192:195]
    ds_read_b64_tr_b16 a[176:177], v228 offset:0
    v_exp_f32 v29, v29
    v_exp_f32 v30, v30
    v_mfma_f32_16x16x32_bf16 v[196:199], v[236:239], v[108:111], v[196:199]
    ds_read_b64_tr_b16 a[178:179], v228 offset:4096
    v_cvt_pk_bf16_f32 v174, v28, v29
    v_exp_f32 v31, v31
    s_nop 0
    v_cvt_pk_bf16_f32 v175, v30, v31
    v_mfma_f32_16x16x32_bf16 v[0:3], a[160:163], v[96:99], 0
    s_waitcnt lgkmcnt(4)
    ds_read_b64_tr_b16 a[180:181], v229 offset:0
    v_max3_f32 v200, v200, v83, v88
    v_max3_f32 v201, v201, v87, v92
    v_max3_f32 v200, v200, v89, v90
    v_max3_f32 v201, v201, v93, v94
    v_mfma_f32_16x16x32_bf16 v[4:7], a[160:163], v[100:103], 0
    ds_read_b64_tr_b16 a[182:183], v229 offset:4096
    v_max3_f32 v202, v200, v201, v91
    v_max_f32 v202, v202, v95
    v_cmp_lt_f32 vcc, s64, v202
    s_cbranch_vccnz L_rare15
L_back15:
    v_mfma_f32_16x16x32_bf16 v[8:11], a[164:167], v[96:99], 0
    ds_read_b64_tr_b16 a[184:185], v230 offset:0
    v_exp_f32 v64, v64
    v_mfma_f32_16x16x32_bf16 v[12:15], a[164:167], v[100:103], 0
    ds_read_b64_tr_b16 a[186:187], v230 offset:4096
    v_exp_f32 v65, v65
    v_exp_f32 v66, v66
    v_mfma_f32_16x16x32_bf16 v[16:19], a[168:171], v[96:99], 0
    s_waitcnt lgkmcnt(4)
    ds_read_b64_tr_b16 a[188:189], v231 offset:0
    v_cvt_pk_bf16_f32 v176, v64, v65
    v_exp_f32 v67, v67
    v_mfma_f32_16x16x32_bf16 v[20:23], a[168:171], v[100:103], 0
    ds_read_b64_tr_b16 a[190:191], v231 offset:4096
    v_exp_f32 v68, v68
    v_mfma_f32_16x16x32_bf16 v[24:27], a[172:175], v[96:99], 0
    ds_read_b64_tr_b16 a[192:193], v224 offset:8192
    v_cvt_pk_bf16_f32 v177, v66, v67
    v_exp_f32 v69, v69
    v_mfma_f32_16x16x32_bf16 v[28:31], a[172:175], v[100:103], 0
    ds_read_b64_tr_b16 a[194:195], v224 offset:12288
    v_exp_f32 v70, v70
    v_mfma_f32_16x16x32_bf16 v[32:35], a[176:179], v[96:99], 0
    s_waitcnt lgkmcnt(4)
    ds_read_b64_tr_b16 a[196:197], v225 offset:8192
    v_cvt_pk_bf16_f32 v180, v68, v69
    v_exp_f32 v71, v71
    v_mfma_f32_16x16x32_bf16 v[36:39], a[176:179], v[100:103], 0
    ds_read_b64_tr_b16 a[198:199], v225 offset:12288
    v_exp_f32 v72, v72
    v_cvt_pk_bf16_f32 v181, v70, v71
    v_mfma_f32_16x16x32_bf16 v[40:43], a[180:183], v[96:99], 0
    ds_read_b64_tr_b16 a[200:201], v226 offset:8192
    v_exp_f32 v73, v73
    v_mfma_f32_16x16x32_bf16 v[44:47], a[180:183], v[100:103], 0
    ds_read_b64_tr_b16 a[202:203], v226 offset:12288
    v_exp_f32 v74, v74
    v_cvt_pk_bf16_f32 v178, v72, v73
    v_mfma_f32_16x16x32_bf16 v[48:51], a[184:187], v[96:99], 0
    s_waitcnt lgkmcnt(4)
    ds_read_b64_tr_b16 a[204:205], v227 offset:8192
    v_exp_f32 v75, v75
    v_mfma_f32_16x16x32_bf16 v[52:55], a[184:187], v[100:103], 0
    ds_read_b64_tr_b16 a[206:207], v227 offset:12288
    v_exp_f32 v76, v76
    v_cvt_pk_bf16_f32 v179, v74, v75
    v_mfma_f32_16x16x32_bf16 v[56:59], a[188:191], v[96:99], 0
    ds_read_b64_tr_b16 a[208:209], v228 offset:8192
    v_exp_f32 v77, v77
    v_exp_f32 v78, v78
    v_mfma_f32_16x16x32_bf16 v[60:63], a[188:191], v[100:103], 0
    ds_read_b64_tr_b16 a[210:211], v228 offset:12288
    v_cvt_pk_bf16_f32 v182, v76, v77
    v_mfma_f32_16x16x32_bf16 v[0:3], a[192:195], v[104:107], v[0:3]
    s_waitcnt lgkmcnt(4)
    ds_read_b64_tr_b16 a[212:213], v229 offset:8192
    v_exp_f32 v79, v79
    v_exp_f32 v80, v80
    v_mfma_f32_16x16x32_bf16 v[4:7], a[192:195], v[108:111], v[4:7]
    ds_read_b64_tr_b16 a[214:215], v229 offset:12288
    v_cvt_pk_bf16_f32 v183, v78, v79
    v_exp_f32 v81, v81
    v_mfma_f32_16x16x32_bf16 v[8:11], a[196:199], v[104:107], v[8:11]
    ds_read_b64_tr_b16 a[216:217], v230 offset:8192
    v_exp_f32 v82, v82
    v_mfma_f32_16x16x32_bf16 v[12:15], a[196:199], v[108:111], v[12:15]
    ds_read_b64_tr_b16 a[218:219], v230 offset:12288
    v_cvt_pk_bf16_f32 v184, v80, v81
    v_exp_f32 v83, v83
    v_mfma_f32_16x16x32_bf16 v[16:19], a[200:203], v[104:107], v[16:19]
    s_waitcnt lgkmcnt(4)
    ds_read_b64_tr_b16 a[220:221], v231 offset:8192
    v_exp_f32 v84, v84
    v_mfma_f32_16x16x32_bf16 v[20:23], a[200:203], v[108:111], v[20:23]
    ds_read_b64_tr_b16 a[222:223], v231 offset:12288
    buffer_load_dwordx4 v240, s[32:35], s61 offen offset:2048 nt lds
    v_cvt_pk_bf16_f32 v185, v82, v83
    v_exp_f32 v85, v85
    v_mfma_f32_16x16x32_bf16 v[24:27], a[204:207], v[104:107], v[24:27]
    buffer_load_dwordx4 v241, s[32:35], s61 offen offset:3072 nt lds
    v_exp_f32 v86, v86
    v_mfma_f32_16x16x32_bf16 v[28:31], a[204:207], v[108:111], v[28:31]
    v_cvt_pk_bf16_f32 v188, v84, v85
    v_exp_f32 v87, v87
    v_mfma_f32_16x16x32_bf16 v[32:35], a[208:211], v[104:107], v[32:35]
    s_waitcnt lgkmcnt(2)
    v_exp_f32 v88, v88
    v_cvt_pk_bf16_f32 v189, v86, v87
    v_exp_f32 v89, v89
    v_mfma_f32_16x16x32_bf16 v[36:39], a[208:211], v[108:111], v[36:39]
    v_exp_f32 v90, v90
    v_cvt_pk_bf16_f32 v186, v88, v89
    v_mfma_f32_16x16x32_bf16 v[40:43], a[212:215], v[104:107], v[40:43]
    s_waitcnt vmcnt(6)
    s_barrier
    ds_read_b64_tr_b16 a[160:161], v224 offset:16384
    v_exp_f32 v91, v91
    v_mfma_f32_16x16x32_bf16 v[44:47], a[212:215], v[108:111], v[44:47]
    s_add_u32 m0, s60, 81920
    ds_read_b64_tr_b16 a[162:163], v224 offset:20480
    v_exp_f32 v92, v92
    v_mfma_f32_16x16x32_bf16 v[48:51], a[216:219], v[104:107], v[48:51]
    s_xor_b32 s61, s12, 81920
    s_waitcnt lgkmcnt(2)
    ds_read_b64_tr_b16 a[164:165], v225 offset:16384
    v_cvt_pk_bf16_f32 v187, v90, v91
    v_mfma_f32_16x16x32_bf16 v[52:55], a[216:219], v[108:111], v[52:55]
    s_waitcnt vmcnt(5)
    ds_read_b64_tr_b16 a[166:167], v225 offset:20480
    buffer_load_dwordx4 v240, s[32:35], s61 offen offset:0 nt lds
    v_exp_f32 v93, v93
    v_mfma_f32_16x16x32_bf16 v[56:59], a[220:223], v[104:107], v[56:59]
    ds_read_b64_tr_b16 a[168:169], v226 offset:16384
    v_exp_f32 v94, v94
    v_cvt_pk_bf16_f32 v190, v92, v93
    v_mfma_f32_16x16x32_bf16 v[60:63], a[220:223], v[108:111], v[60:63]
    ds_read_b64_tr_b16 a[170:171], v226 offset:20480
    v_exp_f32 v95, v95
    s_nop 0
    v_cvt_pk_bf16_f32 v191, v94, v95
    s_bitcmp1_b32 s13, 1
    s_cbranch_scc1 L_resc1
L_rback1:
    v_mfma_f32_16x16x32_bf16 v[192:195], v[236:239], a[0:3], v[192:195]
    s_waitcnt lgkmcnt(4)
    ds_read_b64_tr_b16 a[172:173], v227 offset:16384
    v_mfma_f32_16x16x32_bf16 v[196:199], v[236:239], a[4:7], v[196:199]
    ds_read_b64_tr_b16 a[174:175], v227 offset:20480
    v_mfma_f32_16x16x32_bf16 v[192:195], v[236:239], a[8:11], v[192:195]
    ds_read_b64_tr_b16 a[176:177], v228 offset:16384
    v_subrev_u32 v208, 65536, v224
    v_mfma_f32_16x16x32_bf16 v[196:199], v[236:239], a[12:15], v[196:199]
    ds_read_b64_tr_b16 a[178:179], v228 offset:20480
    v_subrev_u32 v209, 65536, v225
    v_mfma_f32_16x16x32_bf16 v[0:3], a[160:163], a[0:3], v[0:3]
    s_waitcnt lgkmcnt(4)
    ds_read_b64_tr_b16 a[180:181], v229 offset:16384
    v_subrev_u32 v210, 65536, v226
    v_mfma_f32_16x16x32_bf16 v[4:7], a[160:163], a[4:7], v[4:7]
    ds_read_b64_tr_b16 a[182:183], v229 offset:20480
    v_subrev_u32 v211, 65536, v227
    v_mfma_f32_16x16x32_bf16 v[8:11], a[164:167], a[0:3], v[8:11]
    s_waitcnt vmcnt(5)
    ds_read_b64_tr_b16 a[184:185], v230 offset:16384
    buffer_load_dwordx4 v241, s[32:35], s61 offen offset:1024 nt lds
    v_subrev_u32 v212, 65536, v228
    v_mfma_f32_16x16x32_bf16 v[12:15], a[164:167], a[4:7], v[12:15]
    ds_read_b64_tr_b16 a[186:187], v230 offset:20480
    v_subrev_u32 v213, 65536, v229
    v_mfma_f32_16x16x32_bf16 v[16:19], a[168:171], a[0:3], v[16:19]
    s_waitcnt lgkmcnt(4)
    ds_read_b64_tr_b16 a[188:189], v231 offset:16384
    v_subrev_u32 v214, 65536, v230
    v_mfma_f32_16x16x32_bf16 v[20:23], a[168:171], a[4:7], v[20:23]
    ds_read_b64_tr_b16 a[190:191], v231 offset:20480
    v_subrev_u32 v215, 65536, v231
    v_mfma_f32_16x16x32_bf16 v[24:27], a[172:175], a[0:3], v[24:27]
    ds_read_b64_tr_b16 a[192:193], v224 offset:24576
    v_mfma_f32_16x16x32_bf16 v[28:31], a[172:175], a[4:7], v[28:31]
    ds_read_b64_tr_b16 a[194:195], v224 offset:28672
    v_mfma_f32_16x16x32_bf16 v[32:35], a[176:179], a[0:3], v[32:35]
    s_waitcnt lgkmcnt(4)
    ds_read_b64_tr_b16 a[196:197], v225 offset:24576
    v_mfma_f32_16x16x32_bf16 v[36:39], a[176:179], a[4:7], v[36:39]
    ds_read_b64_tr_b16 a[198:199], v225 offset:28672
    v_mfma_f32_16x16x32_bf16 v[40:43], a[180:183], a[0:3], v[40:43]
    ds_read_b64_tr_b16 a[200:201], v226 offset:24576
    v_mfma_f32_16x16x32_bf16 v[44:47], a[180:183], a[4:7], v[44:47]
    s_waitcnt vmcnt(5)
    ds_read_b64_tr_b16 a[202:203], v226 offset:28672
    buffer_load_dwordx4 v240, s[32:35], s61 offen offset:2048 nt lds
    v_mfma_f32_16x16x32_bf16 v[48:51], a[184:187], a[0:3], v[48:51]
    s_waitcnt lgkmcnt(4)
    ds_read_b64_tr_b16 a[204:205], v227 offset:24576
    v_mfma_f32_16x16x32_bf16 v[52:55], a[184:187], a[4:7], v[52:55]
    ds_read_b64_tr_b16 a[206:207], v227 offset:28672
    v_mfma_f32_16x16x32_bf16 v[56:59], a[188:191], a[0:3], v[56:59]
    ds_read_b64_tr_b16 a[208:209], v228 offset:24576
    v_mfma_f32_16x16x32_bf16 v[60:63], a[188:191], a[4:7], v[60:63]
    ds_read_b64_tr_b16 a[210:211], v228 offset:28672
    v_mfma_f32_16x16x32_bf16 v[0:3], a[192:195], a[8:11], v[0:3]
    s_waitcnt lgkmcnt(4)
    ds_read_b64_tr_b16 a[212:213], v229 offset:24576
    v_mfma_f32_16x16x32_bf16 v[4:7], a[192:195], a[12:15], v[4:7]
    ds_read_b64_tr_b16 a[214:215], v229 offset:28672
    v_mfma_f32_16x16x32_bf16 v[8:11], a[196:199], a[8:11], v[8:11]
    ds_read_b64_tr_b16 a[216:217], v230 offset:24576
    v_mfma_f32_16x16x32_bf16 v[12:15], a[196:199], a[12:15], v[12:15]
    ds_read_b64_tr_b16 a[218:219], v230 offset:28672
    v_mfma_f32_16x16x32_bf16 v[16:19], a[200:203], a[8:11], v[16:19]
    s_waitcnt vmcnt(5)
    s_waitcnt lgkmcnt(4)
    ds_read_b64_tr_b16 a[220:221], v231 offset:24576
    buffer_load_dwordx4 v241, s[32:35], s61 offen offset:3072 nt lds
    v_mfma_f32_16x16x32_bf16 v[20:23], a[200:203], a[12:15], v[20:23]
    ds_read_b64_tr_b16 a[222:223], v231 offset:28672
    v_mfma_f32_16x16x32_bf16 v[24:27], a[204:207], a[8:11], v[24:27]
    v_mfma_f32_16x16x32_bf16 v[28:31], a[204:207], a[12:15], v[28:31]
    v_mfma_f32_16x16x32_bf16 v[32:35], a[208:211], a[8:11], v[32:35]
    s_waitcnt lgkmcnt(2)
    v_mfma_f32_16x16x32_bf16 v[36:39], a[208:211], a[12:15], v[36:39]
    v_mfma_f32_16x16x32_bf16 v[40:43], a[212:215], a[8:11], v[40:43]
    s_waitcnt vmcnt(6)
    s_barrier
    ds_read_b64_tr_b16 a[160:161], v224 offset:32768
    v_mfma_f32_16x16x32_bf16 v[44:47], a[212:215], a[12:15], v[44:47]
    s_add_u32 m0, s60, 49152
    ds_read_b64_tr_b16 a[162:163], v224 offset:36864
    v_mfma_f32_16x16x32_bf16 v[48:51], a[216:219], a[8:11], v[48:51]
    s_xor_b32 s61, s12, 98304
    s_waitcnt lgkmcnt(2)
    ds_read_b64_tr_b16 a[164:165], v225 offset:32768
    v_mfma_f32_16x16x32_bf16 v[52:55], a[216:219], a[12:15], v[52:55]
    s_waitcnt vmcnt(5)
    ds_read_b64_tr_b16 a[166:167], v225 offset:36864
    buffer_load_dwordx4 v240, s[32:35], s61 offen offset:0 nt lds
    v_mfma_f32_16x16x32_bf16 v[56:59], a[220:223], a[8:11], v[56:59]
    ds_read_b64_tr_b16 a[168:169], v226 offset:32768
    v_mfma_f32_16x16x32_bf16 v[60:63], a[220:223], a[12:15], v[60:63]
    ds_read_b64_tr_b16 a[170:171], v226 offset:36864
    s_bitcmp1_b32 s13, 2
    s_cbranch_scc1 L_resc2
L_rback2:
    v_mfma_f32_16x16x32_bf16 v[192:195], v[236:239], a[16:19], v[192:195]
    s_waitcnt lgkmcnt(4)
    ds_read_b64_tr_b16 a[172:173], v227 offset:32768
    v_mfma_f32_16x16x32_bf16 v[196:199], v[236:239], a[20:23], v[196:199]
    ds_read_b64_tr_b16 a[174:175], v227 offset:36864
    v_mfma_f32_16x16x32_bf16 v[192:195], v[236:239], a[24:27], v[192:195]
    ds_read_b64_tr_b16 a[176:177], v228 offset:32768
    v_mfma_f32_16x16x32_bf16 v[196:199], v[236:239], a[28:31], v[196:199]
    ds_read_b64_tr_b16 a[178:179], v228 offset:36864
    v_mfma_f32_16x16x32_bf16 v[0:3], a[160:163], a[16:19], v[0:3]
    s_waitcnt lgkmcnt(4)
    ds_read_b64_tr_b16 a[180:181], v229 offset:32768
    v_mfma_f32_16x16x32_bf16 v[4:7], a[160:163], a[20:23], v[4:7]
    ds_read_b64_tr_b16 a[182:183], v229 offset:36864
    v_mfma_f32_16x16x32_bf16 v[8:11], a[164:167], a[16:19], v[8:11]
    ds_read_b64_tr_b16 a[184:185], v230 offset:32768
    v_mfma_f32_16x16x32_bf16 v[12:15], a[164:167], a[20:23], v[12:15]
    ds_read_b64_tr_b16 a[186:187], v230 offset:36864
    v_mfma_f32_16x16x32_bf16 v[16:19], a[168:171], a[16:19], v[16:19]
    s_waitcnt lgkmcnt(4)
    ds_read_b64_tr_b16 a[188:189], v231 offset:32768
    v_mfma_f32_16x16x32_bf16 v[20:23], a[168:171], a[20:23], v[20:23]
    s_waitcnt vmcnt(5)
    ds_read_b64_tr_b16 a[190:191], v231 offset:36864
    buffer_load_dwordx4 v241, s[32:35], s61 offen offset:1024 nt lds
    v_mfma_f32_16x16x32_bf16 v[24:27], a[172:175], a[16:19], v[24:27]
    ds_read_b64_tr_b16 a[192:193], v224 offset:40960
    v_mfma_f32_16x16x32_bf16 v[28:31], a[172:175], a[20:23], v[28:31]
    ds_read_b64_tr_b16 a[194:195], v224 offset:45056
    v_mfma_f32_16x16x32_bf16 v[32:35], a[176:179], a[16:19], v[32:35]
    s_waitcnt lgkmcnt(4)
    ds_read_b64_tr_b16 a[196:197], v225 offset:40960
    v_mfma_f32_16x16x32_bf16 v[36:39], a[176:179], a[20:23], v[36:39]
    ds_read_b64_tr_b16 a[198:199], v225 offset:45056
    v_mfma_f32_16x16x32_bf16 v[40:43], a[180:183], a[16:19], v[40:43]
    ds_read_b64_tr_b16 a[200:201], v226 offset:40960
    v_mfma_f32_16x16x32_bf16 v[44:47], a[180:183], a[20:23], v[44:47]
    ds_read_b64_tr_b16 a[202:203], v226 offset:45056
    v_mfma_f32_16x16x32_bf16 v[48:51], a[184:187], a[16:19], v[48:51]
    s_waitcnt lgkmcnt(4)
    ds_read_b64_tr_b16 a[204:205], v227 offset:40960
    v_mfma_f32_16x16x32_bf16 v[52:55], a[184:187], a[20:23], v[52:55]
    ds_read_b64_tr_b16 a[206:207], v227 offset:45056
    v_mfma_f32_16x16x32_bf16 v[56:59], a[188:191], a[16:19], v[56:59]
    ds_read_b64_tr_b16 a[208:209], v228 offset:40960
    v_mfma_f32_16x16x32_bf16 v[60:63], a[188:191], a[20:23], v[60:63]
    ds_read_b64_tr_b16 a[210:211], v228 offset:45056
    v_mfma_f32_16x16x32_bf16 v[0:3], a[192:195], a[24:27], v[0:3]
    s_waitcnt lgkmcnt(4)
    ds_read_b64_tr_b16 a[212:213], v229 offset:40960
    v_mfma_f32_16x16x32_bf16 v[4:7], a[192:195], a[28:31], v[4:7]
    s_waitcnt vmcnt(5)
    ds_read_b64_tr_b16 a[214:215], v229 offset:45056
    buffer_load_dwordx4 v240, s[32:35], s61 offen offset:2048 nt lds
    v_mfma_f32_16x16x32_bf16 v[8:11], a[196:199], a[24:27], v[8:11]
    ds_read_b64_tr_b16 a[216:217], v230 offset:40960
    v_mfma_f32_16x16x32_bf16 v[12:15], a[196:199], a[28:31], v[12:15]
    ds_read_b64_tr_b16 a[218:219], v230 offset:45056
    v_mfma_f32_16x16x32_bf16 v[16:19], a[200:203], a[24:27], v[16:19]
    s_waitcnt lgkmcnt(4)
    ds_read_b64_tr_b16 a[220:221], v231 offset:40960
    v_mfma_f32_16x16x32_bf16 v[20:23], a[200:203], a[28:31], v[20:23]
    ds_read_b64_tr_b16 a[222:223], v231 offset:45056
    v_mfma_f32_16x16x32_bf16 v[24:27], a[204:207], a[24:27], v[24:27]
    v_mfma_f32_16x16x32_bf16 v[28:31], a[204:207], a[28:31], v[28:31]
    v_mfma_f32_16x16x32_bf16 v[32:35], a[208:211], a[24:27], v[32:35]
    s_waitcnt lgkmcnt(2)
    v_mfma_f32_16x16x32_bf16 v[36:39], a[208:211], a[28:31], v[36:39]
    v_mfma_f32_16x16x32_bf16 v[40:43], a[212:215], a[24:27], v[40:43]
    s_waitcnt vmcnt(6)
    s_barrier
    ds_read_b64_tr_b16 a[160:161], v224 offset:49152
    v_mfma_f32_16x16x32_bf16 v[44:47], a[212:215], a[28:31], v[44:47]
    ds_read_b64_tr_b16 a[162:163], v224 offset:53248
    v_mfma_f32_16x16x32_bf16 v[48:51], a[216:219], a[24:27], v[48:51]
    s_waitcnt lgkmcnt(2)
    ds_read_b64_tr_b16 a[164:165], v225 offset:49152
    v_mfma_f32_16x16x32_bf16 v[52:55], a[216:219], a[28:31], v[52:55]
    s_waitcnt vmcnt(5)
    ds_read_b64_tr_b16 a[166:167], v225 offset:53248
    buffer_load_dwordx4 v241, s[32:35], s61 offen offset:3072 nt lds
    v_mfma_f32_16x16x32_bf16 v[56:59], a[220:223], a[24:27], v[56:59]
    ds_read_b64_tr_b16 a[168:169], v226 offset:49152
    v_mfma_f32_16x16x32_bf16 v[60:63], a[220:223], a[28:31], v[60:63]
    ds_read_b64_tr_b16 a[170:171], v226 offset:53248
    s_bitcmp1_b32 s13, 3
    s_cbranch_scc1 L_resc3
L_rback3:
    v_mfma_f32_16x16x32_bf16 v[192:195], v[236:239], a[32:35], v[192:195]
    s_waitcnt lgkmcnt(4)
    ds_read_b64_tr_b16 a[172:173], v227 offset:49152
    v_mfma_f32_16x16x32_bf16 v[196:199], v[236:239], a[36:39], v[196:199]
    ds_read_b64_tr_b16 a[174:175], v227 offset:53248
    v_mfma_f32_16x16x32_bf16 v[192:195], v[236:239], a[40:43], v[192:195]
    ds_read_b64_tr_b16 a[176:177], v228 offset:49152
    v_mfma_f32_16x16x32_bf16 v[196:199], v[236:239], a[44:47], v[196:199]
    ds_read_b64_tr_b16 a[178:179], v228 offset:53248
    v_mfma_f32_16x16x32_bf16 v[0:3], a[160:163], a[32:35], v[0:3]
    s_add_u32 m0, s60, 65536
    s_waitcnt lgkmcnt(4)
    ds_read_b64_tr_b16 a[180:181], v229 offset:49152
    v_mfma_f32_16x16x32_bf16 v[4:7], a[160:163], a[36:39], v[4:7]
    s_xor_b32 s61, s12, 114688
    ds_read_b64_tr_b16 a[182:183], v229 offset:53248
    v_mfma_f32_16x16x32_bf16 v[8:11], a[164:167], a[32:35], v[8:11]
    s_waitcnt vmcnt(5)
    ds_read_b64_tr_b16 a[184:185], v230 offset:49152
    buffer_load_dwordx4 v240, s[32:35], s61 offen offset:0 nt lds
    v_mfma_f32_16x16x32_bf16 v[12:15], a[164:167], a[36:39], v[12:15]
    ds_read_b64_tr_b16 a[186:187], v230 offset:53248
    v_mfma_f32_16x16x32_bf16 v[16:19], a[168:171], a[32:35], v[16:19]
    s_waitcnt lgkmcnt(4)
    ds_read_b64_tr_b16 a[188:189], v231 offset:49152
    v_mfma_f32_16x16x32_bf16 v[20:23], a[168:171], a[36:39], v[20:23]
    ds_read_b64_tr_b16 a[190:191], v231 offset:53248
    v_mfma_f32_16x16x32_bf16 v[24:27], a[172:175], a[32:35], v[24:27]
    ds_read_b64_tr_b16 a[192:193], v224 offset:57344
    v_mfma_f32_16x16x32_bf16 v[28:31], a[172:175], a[36:39], v[28:31]
    ds_read_b64_tr_b16 a[194:195], v224 offset:61440
    v_mfma_f32_16x16x32_bf16 v[32:35], a[176:179], a[32:35], v[32:35]
    s_waitcnt lgkmcnt(4)
    ds_read_b64_tr_b16 a[196:197], v225 offset:57344
    v_mfma_f32_16x16x32_bf16 v[36:39], a[176:179], a[36:39], v[36:39]
    ds_read_b64_tr_b16 a[198:199], v225 offset:61440
    v_mfma_f32_16x16x32_bf16 v[40:43], a[180:183], a[32:35], v[40:43]
    ds_read_b64_tr_b16 a[200:201], v226 offset:57344
    v_mfma_f32_16x16x32_bf16 v[44:47], a[180:183], a[36:39], v[44:47]
    s_waitcnt vmcnt(5)
    ds_read_b64_tr_b16 a[202:203], v226 offset:61440
    buffer_load_dwordx4 v241, s[32:35], s61 offen offset:1024 nt lds
    v_mfma_f32_16x16x32_bf16 v[48:51], a[184:187], a[32:35], v[48:51]
    s_waitcnt lgkmcnt(4)
    ds_read_b64_tr_b16 a[204:205], v227 offset:57344
    v_mfma_f32_16x16x32_bf16 v[52:55], a[184:187], a[36:39], v[52:55]
    ds_read_b64_tr_b16 a[206:207], v227 offset:61440
    v_mfma_f32_16x16x32_bf16 v[56:59], a[188:191], a[32:35], v[56:59]
    ds_read_b64_tr_b16 a[208:209], v228 offset:57344
    v_mfma_f32_16x16x32_bf16 v[60:63], a[188:191], a[36:39], v[60:63]
    ds_read_b64_tr_b16 a[210:211], v228 offset:61440
    v_mfma_f32_16x16x32_bf16 v[0:3], a[192:195], a[40:43], v[0:3]
    s_waitcnt lgkmcnt(4)
    ds_read_b64_tr_b16 a[212:213], v229 offset:57344
    v_mfma_f32_16x16x32_bf16 v[4:7], a[192:195], a[44:47], v[4:7]
    ds_read_b64_tr_b16 a[214:215], v229 offset:61440
    v_mfma_f32_16x16x32_bf16 v[8:11], a[196:199], a[40:43], v[8:11]
    ds_read_b64_tr_b16 a[216:217], v230 offset:57344
    v_mfma_f32_16x16x32_bf16 v[12:15], a[196:199], a[44:47], v[12:15]
    ds_read_b64_tr_b16 a[218:219], v230 offset:61440
    v_mfma_f32_16x16x32_bf16 v[16:19], a[200:203], a[40:43], v[16:19]
    s_waitcnt vmcnt(5)
    s_waitcnt lgkmcnt(4)
    ds_read_b64_tr_b16 a[220:221], v231 offset:57344
    buffer_load_dwordx4 v240, s[32:35], s61 offen offset:2048 nt lds
    v_mfma_f32_16x16x32_bf16 v[20:23], a[200:203], a[44:47], v[20:23]
    ds_read_b64_tr_b16 a[222:223], v231 offset:61440
    v_mfma_f32_16x16x32_bf16 v[24:27], a[204:207], a[40:43], v[24:27]
    v_mfma_f32_16x16x32_bf16 v[28:31], a[204:207], a[44:47], v[28:31]
    v_mfma_f32_16x16x32_bf16 v[32:35], a[208:211], a[40:43], v[32:35]
    s_waitcnt lgkmcnt(2)
    v_mfma_f32_16x16x32_bf16 v[36:39], a[208:211], a[44:47], v[36:39]
    v_mfma_f32_16x16x32_bf16 v[40:43], a[212:215], a[40:43], v[40:43]
    s_waitcnt vmcnt(6)
    s_barrier
    ds_read_b64_tr_b16 a[160:161], v208 offset:0
    v_mfma_f32_16x16x32_bf16 v[44:47], a[212:215], a[44:47], v[44:47]
    ds_read_b64_tr_b16 a[162:163], v208 offset:4096
    v_mfma_f32_16x16x32_bf16 v[48:51], a[216:219], a[40:43], v[48:51]
    s_waitcnt lgkmcnt(2)
    ds_read_b64_tr_b16 a[164:165], v209 offset:0
    v_mfma_f32_16x16x32_bf16 v[52:55], a[216:219], a[44:47], v[52:55]
    s_waitcnt vmcnt(5)
    ds_read_b64_tr_b16 a[166:167], v209 offset:4096
    buffer_load_dwordx4 v241, s[32:35], s61 offen offset:3072 nt lds
    v_mfma_f32_16x16x32_bf16 v[56:59], a[220:223], a[40:43], v[56:59]
    ds_read_b64_tr_b16 a[168:169], v210 offset:0
    v_mfma_f32_16x16x32_bf16 v[60:63], a[220:223], a[44:47], v[60:63]
    ds_read_b64_tr_b16 a[170:171], v210 offset:4096
    s_bitcmp1_b32 s13, 4
    s_cbranch_scc1 L_resc4
L_rback4:
    v_mfma_f32_16x16x32_bf16 v[192:195], v[236:239], a[48:51], v[192:195]
    s_waitcnt lgkmcnt(4)
    ds_read_b64_tr_b16 a[172:173], v211 offset:0
    v_mfma_f32_16x16x32_bf16 v[196:199], v[236:239], a[52:55], v[196:199]
    ds_read_b64_tr_b16 a[174:175], v211 offset:4096
    v_mfma_f32_16x16x32_bf16 v[192:195], v[236:239], a[56:59], v[192:195]
    ds_read_b64_tr_b16 a[176:177], v212 offset:0
    v_mfma_f32_16x16x32_bf16 v[196:199], v[236:239], a[60:63], v[196:199]
    ds_read_b64_tr_b16 a[178:179], v212 offset:4096
    v_mfma_f32_16x16x32_bf16 v[0:3], a[160:163], a[48:51], v[0:3]
    s_waitcnt lgkmcnt(4)
    ds_read_b64_tr_b16 a[180:181], v213 offset:0
    v_mfma_f32_16x16x32_bf16 v[4:7], a[160:163], a[52:55], v[4:7]
    ds_read_b64_tr_b16 a[182:183], v213 offset:4096
    v_mfma_f32_16x16x32_bf16 v[8:11], a[164:167], a[48:51], v[8:11]
    ds_read_b64_tr_b16 a[184:185], v214 offset:0
    v_mfma_f32_16x16x32_bf16 v[12:15], a[164:167], a[52:55], v[12:15]
    s_add_u32 m0, s60, 98304
    ds_read_b64_tr_b16 a[186:187], v214 offset:4096
    v_mfma_f32_16x16x32_bf16 v[16:19], a[168:171], a[48:51], v[16:19]
    s_xor_b32 s61, s12, 131072
    s_waitcnt lgkmcnt(4)
    ds_read_b64_tr_b16 a[188:189], v215 offset:0
    v_mfma_f32_16x16x32_bf16 v[20:23], a[168:171], a[52:55], v[20:23]
    s_waitcnt vmcnt(5)
    ds_read_b64_tr_b16 a[190:191], v215 offset:4096
    buffer_load_dwordx4 v240, s[32:35], s61 offen offset:0 nt lds
    v_mfma_f32_16x16x32_bf16 v[24:27], a[172:175], a[48:51], v[24:27]
    ds_read_b64_tr_b16 a[192:193], v208 offset:8192
    v_mfma_f32_16x16x32_bf16 v[28:31], a[172:175], a[52:55], v[28:31]
    ds_read_b64_tr_b16 a[194:195], v208 offset:12288
    v_mfma_f32_16x16x32_bf16 v[32:35], a[176:179], a[48:51], v[32:35]
    s_waitcnt lgkmcnt(4)
    ds_read_b64_tr_b16 a[196:197], v209 offset:8192
    v_mfma_f32_16x16x32_bf16 v[36:39], a[176:179], a[52:55], v[36:39]
    ds_read_b64_tr_b16 a[198:199], v209 offset:12288
    v_mfma_f32_16x16x32_bf16 v[40:43], a[180:183], a[48:51], v[40:43]
    ds_read_b64_tr_b16 a[200:201], v210 offset:8192
    v_mfma_f32_16x16x32_bf16 v[44:47], a[180:183], a[52:55], v[44:47]
    ds_read_b64_tr_b16 a[202:203], v210 offset:12288
    v_mfma_f32_16x16x32_bf16 v[48:51], a[184:187], a[48:51], v[48:51]
    s_waitcnt lgkmcnt(4)
    ds_read_b64_tr_b16 a[204:205], v211 offset:8192
    v_mfma_f32_16x16x32_bf16 v[52:55], a[184:187], a[52:55], v[52:55]
    ds_read_b64_tr_b16 a[206:207], v211 offset:12288
    v_mfma_f32_16x16x32_bf16 v[56:59], a[188:191], a[48:51], v[56:59]
    ds_read_b64_tr_b16 a[208:209], v212 offset:8192
    v_mfma_f32_16x16x32_bf16 v[60:63], a[188:191], a[52:55], v[60:63]
    ds_read_b64_tr_b16 a[210:211], v212 offset:12288
    v_mfma_f32_16x16x32_bf16 v[0:3], a[192:195], a[56:59], v[0:3]
    s_waitcnt lgkmcnt(4)
    ds_read_b64_tr_b16 a[212:213], v213 offset:8192
    v_mfma_f32_16x16x32_bf16 v[4:7], a[192:195], a[60:63], v[4:7]
    s_waitcnt vmcnt(5)
    ds_read_b64_tr_b16 a[214:215], v213 offset:12288
    buffer_load_dwordx4 v241, s[32:35], s61 offen offset:1024 nt lds
    v_mfma_f32_16x16x32_bf16 v[8:11], a[196:199], a[56:59], v[8:11]
    ds_read_b64_tr_b16 a[216:217], v214 offset:8192
    v_mfma_f32_16x16x32_bf16 v[12:15], a[196:199], a[60:63], v[12:15]
    ds_read_b64_tr_b16 a[218:219], v214 offset:12288
    v_mfma_f32_16x16x32_bf16 v[16:19], a[200:203], a[56:59], v[16:19]
    s_waitcnt lgkmcnt(4)
    ds_read_b64_tr_b16 a[220:221], v215 offset:8192
    v_mfma_f32_16x16x32_bf16 v[20:23], a[200:203], a[60:63], v[20:23]
    ds_read_b64_tr_b16 a[222:223], v215 offset:12288
    v_mfma_f32_16x16x32_bf16 v[24:27], a[204:207], a[56:59], v[24:27]
    v_mfma_f32_16x16x32_bf16 v[28:31], a[204:207], a[60:63], v[28:31]
    v_mfma_f32_16x16x32_bf16 v[32:35], a[208:211], a[56:59], v[32:35]
    s_waitcnt lgkmcnt(2)
    v_mfma_f32_16x16x32_bf16 v[36:39], a[208:211], a[60:63], v[36:39]
    v_mfma_f32_16x16x32_bf16 v[40:43], a[212:215], a[56:59], v[40:43]
    s_waitcnt vmcnt(6)
    s_barrier
    ds_read_b64_tr_b16 a[160:161], v208 offset:49152
    v_mfma_f32_16x16x32_bf16 v[44:47], a[212:215], a[60:63], v[44:47]
    ds_read_b64_tr_b16 a[162:163], v208 offset:53248
    v_mfma_f32_16x16x32_bf16 v[48:51], a[216:219], a[56:59], v[48:51]
    s_waitcnt lgkmcnt(2)
    ds_read_b64_tr_b16 a[164:165], v209 offset:49152
    v_mfma_f32_16x16x32_bf16 v[52:55], a[216:219], a[60:63], v[52:55]
    s_waitcnt vmcnt(5)
    ds_read_b64_tr_b16 a[166:167], v209 offset:53248
    buffer_load_dwordx4 v240, s[32:35], s61 offen offset:2048 nt lds
    v_mfma_f32_16x16x32_bf16 v[56:59], a[220:223], a[56:59], v[56:59]
    ds_read_b64_tr_b16 a[168:169], v210 offset:49152
    v_mfma_f32_16x16x32_bf16 v[60:63], a[220:223], a[60:63], v[60:63]
    ds_read_b64_tr_b16 a[170:171], v210 offset:53248
    s_bitcmp1_b32 s13, 5
    s_cbranch_scc1 L_resc5
L_rback5:
    v_mfma_f32_16x16x32_bf16 v[192:195], v[236:239], a[64:67], v[192:195]
    s_waitcnt lgkmcnt(4)
    ds_read_b64_tr_b16 a[172:173], v211 offset:49152
    v_mfma_f32_16x16x32_bf16 v[196:199], v[236:239], a[68:71], v[196:199]
    ds_read_b64_tr_b16 a[174:175], v211 offset:53248
    v_mfma_f32_16x16x32_bf16 v[192:195], v[236:239], a[72:75], v[192:195]
    ds_read_b64_tr_b16 a[176:177], v212 offset:49152
    v_mfma_f32_16x16x32_bf16 v[196:199], v[236:239], a[76:79], v[196:199]
    ds_read_b64_tr_b16 a[178:179], v212 offset:53248
    v_mfma_f32_16x16x32_bf16 v[0:3], a[160:163], a[64:67], v[0:3]
    s_waitcnt lgkmcnt(4)
    ds_read_b64_tr_b16 a[180:181], v213 offset:49152
    v_mfma_f32_16x16x32_bf16 v[4:7], a[160:163], a[68:71], v[4:7]
    ds_read_b64_tr_b16 a[182:183], v213 offset:53248
    v_mfma_f32_16x16x32_bf16 v[8:11], a[164:167], a[64:67], v[8:11]
    ds_read_b64_tr_b16 a[184:185], v214 offset:49152
    v_mfma_f32_16x16x32_bf16 v[12:15], a[164:167], a[68:71], v[12:15]
    ds_read_b64_tr_b16 a[186:187], v214 offset:53248
    v_mfma_f32_16x16x32_bf16 v[16:19], a[168:171], a[64:67], v[16:19]
    s_waitcnt lgkmcnt(4)
    ds_read_b64_tr_b16 a[188:189], v215 offset:49152
    v_mfma_f32_16x16x32_bf16 v[20:23], a[168:171], a[68:71], v[20:23]
    s_waitcnt vmcnt(5)
    ds_read_b64_tr_b16 a[190:191], v215 offset:53248
    buffer_load_dwordx4 v241, s[32:35], s61 offen offset:3072 nt lds
    v_mfma_f32_16x16x32_bf16 v[24:27], a[172:175], a[64:67], v[24:27]
    ds_read_b64_tr_b16 a[192:193], v208 offset:57344
    v_mfma_f32_16x16x32_bf16 v[28:31], a[172:175], a[68:71], v[28:31]
    ds_read_b64_tr_b16 a[194:195], v208 offset:61440
    v_mfma_f32_16x16x32_bf16 v[32:35], a[176:179], a[64:67], v[32:35]
    s_waitcnt lgkmcnt(4)
    ds_read_b64_tr_b16 a[196:197], v209 offset:57344
    v_mfma_f32_16x16x32_bf16 v[36:39], a[176:179], a[68:71], v[36:39]
    ds_read_b64_tr_b16 a[198:199], v209 offset:61440
    v_mfma_f32_16x16x32_bf16 v[40:43], a[180:183], a[64:67], v[40:43]
    ds_read_b64_tr_b16 a[200:201], v210 offset:57344
    v_mfma_f32_16x16x32_bf16 v[44:47], a[180:183], a[68:71], v[44:47]
    ds_read_b64_tr_b16 a[202:203], v210 offset:61440
    v_mfma_f32_16x16x32_bf16 v[48:51], a[184:187], a[64:67], v[48:51]
    s_waitcnt lgkmcnt(4)
    ds_read_b64_tr_b16 a[204:205], v211 offset:57344
    v_mfma_f32_16x16x32_bf16 v[52:55], a[184:187], a[68:71], v[52:55]
    ds_read_b64_tr_b16 a[206:207], v211 offset:61440
    v_mfma_f32_16x16x32_bf16 v[56:59], a[188:191], a[64:67], v[56:59]
    ds_read_b64_tr_b16 a[208:209], v212 offset:57344
    v_mfma_f32_16x16x32_bf16 v[60:63], a[188:191], a[68:71], v[60:63]
    s_add_u32 m0, s60, 114688
    ds_read_b64_tr_b16 a[210:211], v212 offset:61440
    v_mfma_f32_16x16x32_bf16 v[0:3], a[192:195], a[72:75], v[0:3]
    s_xor_b32 s61, s12, 147456
    s_waitcnt lgkmcnt(4)
    ds_read_b64_tr_b16 a[212:213], v213 offset:57344
    v_mfma_f32_16x16x32_bf16 v[4:7], a[192:195], a[76:79], v[4:7]
    s_waitcnt vmcnt(5)
    ds_read_b64_tr_b16 a[214:215], v213 offset:61440
    buffer_load_dwordx4 v240, s[32:35], s61 offen offset:0 nt lds
    v_mfma_f32_16x16x32_bf16 v[8:11], a[196:199], a[72:75], v[8:11]
    ds_read_b64_tr_b16 a[216:217], v214 offset:57344
    v_mfma_f32_16x16x32_bf16 v[12:15], a[196:199], a[76:79], v[12:15]
    ds_read_b64_tr_b16 a[218:219], v214 offset:61440
    v_mfma_f32_16x16x32_bf16 v[16:19], a[200:203], a[72:75], v[16:19]
    s_waitcnt lgkmcnt(4)
    ds_read_b64_tr_b16 a[220:221], v215 offset:57344
    v_mfma_f32_16x16x32_bf16 v[20:23], a[200:203], a[76:79], v[20:23]
    ds_read_b64_tr_b16 a[222:223], v215 offset:61440
    v_mfma_f32_16x16x32_bf16 v[24:27], a[204:207], a[72:75], v[24:27]
    v_mfma_f32_16x16x32_bf16 v[28:31], a[204:207], a[76:79], v[28:31]
    v_mfma_f32_16x16x32_bf16 v[32:35], a[208:211], a[72:75], v[32:35]
    s_waitcnt lgkmcnt(2)
    v_mfma_f32_16x16x32_bf16 v[36:39], a[208:211], a[76:79], v[36:39]
    v_mfma_f32_16x16x32_bf16 v[40:43], a[212:215], a[72:75], v[40:43]
    s_waitcnt vmcnt(6)
    s_barrier
    ds_read_b64_tr_b16 a[160:161], v208 offset:16384
    v_mfma_f32_16x16x32_bf16 v[44:47], a[212:215], a[76:79], v[44:47]
    ds_read_b64_tr_b16 a[162:163], v208 offset:20480
    v_mfma_f32_16x16x32_bf16 v[48:51], a[216:219], a[72:75], v[48:51]
    s_waitcnt lgkmcnt(2)
    ds_read_b64_tr_b16 a[164:165], v209 offset:16384
    v_mfma_f32_16x16x32_bf16 v[52:55], a[216:219], a[76:79], v[52:55]
    s_waitcnt vmcnt(5)
    ds_read_b64_tr_b16 a[166:167], v209 offset:20480
    buffer_load_dwordx4 v241, s[32:35], s61 offen offset:1024 nt lds
    v_mfma_f32_16x16x32_bf16 v[56:59], a[220:223], a[72:75], v[56:59]
    ds_read_b64_tr_b16 a[168:169], v210 offset:16384
    v_mfma_f32_16x16x32_bf16 v[60:63], a[220:223], a[76:79], v[60:63]
    ds_read_b64_tr_b16 a[170:171], v210 offset:20480
    s_bitcmp1_b32 s13, 6
    s_cbranch_scc1 L_resc6
L_rback6:
    v_mfma_f32_16x16x32_bf16 v[192:195], v[236:239], a[80:83], v[192:195]
    s_waitcnt lgkmcnt(4)
    ds_read_b64_tr_b16 a[172:173], v211 offset:16384
    v_mfma_f32_16x16x32_bf16 v[196:199], v[236:239], a[84:87], v[196:199]
    ds_read_b64_tr_b16 a[174:175], v211 offset:20480
    v_mfma_f32_16x16x32_bf16 v[192:195], v[236:239], a[88:91], v[192:195]
    ds_read_b64_tr_b16 a[176:177], v212 offset:16384
    v_mfma_f32_16x16x32_bf16 v[196:199], v[236:239], a[92:95], v[196:199]
    ds_read_b64_tr_b16 a[178:179], v212 offset:20480
    v_mfma_f32_16x16x32_bf16 v[0:3], a[160:163], a[80:83], v[0:3]
    s_waitcnt lgkmcnt(4)
    ds_read_b64_tr_b16 a[180:181], v213 offset:16384
    v_mfma_f32_16x16x32_bf16 v[4:7], a[160:163], a[84:87], v[4:7]
    ds_read_b64_tr_b16 a[182:183], v213 offset:20480
    v_mfma_f32_16x16x32_bf16 v[8:11], a[164:167], a[80:83], v[8:11]
    ds_read_b64_tr_b16 a[184:185], v214 offset:16384
    v_mfma_f32_16x16x32_bf16 v[12:15], a[164:167], a[84:87], v[12:15]
    ds_read_b64_tr_b16 a[186:187], v214 offset:20480
    v_mfma_f32_16x16x32_bf16 v[16:19], a[168:171], a[80:83], v[16:19]
    s_waitcnt lgkmcnt(4)
    ds_read_b64_tr_b16 a[188:189], v215 offset:16384
    v_mfma_f32_16x16x32_bf16 v[20:23], a[168:171], a[84:87], v[20:23]
    s_waitcnt vmcnt(5)
    ds_read_b64_tr_b16 a[190:191], v215 offset:20480
    buffer_load_dwordx4 v240, s[32:35], s61 offen offset:2048 nt lds
    v_mfma_f32_16x16x32_bf16 v[24:27], a[172:175], a[80:83], v[24:27]
    ds_read_b64_tr_b16 a[192:193], v208 offset:24576
    v_mfma_f32_16x16x32_bf16 v[28:31], a[172:175], a[84:87], v[28:31]
    ds_read_b64_tr_b16 a[194:195], v208 offset:28672
    v_mfma_f32_16x16x32_bf16 v[32:35], a[176:179], a[80:83], v[32:35]
    s_waitcnt lgkmcnt(4)
    ds_read_b64_tr_b16 a[196:197], v209 offset:24576
    v_mfma_f32_16x16x32_bf16 v[36:39], a[176:179], a[84:87], v[36:39]
    ds_read_b64_tr_b16 a[198:199], v209 offset:28672
    v_mfma_f32_16x16x32_bf16 v[40:43], a[180:183], a[80:83], v[40:43]
    ds_read_b64_tr_b16 a[200:201], v210 offset:24576
    v_mfma_f32_16x16x32_bf16 v[44:47], a[180:183], a[84:87], v[44:47]
    ds_read_b64_tr_b16 a[202:203], v210 offset:28672
    v_mfma_f32_16x16x32_bf16 v[48:51], a[184:187], a[80:83], v[48:51]
    s_waitcnt lgkmcnt(4)
    ds_read_b64_tr_b16 a[204:205], v211 offset:24576
    v_mfma_f32_16x16x32_bf16 v[52:55], a[184:187], a[84:87], v[52:55]
    ds_read_b64_tr_b16 a[206:207], v211 offset:28672
    v_mfma_f32_16x16x32_bf16 v[56:59], a[188:191], a[80:83], v[56:59]
    ds_read_b64_tr_b16 a[208:209], v212 offset:24576
    v_mfma_f32_16x16x32_bf16 v[60:63], a[188:191], a[84:87], v[60:63]
    ds_read_b64_tr_b16 a[210:211], v212 offset:28672
    v_mfma_f32_16x16x32_bf16 v[0:3], a[192:195], a[88:91], v[0:3]
    s_waitcnt lgkmcnt(4)
    ds_read_b64_tr_b16 a[212:213], v213 offset:24576
    v_mfma_f32_16x16x32_bf16 v[4:7], a[192:195], a[92:95], v[4:7]
    s_waitcnt vmcnt(5)
    ds_read_b64_tr_b16 a[214:215], v213 offset:28672
    buffer_load_dwordx4 v241, s[32:35], s61 offen offset:3072 nt lds
    v_mfma_f32_16x16x32_bf16 v[8:11], a[196:199], a[88:91], v[8:11]
    ds_read_b64_tr_b16 a[216:217], v214 offset:24576
    v_mfma_f32_16x16x32_bf16 v[12:15], a[196:199], a[92:95], v[12:15]
    ds_read_b64_tr_b16 a[218:219], v214 offset:28672
    v_mfma_f32_16x16x32_bf16 v[16:19], a[200:203], a[88:91], v[16:19]
    s_waitcnt lgkmcnt(4)
    ds_read_b64_tr_b16 a[220:221], v215 offset:24576
    v_mfma_f32_16x16x32_bf16 v[20:23], a[200:203], a[92:95], v[20:23]
    ds_read_b64_tr_b16 a[222:223], v215 offset:28672
    v_mfma_f32_16x16x32_bf16 v[24:27], a[204:207], a[88:91], v[24:27]
    v_mfma_f32_16x16x32_bf16 v[28:31], a[204:207], a[92:95], v[28:31]
    v_mfma_f32_16x16x32_bf16 v[32:35], a[208:211], a[88:91], v[32:35]
    s_waitcnt lgkmcnt(2)
    v_mfma_f32_16x16x32_bf16 v[36:39], a[208:211], a[92:95], v[36:39]
    v_mfma_f32_16x16x32_bf16 v[40:43], a[212:215], a[88:91], v[40:43]
    s_waitcnt vmcnt(6)
    s_barrier
    ds_read_b64_tr_b16 a[160:161], v208 offset:32768
    v_mfma_f32_16x16x32_bf16 v[44:47], a[212:215], a[92:95], v[44:47]
    s_add_u32 m0, s60, 131072
    ds_read_b64_tr_b16 a[162:163], v208 offset:36864
    v_mfma_f32_16x16x32_bf16 v[48:51], a[216:219], a[88:91], v[48:51]
    s_xor_b32 s61, s12, 163840
    s_waitcnt lgkmcnt(2)
    ds_read_b64_tr_b16 a[164:165], v209 offset:32768
    v_mfma_f32_16x16x32_bf16 v[52:55], a[216:219], a[92:95], v[52:55]
    s_waitcnt vmcnt(5)
    ds_read_b64_tr_b16 a[166:167], v209 offset:36864
    buffer_load_dwordx4 v240, s[32:35], s61 offen offset:0 nt lds
    v_mfma_f32_16x16x32_bf16 v[56:59], a[220:223], a[88:91], v[56:59]
    ds_read_b64_tr_b16 a[168:169], v210 offset:32768
    v_mfma_f32_16x16x32_bf16 v[60:63], a[220:223], a[92:95], v[60:63]
    ds_read_b64_tr_b16 a[170:171], v210 offset:36864
    s_bitcmp1_b32 s13, 7
    s_cbranch_scc1 L_resc7
L_rback7:
    v_mfma_f32_16x16x32_bf16 v[192:195], v[236:239], a[96:99], v[192:195]
    s_waitcnt lgkmcnt(4)
    ds_read_b64_tr_b16 a[172:173], v211 offset:32768
    v_mfma_f32_16x16x32_bf16 v[196:199], v[236:239], a[100:103], v[196:199]
    ds_read_b64_tr_b16 a[174:175], v211 offset:36864
    v_mfma_f32_16x16x32_bf16 v[192:195], v[236:239], a[104:107], v[192:195]
    ds_read_b64_tr_b16 a[176:177], v212 offset:32768
    v_mfma_f32_16x16x32_bf16 v[196:199], v[236:239], a[108:111], v[196:199]
    ds_read_b64_tr_b16 a[178:179], v212 offset:36864
    v_mfma_f32_16x16x32_bf16 v[0:3], a[160:163], a[96:99], v[0:3]
    s_waitcnt lgkmcnt(4)
    ds_read_b64_tr_b16 a[180:181], v213 offset:32768
    v_mfma_f32_16x16x32_bf16 v[4:7], a[160:163], a[100:103], v[4:7]
    ds_read_b64_tr_b16 a[182:183], v213 offset:36864
    v_mfma_f32_16x16x32_bf16 v[8:11], a[164:167], a[96:99], v[8:11]
    s_waitcnt vmcnt(5)
    ds_read_b64_tr_b16 a[184:185], v214 offset:32768
    buffer_load_dwordx4 v241, s[32:35], s61 offen offset:1024 nt lds
    v_mfma_f32_16x16x32_bf16 v[12:15], a[164:167], a[100:103], v[12:15]
    ds_read_b64_tr_b16 a[186:187], v214 offset:36864
    v_mfma_f32_16x16x32_bf16 v[16:19], a[168:171], a[96:99], v[16:19]
    s_waitcnt lgkmcnt(4)
    ds_read_b64_tr_b16 a[188:189], v215 offset:32768
    v_mfma_f32_16x16x32_bf16 v[20:23], a[168:171], a[100:103], v[20:23]
    ds_read_b64_tr_b16 a[190:191], v215 offset:36864
    v_mfma_f32_16x16x32_bf16 v[24:27], a[172:175], a[96:99], v[24:27]
    ds_read_b64_tr_b16 a[192:193], v208 offset:40960
    v_mfma_f32_16x16x32_bf16 v[28:31], a[172:175], a[100:103], v[28:31]
    ds_read_b64_tr_b16 a[194:195], v208 offset:45056
    v_mfma_f32_16x16x32_bf16 v[32:35], a[176:179], a[96:99], v[32:35]
    s_waitcnt lgkmcnt(4)
    ds_read_b64_tr_b16 a[196:197], v209 offset:40960
    v_mfma_f32_16x16x32_bf16 v[36:39], a[176:179], a[100:103], v[36:39]
    ds_read_b64_tr_b16 a[198:199], v209 offset:45056
    v_mfma_f32_16x16x32_bf16 v[40:43], a[180:183], a[96:99], v[40:43]
    ds_read_b64_tr_b16 a[200:201], v210 offset:40960
    v_mfma_f32_16x16x32_bf16 v[44:47], a[180:183], a[100:103], v[44:47]
    s_waitcnt vmcnt(5)
    ds_read_b64_tr_b16 a[202:203], v210 offset:45056
    buffer_load_dwordx4 v240, s[32:35], s61 offen offset:2048 nt lds
    v_mfma_f32_16x16x32_bf16 v[48:51], a[184:187], a[96:99], v[48:51]
    s_waitcnt lgkmcnt(4)
    ds_read_b64_tr_b16 a[204:205], v211 offset:40960
    v_mfma_f32_16x16x32_bf16 v[52:55], a[184:187], a[100:103], v[52:55]
    ds_read_b64_tr_b16 a[206:207], v211 offset:45056
    v_mfma_f32_16x16x32_bf16 v[56:59], a[188:191], a[96:99], v[56:59]
    ds_read_b64_tr_b16 a[208:209], v212 offset:40960
    v_mfma_f32_16x16x32_bf16 v[60:63], a[188:191], a[100:103], v[60:63]
    ds_read_b64_tr_b16 a[210:211], v212 offset:45056
    v_mfma_f32_16x16x32_bf16 v[0:3], a[192:195], a[104:107], v[0:3]
    s_waitcnt lgkmcnt(4)
    ds_read_b64_tr_b16 a[212:213], v213 offset:40960
    v_mfma_f32_16x16x32_bf16 v[4:7], a[192:195], a[108:111], v[4:7]
    ds_read_b64_tr_b16 a[214:215], v213 offset:45056
    v_mfma_f32_16x16x32_bf16 v[8:11], a[196:199], a[104:107], v[8:11]
    ds_read_b64_tr_b16 a[216:217], v214 offset:40960
    v_mfma_f32_16x16x32_bf16 v[12:15], a[196:199], a[108:111], v[12:15]
    ds_read_b64_tr_b16 a[218:219], v214 offset:45056
    v_mfma_f32_16x16x32_bf16 v[16:19], a[200:203], a[104:107], v[16:19]
    s_waitcnt vmcnt(5)
    s_waitcnt lgkmcnt(4)
    ds_read_b64_tr_b16 a[220:221], v215 offset:40960
    buffer_load_dwordx4 v241, s[32:35], s61 offen offset:3072 nt lds
    v_mfma_f32_16x16x32_bf16 v[20:23], a[200:203], a[108:111], v[20:23]
    ds_read_b64_tr_b16 a[222:223], v215 offset:45056
    v_mfma_f32_16x16x32_bf16 v[24:27], a[204:207], a[104:107], v[24:27]
    v_mfma_f32_16x16x32_bf16 v[28:31], a[204:207], a[108:111], v[28:31]
    v_mfma_f32_16x16x32_bf16 v[32:35], a[208:211], a[104:107], v[32:35]
    s_waitcnt lgkmcnt(2)
    v_mfma_f32_16x16x32_bf16 v[36:39], a[208:211], a[108:111], v[36:39]
    v_mfma_f32_16x16x32_bf16 v[40:43], a[212:215], a[104:107], v[40:43]
    s_waitcnt vmcnt(6)
    s_barrier
    ds_read_b64_tr_b16 a[160:161], v224 offset:0
    buffer_load_dword v253, v255, s[16:19], 0 offen offset:0 sc1
    v_mfma_f32_16x16x32_bf16 v[44:47], a[212:215], a[108:111], v[44:47]
    s_add_u32 m0, s60, 147456
    ds_read_b64_tr_b16 a[162:163], v224 offset:4096
    v_mfma_f32_16x16x32_bf16 v[48:51], a[216:219], a[104:107], v[48:51]
    s_xor_b32 s61, s12, 180224
    s_waitcnt lgkmcnt(2)
    ds_read_b64_tr_b16 a[164:165], v225 offset:0
    v_mfma_f32_16x16x32_bf16 v[52:55], a[216:219], a[108:111], v[52:55]
    s_waitcnt vmcnt(5)
    ds_read_b64_tr_b16 a[166:167], v225 offset:4096
    buffer_load_dwordx4 v240, s[32:35], s61 offen offset:0 nt lds
    v_mfma_f32_16x16x32_bf16 v[56:59], a[220:223], a[104:107], v[56:59]
    ds_read_b64_tr_b16 a[168:169], v226 offset:0
    v_mfma_f32_16x16x32_bf16 v[60:63], a[220:223], a[108:111], v[60:63]
    ds_read_b64_tr_b16 a[170:171], v226 offset:4096
    s_bitcmp1_b32 s13, 8
    s_cbranch_scc1 L_resc8
L_rback8:
    v_mfma_f32_16x16x32_bf16 v[192:195], v[236:239], a[112:115], v[192:195]
    s_waitcnt lgkmcnt(4)
    ds_read_b64_tr_b16 a[172:173], v227 offset:0
    v_mfma_f32_16x16x32_bf16 v[196:199], v[236:239], a[116:119], v[196:199]
    ds_read_b64_tr_b16 a[174:175], v227 offset:4096
    v_mfma_f32_16x16x32_bf16 v[192:195], v[236:239], a[120:123], v[192:195]
    ds_read_b64_tr_b16 a[176:177], v228 offset:0
    v_mfma_f32_16x16x32_bf16 v[196:199], v[236:239], a[124:127], v[196:199]
    ds_read_b64_tr_b16 a[178:179], v228 offset:4096
    v_mfma_f32_16x16x32_bf16 v[0:3], a[160:163], a[112:115], v[0:3]
    s_waitcnt lgkmcnt(4)
    ds_read_b64_tr_b16 a[180:181], v229 offset:0
    v_mfma_f32_16x16x32_bf16 v[4:7], a[160:163], a[116:119], v[4:7]
    ds_read_b64_tr_b16 a[182:183], v229 offset:4096
    v_mfma_f32_16x16x32_bf16 v[8:11], a[164:167], a[112:115], v[8:11]
    ds_read_b64_tr_b16 a[184:185], v230 offset:0
    v_mfma_f32_16x16x32_bf16 v[12:15], a[164:167], a[116:119], v[12:15]
    ds_read_b64_tr_b16 a[186:187], v230 offset:4096
    v_mfma_f32_16x16x32_bf16 v[16:19], a[168:171], a[112:115], v[16:19]
    s_waitcnt lgkmcnt(4)
    ds_read_b64_tr_b16 a[188:189], v231 offset:0
    v_mfma_f32_16x16x32_bf16 v[20:23], a[168:171], a[116:119], v[20:23]
    s_waitcnt vmcnt(5)
    ds_read_b64_tr_b16 a[190:191], v231 offset:4096
    buffer_load_dwordx4 v241, s[32:35], s61 offen offset:1024 nt lds
    v_mfma_f32_16x16x32_bf16 v[24:27], a[172:175], a[112:115], v[24:27]
    ds_read_b64_tr_b16 a[192:193], v224 offset:8192
    v_mfma_f32_16x16x32_bf16 v[28:31], a[172:175], a[116:119], v[28:31]
    ds_read_b64_tr_b16 a[194:195], v224 offset:12288
    v_mfma_f32_16x16x32_bf16 v[32:35], a[176:179], a[112:115], v[32:35]
    s_waitcnt lgkmcnt(4)
    ds_read_b64_tr_b16 a[196:197], v225 offset:8192
    v_mfma_f32_16x16x32_bf16 v[36:39], a[176:179], a[116:119], v[36:39]
    ds_read_b64_tr_b16 a[198:199], v225 offset:12288
    v_mfma_f32_16x16x32_bf16 v[40:43], a[180:183], a[112:115], v[40:43]
    ds_read_b64_tr_b16 a[200:201], v226 offset:8192
    v_mfma_f32_16x16x32_bf16 v[44:47], a[180:183], a[116:119], v[44:47]
    ds_read_b64_tr_b16 a[202:203], v226 offset:12288
    v_mfma_f32_16x16x32_bf16 v[48:51], a[184:187], a[112:115], v[48:51]
    s_waitcnt lgkmcnt(4)
    ds_read_b64_tr_b16 a[204:205], v227 offset:8192
    v_mfma_f32_16x16x32_bf16 v[52:55], a[184:187], a[116:119], v[52:55]
    ds_read_b64_tr_b16 a[206:207], v227 offset:12288
    v_mfma_f32_16x16x32_bf16 v[56:59], a[188:191], a[112:115], v[56:59]
    ds_read_b64_tr_b16 a[208:209], v228 offset:8192
    v_mfma_f32_16x16x32_bf16 v[60:63], a[188:191], a[116:119], v[60:63]
    ds_read_b64_tr_b16 a[210:211], v228 offset:12288
    v_mfma_f32_16x16x32_bf16 v[0:3], a[192:195], a[120:123], v[0:3]
    s_waitcnt lgkmcnt(4)
    ds_read_b64_tr_b16 a[212:213], v229 offset:8192
    v_mfma_f32_16x16x32_bf16 v[4:7], a[192:195], a[124:127], v[4:7]
    s_waitcnt vmcnt(5)
    ds_read_b64_tr_b16 a[214:215], v229 offset:12288
    buffer_load_dwordx4 v240, s[32:35], s61 offen offset:2048 nt lds
    v_mfma_f32_16x16x32_bf16 v[8:11], a[196:199], a[120:123], v[8:11]
    ds_read_b64_tr_b16 a[216:217], v230 offset:8192
    v_mfma_f32_16x16x32_bf16 v[12:15], a[196:199], a[124:127], v[12:15]
    ds_read_b64_tr_b16 a[218:219], v230 offset:12288
    v_mfma_f32_16x16x32_bf16 v[16:19], a[200:203], a[120:123], v[16:19]
    s_waitcnt lgkmcnt(4)
    ds_read_b64_tr_b16 a[220:221], v231 offset:8192
    v_mfma_f32_16x16x32_bf16 v[20:23], a[200:203], a[124:127], v[20:23]
    ds_read_b64_tr_b16 a[222:223], v231 offset:12288
    v_mfma_f32_16x16x32_bf16 v[24:27], a[204:207], a[120:123], v[24:27]
    v_mfma_f32_16x16x32_bf16 v[28:31], a[204:207], a[124:127], v[28:31]
    v_mfma_f32_16x16x32_bf16 v[32:35], a[208:211], a[120:123], v[32:35]
    s_waitcnt lgkmcnt(2)
    v_mfma_f32_16x16x32_bf16 v[36:39], a[208:211], a[124:127], v[36:39]
    v_mfma_f32_16x16x32_bf16 v[40:43], a[212:215], a[120:123], v[40:43]
    s_waitcnt vmcnt(7)
    s_barrier
    ds_read_b64_tr_b16 a[160:161], v224 offset:16384
    v_mfma_f32_16x16x32_bf16 v[44:47], a[212:215], a[124:127], v[44:47]
    ds_read_b64_tr_b16 a[162:163], v224 offset:20480
    v_mfma_f32_16x16x32_bf16 v[48:51], a[216:219], a[120:123], v[48:51]
    s_waitcnt lgkmcnt(2)
    ds_read_b64_tr_b16 a[164:165], v225 offset:16384
    v_mfma_f32_16x16x32_bf16 v[52:55], a[216:219], a[124:127], v[52:55]
    s_waitcnt vmcnt(5)
    ds_read_b64_tr_b16 a[166:167], v225 offset:20480
    buffer_load_dwordx4 v241, s[32:35], s61 offen offset:3072 nt lds
    v_mfma_f32_16x16x32_bf16 v[56:59], a[220:223], a[120:123], v[56:59]
    ds_read_b64_tr_b16 a[168:169], v226 offset:16384
    v_mfma_f32_16x16x32_bf16 v[60:63], a[220:223], a[124:127], v[60:63]
    ds_read_b64_tr_b16 a[170:171], v226 offset:20480
    s_bitcmp1_b32 s13, 9
    s_cbranch_scc1 L_resc9
L_rback9:
    v_mfma_f32_16x16x32_bf16 v[192:195], v[236:239], a[128:131], v[192:195]
    s_waitcnt lgkmcnt(4)
    ds_read_b64_tr_b16 a[172:173], v227 offset:16384
    v_mfma_f32_16x16x32_bf16 v[196:199], v[236:239], a[132:135], v[196:199]
    ds_read_b64_tr_b16 a[174:175], v227 offset:20480
    v_mfma_f32_16x16x32_bf16 v[192:195], v[236:239], a[136:139], v[192:195]
    ds_read_b64_tr_b16 a[176:177], v228 offset:16384
    v_mfma_f32_16x16x32_bf16 v[196:199], v[236:239], a[140:143], v[196:199]
    ds_read_b64_tr_b16 a[178:179], v228 offset:20480
    v_mfma_f32_16x16x32_bf16 v[0:3], a[160:163], a[128:131], v[0:3]
    s_waitcnt lgkmcnt(4)
    ds_read_b64_tr_b16 a[180:181], v229 offset:16384
    v_mfma_f32_16x16x32_bf16 v[4:7], a[160:163], a[132:135], v[4:7]
    ds_read_b64_tr_b16 a[182:183], v229 offset:20480
    v_mfma_f32_16x16x32_bf16 v[8:11], a[164:167], a[128:131], v[8:11]
    ds_read_b64_tr_b16 a[184:185], v230 offset:16384
    v_mfma_f32_16x16x32_bf16 v[12:15], a[164:167], a[132:135], v[12:15]
    s_add_u32 m0, s60, 32768
    ds_read_b64_tr_b16 a[186:187], v230 offset:20480
    v_mfma_f32_16x16x32_bf16 v[16:19], a[168:171], a[128:131], v[16:19]
    s_xor_b32 s61, s12, 196608
    s_waitcnt lgkmcnt(4)
    ds_read_b64_tr_b16 a[188:189], v231 offset:16384
    v_mfma_f32_16x16x32_bf16 v[20:23], a[168:171], a[132:135], v[20:23]
    s_waitcnt vmcnt(5)
    ds_read_b64_tr_b16 a[190:191], v231 offset:20480
    buffer_load_dwordx4 v240, s[32:35], s61 offen offset:0 nt lds
    v_mfma_f32_16x16x32_bf16 v[24:27], a[172:175], a[128:131], v[24:27]
    ds_read_b64_tr_b16 a[192:193], v224 offset:24576
    v_mfma_f32_16x16x32_bf16 v[28:31], a[172:175], a[132:135], v[28:31]
    ds_read_b64_tr_b16 a[194:195], v224 offset:28672
    v_mfma_f32_16x16x32_bf16 v[32:35], a[176:179], a[128:131], v[32:35]
    s_waitcnt lgkmcnt(4)
    ds_read_b64_tr_b16 a[196:197], v225 offset:24576
    v_mfma_f32_16x16x32_bf16 v[36:39], a[176:179], a[132:135], v[36:39]
    ds_read_b64_tr_b16 a[198:199], v225 offset:28672
    v_mfma_f32_16x16x32_bf16 v[40:43], a[180:183], a[128:131], v[40:43]
    ds_read_b64_tr_b16 a[200:201], v226 offset:24576
    v_mfma_f32_16x16x32_bf16 v[44:47], a[180:183], a[132:135], v[44:47]
    ds_read_b64_tr_b16 a[202:203], v226 offset:28672
    v_mfma_f32_16x16x32_bf16 v[48:51], a[184:187], a[128:131], v[48:51]
    s_waitcnt lgkmcnt(4)
    ds_read_b64_tr_b16 a[204:205], v227 offset:24576
    v_mfma_f32_16x16x32_bf16 v[52:55], a[184:187], a[132:135], v[52:55]
    ds_read_b64_tr_b16 a[206:207], v227 offset:28672
    v_mfma_f32_16x16x32_bf16 v[56:59], a[188:191], a[128:131], v[56:59]
    ds_read_b64_tr_b16 a[208:209], v228 offset:24576
    v_mfma_f32_16x16x32_bf16 v[60:63], a[188:191], a[132:135], v[60:63]
    ds_read_b64_tr_b16 a[210:211], v228 offset:28672
    v_mfma_f32_16x16x32_bf16 v[0:3], a[192:195], a[136:139], v[0:3]
    s_waitcnt lgkmcnt(4)
    ds_read_b64_tr_b16 a[212:213], v229 offset:24576
    v_mfma_f32_16x16x32_bf16 v[4:7], a[192:195], a[140:143], v[4:7]
    s_waitcnt vmcnt(5)
    ds_read_b64_tr_b16 a[214:215], v229 offset:28672
    buffer_load_dwordx4 v241, s[32:35], s61 offen offset:1024 nt lds
    v_mfma_f32_16x16x32_bf16 v[8:11], a[196:199], a[136:139], v[8:11]
    ds_read_b64_tr_b16 a[216:217], v230 offset:24576
    v_mfma_f32_16x16x32_bf16 v[12:15], a[196:199], a[140:143], v[12:15]
    ds_read_b64_tr_b16 a[218:219], v230 offset:28672
    v_mfma_f32_16x16x32_bf16 v[16:19], a[200:203], a[136:139], v[16:19]
    s_waitcnt lgkmcnt(4)
    ds_read_b64_tr_b16 a[220:221], v231 offset:24576
    v_mfma_f32_16x16x32_bf16 v[20:23], a[200:203], a[140:143], v[20:23]
    ds_read_b64_tr_b16 a[222:223], v231 offset:28672
    v_mfma_f32_16x16x32_bf16 v[24:27], a[204:207], a[136:139], v[24:27]
    v_mfma_f32_16x16x32_bf16 v[28:31], a[204:207], a[140:143], v[28:31]
    v_mfma_f32_16x16x32_bf16 v[32:35], a[208:211], a[136:139], v[32:35]
    s_waitcnt lgkmcnt(2)
    v_mfma_f32_16x16x32_bf16 v[36:39], a[208:211], a[140:143], v[36:39]
    v_mfma_f32_16x16x32_bf16 v[40:43], a[212:215], a[136:139], v[40:43]
    s_waitcnt vmcnt(6)
    s_barrier
    ds_read_b64_tr_b16 a[160:161], v224 offset:32768
    v_mfma_f32_16x16x32_bf16 v[44:47], a[212:215], a[140:143], v[44:47]
    ds_read_b64_tr_b16 a[162:163], v224 offset:36864
    v_mfma_f32_16x16x32_bf16 v[48:51], a[216:219], a[136:139], v[48:51]
    s_waitcnt lgkmcnt(2)
    ds_read_b64_tr_b16 a[164:165], v225 offset:32768
    v_mfma_f32_16x16x32_bf16 v[52:55], a[216:219], a[140:143], v[52:55]
    s_waitcnt vmcnt(5)
    ds_read_b64_tr_b16 a[166:167], v225 offset:36864
    buffer_load_dwordx4 v240, s[32:35], s61 offen offset:2048 nt lds
    v_mfma_f32_16x16x32_bf16 v[56:59], a[220:223], a[136:139], v[56:59]
    ds_read_b64_tr_b16 a[168:169], v226 offset:32768
    v_mfma_f32_16x16x32_bf16 v[60:63], a[220:223], a[140:143], v[60:63]
    ds_read_b64_tr_b16 a[170:171], v226 offset:36864
    s_bitcmp1_b32 s13, 10
    s_cbranch_scc1 L_resc10
L_rback10:
    v_mfma_f32_16x16x32_bf16 v[192:195], v[236:239], a[144:147], v[192:195]
    s_waitcnt lgkmcnt(4)
    ds_read_b64_tr_b16 a[172:173], v227 offset:32768
    v_mfma_f32_16x16x32_bf16 v[196:199], v[236:239], a[148:151], v[196:199]
    ds_read_b64_tr_b16 a[174:175], v227 offset:36864
    v_mfma_f32_16x16x32_bf16 v[192:195], v[236:239], a[152:155], v[192:195]
    ds_read_b64_tr_b16 a[176:177], v228 offset:32768
    v_mfma_f32_16x16x32_bf16 v[196:199], v[236:239], a[156:159], v[196:199]
    ds_read_b64_tr_b16 a[178:179], v228 offset:36864
    v_mfma_f32_16x16x32_bf16 v[0:3], a[160:163], a[144:147], v[0:3]
    s_waitcnt lgkmcnt(4)
    ds_read_b64_tr_b16 a[180:181], v229 offset:32768
    v_mfma_f32_16x16x32_bf16 v[4:7], a[160:163], a[148:151], v[4:7]
    ds_read_b64_tr_b16 a[182:183], v229 offset:36864
    v_mfma_f32_16x16x32_bf16 v[8:11], a[164:167], a[144:147], v[8:11]
    s_waitcnt vmcnt(5)
    ds_read_b64_tr_b16 a[184:185], v230 offset:32768
    buffer_load_dwordx4 v241, s[32:35], s61 offen offset:3072 nt lds
    v_mfma_f32_16x16x32_bf16 v[12:15], a[164:167], a[148:151], v[12:15]
    ds_read_b64_tr_b16 a[186:187], v230 offset:36864
    v_mfma_f32_16x16x32_bf16 v[16:19], a[168:171], a[144:147], v[16:19]
    s_waitcnt lgkmcnt(4)
    ds_read_b64_tr_b16 a[188:189], v231 offset:32768
    v_mfma_f32_16x16x32_bf16 v[20:23], a[168:171], a[148:151], v[20:23]
    ds_read_b64_tr_b16 a[190:191], v231 offset:36864
    v_mfma_f32_16x16x32_bf16 v[24:27], a[172:175], a[144:147], v[24:27]
    ds_read_b64_tr_b16 a[192:193], v224 offset:40960
    v_mfma_f32_16x16x32_bf16 v[28:31], a[172:175], a[148:151], v[28:31]
    ds_read_b64_tr_b16 a[194:195], v224 offset:45056
    v_mfma_f32_16x16x32_bf16 v[32:35], a[176:179], a[144:147], v[32:35]
    s_waitcnt lgkmcnt(4)
    ds_read_b64_tr_b16 a[196:197], v225 offset:40960
    v_mfma_f32_16x16x32_bf16 v[36:39], a[176:179], a[148:151], v[36:39]
    s_add_u32 m0, s60, 81920
    ds_read_b64_tr_b16 a[198:199], v225 offset:45056
    v_mfma_f32_16x16x32_bf16 v[40:43], a[180:183], a[144:147], v[40:43]
    s_xor_b32 s61, s12, 212992
    ds_read_b64_tr_b16 a[200:201], v226 offset:40960
    v_mfma_f32_16x16x32_bf16 v[44:47], a[180:183], a[148:151], v[44:47]
    s_waitcnt vmcnt(5)
    ds_read_b64_tr_b16 a[202:203], v226 offset:45056
    buffer_load_dwordx4 v240, s[32:35], s61 offen offset:0 nt lds
    v_mfma_f32_16x16x32_bf16 v[48:51], a[184:187], a[144:147], v[48:51]
    s_waitcnt lgkmcnt(4)
    ds_read_b64_tr_b16 a[204:205], v227 offset:40960
    v_mfma_f32_16x16x32_bf16 v[52:55], a[184:187], a[148:151], v[52:55]
    ds_read_b64_tr_b16 a[206:207], v227 offset:45056
    v_mfma_f32_16x16x32_bf16 v[56:59], a[188:191], a[144:147], v[56:59]
    ds_read_b64_tr_b16 a[208:209], v228 offset:40960
    v_mfma_f32_16x16x32_bf16 v[60:63], a[188:191], a[148:151], v[60:63]
    ds_read_b64_tr_b16 a[210:211], v228 offset:45056
    v_mfma_f32_16x16x32_bf16 v[0:3], a[192:195], a[152:155], v[0:3]
    s_waitcnt lgkmcnt(4)
    ds_read_b64_tr_b16 a[212:213], v229 offset:40960
    v_mfma_f32_16x16x32_bf16 v[4:7], a[192:195], a[156:159], v[4:7]
    ds_read_b64_tr_b16 a[214:215], v229 offset:45056
    v_mfma_f32_16x16x32_bf16 v[8:11], a[196:199], a[152:155], v[8:11]
    ds_read_b64_tr_b16 a[216:217], v230 offset:40960
    v_mfma_f32_16x16x32_bf16 v[12:15], a[196:199], a[156:159], v[12:15]
    ds_read_b64_tr_b16 a[218:219], v230 offset:45056
    v_mfma_f32_16x16x32_bf16 v[16:19], a[200:203], a[152:155], v[16:19]
    s_waitcnt vmcnt(5)
    s_waitcnt lgkmcnt(4)
    ds_read_b64_tr_b16 a[220:221], v231 offset:40960
    buffer_load_dwordx4 v241, s[32:35], s61 offen offset:1024 nt lds
    v_mfma_f32_16x16x32_bf16 v[20:23], a[200:203], a[156:159], v[20:23]
    ds_read_b64_tr_b16 a[222:223], v231 offset:45056
    v_mfma_f32_16x16x32_bf16 v[24:27], a[204:207], a[152:155], v[24:27]
    v_mfma_f32_16x16x32_bf16 v[28:31], a[204:207], a[156:159], v[28:31]
    v_mfma_f32_16x16x32_bf16 v[32:35], a[208:211], a[152:155], v[32:35]
    s_waitcnt lgkmcnt(2)
    v_mfma_f32_16x16x32_bf16 v[36:39], a[208:211], a[156:159], v[36:39]
    v_mfma_f32_16x16x32_bf16 v[40:43], a[212:215], a[152:155], v[40:43]
    s_waitcnt vmcnt(6)
    s_barrier
    ds_read_b64_tr_b16 a[160:161], v224 offset:49152
    v_mfma_f32_16x16x32_bf16 v[44:47], a[212:215], a[156:159], v[44:47]
    ds_read_b64_tr_b16 a[162:163], v224 offset:53248
    v_mfma_f32_16x16x32_bf16 v[48:51], a[216:219], a[152:155], v[48:51]
    s_waitcnt lgkmcnt(2)
    ds_read_b64_tr_b16 a[164:165], v225 offset:49152
    v_mfma_f32_16x16x32_bf16 v[52:55], a[216:219], a[156:159], v[52:55]
    s_waitcnt vmcnt(5)
    ds_read_b64_tr_b16 a[166:167], v225 offset:53248
    buffer_load_dwordx4 v240, s[32:35], s61 offen offset:2048 nt lds
    v_mfma_f32_16x16x32_bf16 v[56:59], a[220:223], a[152:155], v[56:59]
    ds_read_b64_tr_b16 a[168:169], v226 offset:49152
    v_mfma_f32_16x16x32_bf16 v[60:63], a[220:223], a[156:159], v[60:63]
    ds_read_b64_tr_b16 a[170:171], v226 offset:53248
    s_bitcmp1_b32 s13, 11
    s_cbranch_scc1 L_resc11
L_rback11:
    v_mfma_f32_16x16x32_bf16 v[192:195], v[236:239], v[112:115], v[192:195]
    s_waitcnt lgkmcnt(4)
    ds_read_b64_tr_b16 a[172:173], v227 offset:49152
    v_mfma_f32_16x16x32_bf16 v[196:199], v[236:239], v[116:119], v[196:199]
    ds_read_b64_tr_b16 a[174:175], v227 offset:53248
    v_mfma_f32_16x16x32_bf16 v[192:195], v[236:239], v[120:123], v[192:195]
    ds_read_b64_tr_b16 a[176:177], v228 offset:49152
    v_mfma_f32_16x16x32_bf16 v[196:199], v[236:239], v[124:127], v[196:199]
    ds_read_b64_tr_b16 a[178:179], v228 offset:53248
    v_mfma_f32_16x16x32_bf16 v[0:3], a[160:163], v[112:115], v[0:3]
    s_waitcnt lgkmcnt(4)
    ds_read_b64_tr_b16 a[180:181], v229 offset:49152
    v_mfma_f32_16x16x32_bf16 v[4:7], a[160:163], v[116:119], v[4:7]
    ds_read_b64_tr_b16 a[182:183], v229 offset:53248
    v_mfma_f32_16x16x32_bf16 v[8:11], a[164:167], v[112:115], v[8:11]
    ds_read_b64_tr_b16 a[184:185], v230 offset:49152
    v_mfma_f32_16x16x32_bf16 v[12:15], a[164:167], v[116:119], v[12:15]
    ds_read_b64_tr_b16 a[186:187], v230 offset:53248
    v_mfma_f32_16x16x32_bf16 v[16:19], a[168:171], v[112:115], v[16:19]
    s_waitcnt lgkmcnt(4)
    ds_read_b64_tr_b16 a[188:189], v231 offset:49152
    v_mfma_f32_16x16x32_bf16 v[20:23], a[168:171], v[116:119], v[20:23]
    s_waitcnt vmcnt(5)
    ds_read_b64_tr_b16 a[190:191], v231 offset:53248
    buffer_load_dwordx4 v241, s[32:35], s61 offen offset:3072 nt lds
    v_mfma_f32_16x16x32_bf16 v[24:27], a[172:175], v[112:115], v[24:27]
    ds_read_b64_tr_b16 a[192:193], v224 offset:57344
    v_mfma_f32_16x16x32_bf16 v[28:31], a[172:175], v[116:119], v[28:31]
    ds_read_b64_tr_b16 a[194:195], v224 offset:61440
    v_mfma_f32_16x16x32_bf16 v[32:35], a[176:179], v[112:115], v[32:35]
    s_waitcnt lgkmcnt(4)
    ds_read_b64_tr_b16 a[196:197], v225 offset:57344
    v_mfma_f32_16x16x32_bf16 v[36:39], a[176:179], v[116:119], v[36:39]
    ds_read_b64_tr_b16 a[198:199], v225 offset:61440
    v_mfma_f32_16x16x32_bf16 v[40:43], a[180:183], v[112:115], v[40:43]
    ds_read_b64_tr_b16 a[200:201], v226 offset:57344
    v_mfma_f32_16x16x32_bf16 v[44:47], a[180:183], v[116:119], v[44:47]
    ds_read_b64_tr_b16 a[202:203], v226 offset:61440
    v_mfma_f32_16x16x32_bf16 v[48:51], a[184:187], v[112:115], v[48:51]
    s_waitcnt lgkmcnt(4)
    ds_read_b64_tr_b16 a[204:205], v227 offset:57344
    v_mfma_f32_16x16x32_bf16 v[52:55], a[184:187], v[116:119], v[52:55]
    ds_read_b64_tr_b16 a[206:207], v227 offset:61440
    v_mfma_f32_16x16x32_bf16 v[56:59], a[188:191], v[112:115], v[56:59]
    ds_read_b64_tr_b16 a[208:209], v228 offset:57344
    v_mfma_f32_16x16x32_bf16 v[60:63], a[188:191], v[116:119], v[60:63]
    s_add_u32 m0, s60, 49152
    ds_read_b64_tr_b16 a[210:211], v228 offset:61440
    v_mfma_f32_16x16x32_bf16 v[0:3], a[192:195], v[120:123], v[0:3]
    s_xor_b32 s61, s12, 229376
    s_waitcnt lgkmcnt(4)
    ds_read_b64_tr_b16 a[212:213], v229 offset:57344
    v_mfma_f32_16x16x32_bf16 v[4:7], a[192:195], v[124:127], v[4:7]
    s_waitcnt vmcnt(5)
    ds_read_b64_tr_b16 a[214:215], v229 offset:61440
    buffer_load_dwordx4 v240, s[32:35], s61 offen offset:0 nt lds
    v_mfma_f32_16x16x32_bf16 v[8:11], a[196:199], v[120:123], v[8:11]
    ds_read_b64_tr_b16 a[216:217], v230 offset:57344
    v_mfma_f32_16x16x32_bf16 v[12:15], a[196:199], v[124:127], v[12:15]
    ds_read_b64_tr_b16 a[218:219], v230 offset:61440
    v_mfma_f32_16x16x32_bf16 v[16:19], a[200:203], v[120:123], v[16:19]
    s_waitcnt lgkmcnt(4)
    ds_read_b64_tr_b16 a[220:221], v231 offset:57344
    v_mfma_f32_16x16x32_bf16 v[20:23], a[200:203], v[124:127], v[20:23]
    ds_read_b64_tr_b16 a[222:223], v231 offset:61440
    v_mfma_f32_16x16x32_bf16 v[24:27], a[204:207], v[120:123], v[24:27]
    v_mfma_f32_16x16x32_bf16 v[28:31], a[204:207], v[124:127], v[28:31]
    v_mfma_f32_16x16x32_bf16 v[32:35], a[208:211], v[120:123], v[32:35]
    s_waitcnt lgkmcnt(2)
    v_mfma_f32_16x16x32_bf16 v[36:39], a[208:211], v[124:127], v[36:39]
    v_mfma_f32_16x16x32_bf16 v[40:43], a[212:215], v[120:123], v[40:43]
    s_waitcnt vmcnt(5)
    s_barrier
    ds_read_b64_tr_b16 a[160:161], v208 offset:0
    v_mfma_f32_16x16x32_bf16 v[44:47], a[212:215], v[124:127], v[44:47]
    ds_read_b64_tr_b16 a[162:163], v208 offset:4096
    v_mfma_f32_16x16x32_bf16 v[48:51], a[216:219], v[120:123], v[48:51]
    s_waitcnt lgkmcnt(2)
    ds_read_b64_tr_b16 a[164:165], v209 offset:0
    v_mfma_f32_16x16x32_bf16 v[52:55], a[216:219], v[124:127], v[52:55]
    s_waitcnt vmcnt(5)
    ds_read_b64_tr_b16 a[166:167], v209 offset:4096
    buffer_load_dwordx4 v241, s[32:35], s61 offen offset:1024 nt lds
    v_mfma_f32_16x16x32_bf16 v[56:59], a[220:223], v[120:123], v[56:59]
    ds_read_b64_tr_b16 a[168:169], v210 offset:0
    v_mfma_f32_16x16x32_bf16 v[60:63], a[220:223], v[124:127], v[60:63]
    ds_read_b64_tr_b16 a[170:171], v210 offset:4096
    s_bitcmp1_b32 s13, 12
    s_cbranch_scc1 L_resc12
L_rback12:
    v_mfma_f32_16x16x32_bf16 v[192:195], v[236:239], v[128:131], v[192:195]
    s_waitcnt lgkmcnt(4)
    ds_read_b64_tr_b16 a[172:173], v211 offset:0
    v_mfma_f32_16x16x32_bf16 v[196:199], v[236:239], v[132:135], v[196:199]
    ds_read_b64_tr_b16 a[174:175], v211 offset:4096
    v_mfma_f32_16x16x32_bf16 v[192:195], v[236:239], v[136:139], v[192:195]
    ds_read_b64_tr_b16 a[176:177], v212 offset:0
    v_mfma_f32_16x16x32_bf16 v[196:199], v[236:239], v[140:143], v[196:199]
    ds_read_b64_tr_b16 a[178:179], v212 offset:4096
    v_mfma_f32_16x16x32_bf16 v[0:3], a[160:163], v[128:131], v[0:3]
    s_waitcnt lgkmcnt(4)
    ds_read_b64_tr_b16 a[180:181], v213 offset:0
    v_mfma_f32_16x16x32_bf16 v[4:7], a[160:163], v[132:135], v[4:7]
    ds_read_b64_tr_b16 a[182:183], v213 offset:4096
    v_mfma_f32_16x16x32_bf16 v[8:11], a[164:167], v[128:131], v[8:11]
    ds_read_b64_tr_b16 a[184:185], v214 offset:0
    v_mfma_f32_16x16x32_bf16 v[12:15], a[164:167], v[132:135], v[12:15]
    ds_read_b64_tr_b16 a[186:187], v214 offset:4096
    v_mfma_f32_16x16x32_bf16 v[16:19], a[168:171], v[128:131], v[16:19]
    s_waitcnt lgkmcnt(4)
    ds_read_b64_tr_b16 a[188:189], v215 offset:0
    v_mfma_f32_16x16x32_bf16 v[20:23], a[168:171], v[132:135], v[20:23]
    s_waitcnt vmcnt(5)
    ds_read_b64_tr_b16 a[190:191], v215 offset:4096
    buffer_load_dwordx4 v240, s[32:35], s61 offen offset:2048 nt lds
    v_mfma_f32_16x16x32_bf16 v[24:27], a[172:175], v[128:131], v[24:27]
    ds_read_b64_tr_b16 a[192:193], v208 offset:8192
    v_mfma_f32_16x16x32_bf16 v[28:31], a[172:175], v[132:135], v[28:31]
    ds_read_b64_tr_b16 a[194:195], v208 offset:12288
    v_mfma_f32_16x16x32_bf16 v[32:35], a[176:179], v[128:131], v[32:35]
    s_waitcnt lgkmcnt(4)
    ds_read_b64_tr_b16 a[196:197], v209 offset:8192
    v_mfma_f32_16x16x32_bf16 v[36:39], a[176:179], v[132:135], v[36:39]
    ds_read_b64_tr_b16 a[198:199], v209 offset:12288
    v_mfma_f32_16x16x32_bf16 v[40:43], a[180:183], v[128:131], v[40:43]
    ds_read_b64_tr_b16 a[200:201], v210 offset:8192
    v_mfma_f32_16x16x32_bf16 v[44:47], a[180:183], v[132:135], v[44:47]
    ds_read_b64_tr_b16 a[202:203], v210 offset:12288
    v_mfma_f32_16x16x32_bf16 v[48:51], a[184:187], v[128:131], v[48:51]
    s_waitcnt lgkmcnt(4)
    ds_read_b64_tr_b16 a[204:205], v211 offset:8192
    v_mfma_f32_16x16x32_bf16 v[52:55], a[184:187], v[132:135], v[52:55]
    ds_read_b64_tr_b16 a[206:207], v211 offset:12288
    v_mfma_f32_16x16x32_bf16 v[56:59], a[188:191], v[128:131], v[56:59]
    ds_read_b64_tr_b16 a[208:209], v212 offset:8192
    v_mfma_f32_16x16x32_bf16 v[60:63], a[188:191], v[132:135], v[60:63]
    ds_read_b64_tr_b16 a[210:211], v212 offset:12288
    v_mfma_f32_16x16x32_bf16 v[0:3], a[192:195], v[136:139], v[0:3]
    s_waitcnt lgkmcnt(4)
    ds_read_b64_tr_b16 a[212:213], v213 offset:8192
    v_mfma_f32_16x16x32_bf16 v[4:7], a[192:195], v[140:143], v[4:7]
    s_waitcnt vmcnt(5)
    ds_read_b64_tr_b16 a[214:215], v213 offset:12288
    buffer_load_dwordx4 v241, s[32:35], s61 offen offset:3072 nt lds
    v_mfma_f32_16x16x32_bf16 v[8:11], a[196:199], v[136:139], v[8:11]
    ds_read_b64_tr_b16 a[216:217], v214 offset:8192
    v_mfma_f32_16x16x32_bf16 v[12:15], a[196:199], v[140:143], v[12:15]
    ds_read_b64_tr_b16 a[218:219], v214 offset:12288
    v_mfma_f32_16x16x32_bf16 v[16:19], a[200:203], v[136:139], v[16:19]
    s_waitcnt lgkmcnt(4)
    ds_read_b64_tr_b16 a[220:221], v215 offset:8192
    v_mfma_f32_16x16x32_bf16 v[20:23], a[200:203], v[140:143], v[20:23]
    ds_read_b64_tr_b16 a[222:223], v215 offset:12288
    v_mfma_f32_16x16x32_bf16 v[24:27], a[204:207], v[136:139], v[24:27]
    v_mfma_f32_16x16x32_bf16 v[28:31], a[204:207], v[140:143], v[28:31]
    v_mfma_f32_16x16x32_bf16 v[32:35], a[208:211], v[136:139], v[32:35]
    s_waitcnt lgkmcnt(2)
    v_mfma_f32_16x16x32_bf16 v[36:39], a[208:211], v[140:143], v[36:39]
    v_mfma_f32_16x16x32_bf16 v[40:43], a[212:215], v[136:139], v[40:43]
    s_waitcnt vmcnt(4)
    s_barrier
    ds_read_b64_tr_b16 a[160:161], v208 offset:49152
    v_mfma_f32_16x16x32_bf16 v[44:47], a[212:215], v[140:143], v[44:47]
    s_add_u32 m0, s60, 65536
    ds_read_b64_tr_b16 a[162:163], v208 offset:53248
    v_mfma_f32_16x16x32_bf16 v[48:51], a[216:219], v[136:139], v[48:51]
    s_xor_b32 s61, s12, 245760
    s_waitcnt lgkmcnt(2)
    ds_read_b64_tr_b16 a[164:165], v209 offset:49152
    v_mfma_f32_16x16x32_bf16 v[52:55], a[216:219], v[140:143], v[52:55]
    s_waitcnt vmcnt(5)
    ds_read_b64_tr_b16 a[166:167], v209 offset:53248
    buffer_load_dwordx4 v240, s[32:35], s61 offen offset:0 nt lds
    v_mfma_f32_16x16x32_bf16 v[56:59], a[220:223], v[136:139], v[56:59]
    ds_read_b64_tr_b16 a[168:169], v210 offset:49152
    v_mfma_f32_16x16x32_bf16 v[60:63], a[220:223], v[140:143], v[60:63]
    ds_read_b64_tr_b16 a[170:171], v210 offset:53248
    s_bitcmp1_b32 s13, 13
    s_cbranch_scc1 L_resc13
L_rback13:
    v_mfma_f32_16x16x32_bf16 v[192:195], v[236:239], v[144:147], v[192:195]
    s_waitcnt lgkmcnt(4)
    ds_read_b64_tr_b16 a[172:173], v211 offset:49152
    v_mfma_f32_16x16x32_bf16 v[196:199], v[236:239], v[148:151], v[196:199]
    ds_read_b64_tr_b16 a[174:175], v211 offset:53248
    v_mfma_f32_16x16x32_bf16 v[192:195], v[236:239], v[152:155], v[192:195]
    ds_read_b64_tr_b16 a[176:177], v212 offset:49152
    v_mfma_f32_16x16x32_bf16 v[196:199], v[236:239], v[156:159], v[196:199]
    ds_read_b64_tr_b16 a[178:179], v212 offset:53248
    v_mfma_f32_16x16x32_bf16 v[0:3], a[160:163], v[144:147], v[0:3]
    s_waitcnt lgkmcnt(4)
    ds_read_b64_tr_b16 a[180:181], v213 offset:49152
    v_mfma_f32_16x16x32_bf16 v[4:7], a[160:163], v[148:151], v[4:7]
    ds_read_b64_tr_b16 a[182:183], v213 offset:53248
    v_mfma_f32_16x16x32_bf16 v[8:11], a[164:167], v[144:147], v[8:11]
    s_waitcnt vmcnt(5)
    ds_read_b64_tr_b16 a[184:185], v214 offset:49152
    buffer_load_dwordx4 v241, s[32:35], s61 offen offset:1024 nt lds
    v_mfma_f32_16x16x32_bf16 v[12:15], a[164:167], v[148:151], v[12:15]
    ds_read_b64_tr_b16 a[186:187], v214 offset:53248
    v_mfma_f32_16x16x32_bf16 v[16:19], a[168:171], v[144:147], v[16:19]
    s_waitcnt lgkmcnt(4)
    ds_read_b64_tr_b16 a[188:189], v215 offset:49152
    v_mfma_f32_16x16x32_bf16 v[20:23], a[168:171], v[148:151], v[20:23]
    ds_read_b64_tr_b16 a[190:191], v215 offset:53248
    v_mfma_f32_16x16x32_bf16 v[24:27], a[172:175], v[144:147], v[24:27]
    ds_read_b64_tr_b16 a[192:193], v208 offset:57344
    v_mfma_f32_16x16x32_bf16 v[28:31], a[172:175], v[148:151], v[28:31]
    ds_read_b64_tr_b16 a[194:195], v208 offset:61440
    v_mfma_f32_16x16x32_bf16 v[32:35], a[176:179], v[144:147], v[32:35]
    s_waitcnt lgkmcnt(4)
    ds_read_b64_tr_b16 a[196:197], v209 offset:57344
    v_mfma_f32_16x16x32_bf16 v[36:39], a[176:179], v[148:151], v[36:39]
    ds_read_b64_tr_b16 a[198:199], v209 offset:61440
    v_mfma_f32_16x16x32_bf16 v[40:43], a[180:183], v[144:147], v[40:43]
    ds_read_b64_tr_b16 a[200:201], v210 offset:57344
    v_mfma_f32_16x16x32_bf16 v[44:47], a[180:183], v[148:151], v[44:47]
    s_waitcnt vmcnt(5)
    ds_read_b64_tr_b16 a[202:203], v210 offset:61440
    buffer_load_dwordx4 v240, s[32:35], s61 offen offset:2048 nt lds
    v_mfma_f32_16x16x32_bf16 v[48:51], a[184:187], v[144:147], v[48:51]
    s_waitcnt lgkmcnt(4)
    ds_read_b64_tr_b16 a[204:205], v211 offset:57344
    v_mfma_f32_16x16x32_bf16 v[52:55], a[184:187], v[148:151], v[52:55]
    ds_read_b64_tr_b16 a[206:207], v211 offset:61440
    v_mfma_f32_16x16x32_bf16 v[56:59], a[188:191], v[144:147], v[56:59]
    ds_read_b64_tr_b16 a[208:209], v212 offset:57344
    v_mfma_f32_16x16x32_bf16 v[60:63], a[188:191], v[148:151], v[60:63]
    ds_read_b64_tr_b16 a[210:211], v212 offset:61440
    v_mfma_f32_16x16x32_bf16 v[0:3], a[192:195], v[152:155], v[0:3]
    s_waitcnt lgkmcnt(4)
    ds_read_b64_tr_b16 a[212:213], v213 offset:57344
    v_mfma_f32_16x16x32_bf16 v[4:7], a[192:195], v[156:159], v[4:7]
    ds_read_b64_tr_b16 a[214:215], v213 offset:61440
    v_mfma_f32_16x16x32_bf16 v[8:11], a[196:199], v[152:155], v[8:11]
    ds_read_b64_tr_b16 a[216:217], v214 offset:57344
    v_mfma_f32_16x16x32_bf16 v[12:15], a[196:199], v[156:159], v[12:15]
    ds_read_b64_tr_b16 a[218:219], v214 offset:61440
    v_mfma_f32_16x16x32_bf16 v[16:19], a[200:203], v[152:155], v[16:19]
    s_waitcnt vmcnt(5)
    s_waitcnt lgkmcnt(4)
    ds_read_b64_tr_b16 a[220:221], v215 offset:57344
    buffer_load_dwordx4 v241, s[32:35], s61 offen offset:3072 nt lds
    v_mfma_f32_16x16x32_bf16 v[20:23], a[200:203], v[156:159], v[20:23]
    ds_read_b64_tr_b16 a[222:223], v215 offset:61440
    v_mfma_f32_16x16x32_bf16 v[24:27], a[204:207], v[152:155], v[24:27]
    v_mfma_f32_16x16x32_bf16 v[28:31], a[204:207], v[156:159], v[28:31]
    v_mfma_f32_16x16x32_bf16 v[32:35], a[208:211], v[152:155], v[32:35]
    s_waitcnt lgkmcnt(2)
    v_mfma_f32_16x16x32_bf16 v[36:39], a[208:211], v[156:159], v[36:39]
    v_mfma_f32_16x16x32_bf16 v[40:43], a[212:215], v[152:155], v[40:43]
    s_waitcnt vmcnt(4)
    s_barrier
    ds_read_b64_tr_b16 a[160:161], v208 offset:16384
    v_mfma_f32_16x16x32_bf16 v[44:47], a[212:215], v[156:159], v[44:47]
    ds_read_b64_tr_b16 a[162:163], v208 offset:20480
    v_mfma_f32_16x16x32_bf16 v[48:51], a[216:219], v[152:155], v[48:51]
    s_waitcnt lgkmcnt(2)
    ds_read_b64_tr_b16 a[164:165], v209 offset:16384
    v_mfma_f32_16x16x32_bf16 v[52:55], a[216:219], v[156:159], v[52:55]
    ds_read_b64_tr_b16 a[166:167], v209 offset:20480
    v_mfma_f32_16x16x32_bf16 v[56:59], a[220:223], v[152:155], v[56:59]
    ds_read_b64_tr_b16 a[168:169], v210 offset:16384
    v_mfma_f32_16x16x32_bf16 v[60:63], a[220:223], v[156:159], v[60:63]
    ds_read_b64_tr_b16 a[170:171], v210 offset:20480
    s_bitcmp1_b32 s13, 14
    s_cbranch_scc1 L_resc14
L_rback14:
    v_mfma_f32_16x16x32_bf16 v[192:195], v[236:239], v[160:163], v[192:195]
    s_add_u32 m0, s60, 16384
    s_waitcnt lgkmcnt(4)
    ds_read_b64_tr_b16 a[172:173], v211 offset:16384
    v_mfma_f32_16x16x32_bf16 v[196:199], v[236:239], v[164:167], v[196:199]
    ds_read_b64_tr_b16 a[174:175], v211 offset:20480
    v_mfma_f32_16x16x32_bf16 v[192:195], v[236:239], v[168:171], v[192:195]
    ds_read_b64_tr_b16 a[176:177], v212 offset:16384
    v_mfma_f32_16x16x32_bf16 v[196:199], v[236:239], v[172:175], v[196:199]
    ds_read_b64_tr_b16 a[178:179], v212 offset:20480
    v_mfma_f32_16x16x32_bf16 v[0:3], a[160:163], v[160:163], v[0:3]
    s_lshl_b32 s59, s5, 17
    s_waitcnt lgkmcnt(4)
    ds_read_b64_tr_b16 a[180:181], v213 offset:16384
    v_mfma_f32_16x16x32_bf16 v[4:7], a[160:163], v[164:167], v[4:7]
    ds_read_b64_tr_b16 a[182:183], v213 offset:20480
    v_mfma_f32_16x16x32_bf16 v[8:11], a[164:167], v[160:163], v[8:11]
    ds_read_b64_tr_b16 a[184:185], v214 offset:16384
    v_mfma_f32_16x16x32_bf16 v[12:15], a[164:167], v[164:167], v[12:15]
    ds_read_b64_tr_b16 a[186:187], v214 offset:20480
    v_mfma_f32_16x16x32_bf16 v[16:19], a[168:171], v[160:163], v[16:19]
    s_waitcnt lgkmcnt(4)
    ds_read_b64_tr_b16 a[188:189], v215 offset:16384
    v_mfma_f32_16x16x32_bf16 v[20:23], a[168:171], v[164:167], v[20:23]
    ds_read_b64_tr_b16 a[190:191], v215 offset:20480
    buffer_load_dwordx4 v242, s[36:39], s59 offen offset:0 lds
    v_mfma_f32_16x16x32_bf16 v[24:27], a[172:175], v[160:163], v[24:27]
    ds_read_b64_tr_b16 a[192:193], v208 offset:24576
    v_mfma_f32_16x16x32_bf16 v[28:31], a[172:175], v[164:167], v[28:31]
    ds_read_b64_tr_b16 a[194:195], v208 offset:28672
    v_mfma_f32_16x16x32_bf16 v[32:35], a[176:179], v[160:163], v[32:35]
    s_waitcnt lgkmcnt(4)
    ds_read_b64_tr_b16 a[196:197], v209 offset:24576
    v_mfma_f32_16x16x32_bf16 v[36:39], a[176:179], v[164:167], v[36:39]
    ds_read_b64_tr_b16 a[198:199], v209 offset:28672
    v_mfma_f32_16x16x32_bf16 v[40:43], a[180:183], v[160:163], v[40:43]
    ds_read_b64_tr_b16 a[200:201], v210 offset:24576
    buffer_load_dwordx4 v243, s[36:39], s59 offen offset:1024 lds
    v_mfma_f32_16x16x32_bf16 v[44:47], a[180:183], v[164:167], v[44:47]
    ds_read_b64_tr_b16 a[202:203], v210 offset:28672
    v_mfma_f32_16x16x32_bf16 v[48:51], a[184:187], v[160:163], v[48:51]
    s_waitcnt lgkmcnt(4)
    ds_read_b64_tr_b16 a[204:205], v211 offset:24576
    v_mfma_f32_16x16x32_bf16 v[52:55], a[184:187], v[164:167], v[52:55]
    ds_read_b64_tr_b16 a[206:207], v211 offset:28672
    v_mfma_f32_16x16x32_bf16 v[56:59], a[188:191], v[160:163], v[56:59]
    ds_read_b64_tr_b16 a[208:209], v212 offset:24576
    v_mfma_f32_16x16x32_bf16 v[60:63], a[188:191], v[164:167], v[60:63]
    ds_read_b64_tr_b16 a[210:211], v212 offset:28672
    buffer_load_dwordx4 v244, s[36:39], s59 offen offset:2048 lds
    v_mfma_f32_16x16x32_bf16 v[0:3], a[192:195], v[168:171], v[0:3]
    s_waitcnt lgkmcnt(4)
    ds_read_b64_tr_b16 a[212:213], v213 offset:24576
    v_mfma_f32_16x16x32_bf16 v[4:7], a[192:195], v[172:175], v[4:7]
    ds_read_b64_tr_b16 a[214:215], v213 offset:28672
    v_mfma_f32_16x16x32_bf16 v[8:11], a[196:199], v[168:171], v[8:11]
    ds_read_b64_tr_b16 a[216:217], v214 offset:24576
    v_mfma_f32_16x16x32_bf16 v[12:15], a[196:199], v[172:175], v[12:15]
    ds_read_b64_tr_b16 a[218:219], v214 offset:28672
    v_mfma_f32_16x16x32_bf16 v[16:19], a[200:203], v[168:171], v[16:19]
    s_waitcnt lgkmcnt(4)
    ds_read_b64_tr_b16 a[220:221], v215 offset:24576
    buffer_load_dwordx4 v245, s[36:39], s59 offen offset:3072 lds
    v_mfma_f32_16x16x32_bf16 v[20:23], a[200:203], v[172:175], v[20:23]
    ds_read_b64_tr_b16 a[222:223], v215 offset:28672
    v_mfma_f32_16x16x32_bf16 v[24:27], a[204:207], v[168:171], v[24:27]
    v_mfma_f32_16x16x32_bf16 v[28:31], a[204:207], v[172:175], v[28:31]
    v_mfma_f32_16x16x32_bf16 v[32:35], a[208:211], v[168:171], v[32:35]
    s_waitcnt lgkmcnt(2)
    v_mfma_f32_16x16x32_bf16 v[36:39], a[208:211], v[172:175], v[36:39]
    v_mfma_f32_16x16x32_bf16 v[40:43], a[212:215], v[168:171], v[40:43]
    v_mfma_f32_16x16x32_bf16 v[44:47], a[212:215], v[172:175], v[44:47]
    v_mfma_f32_16x16x32_bf16 v[48:51], a[216:219], v[168:171], v[48:51]
    s_waitcnt lgkmcnt(0)
    v_mfma_f32_16x16x32_bf16 v[52:55], a[216:219], v[172:175], v[52:55]
    v_mfma_f32_16x16x32_bf16 v[56:59], a[220:223], v[168:171], v[56:59]
    v_mfma_f32_16x16x32_bf16 v[60:63], a[220:223], v[172:175], v[60:63]

    s_bitcmp1_b32 s13, 15
    s_cbranch_scc1 L_resc15
L_rback15:
    v_mfma_f32_16x16x32_bf16 v[192:195], v[236:239], v[176:179], v[192:195]
    v_mfma_f32_16x16x32_bf16 v[196:199], v[236:239], v[180:183], v[196:199]
    v_mfma_f32_16x16x32_bf16 v[192:195], v[236:239], v[184:187], v[192:195]
    v_mfma_f32_16x16x32_bf16 v[196:199], v[236:239], v[188:191], v[196:199]
    s_lshl_b32 s56, s52, 13
    s_add_u32 s56, s56, s66
    s_waitcnt vmcnt(4) lgkmcnt(0)
    s_barrier
    ds_read_b64_tr_b16 a[160:161], v208 offset:32768
    ds_read_b64_tr_b16 a[162:163], v208 offset:36864
    ds_read_b64_tr_b16 a[192:193], v208 offset:40960
    ds_read_b64_tr_b16 a[194:195], v208 offset:45056
    ds_read_b64_tr_b16 a[164:165], v209 offset:32768
    ds_read_b64_tr_b16 a[166:167], v209 offset:36864
    ds_read_b64_tr_b16 a[196:197], v209 offset:40960
    ds_read_b64_tr_b16 a[198:199], v209 offset:45056
    ds_read_b64_tr_b16 a[168:169], v210 offset:32768
    ds_read_b64_tr_b16 a[170:171], v210 offset:36864
    ds_read_b64_tr_b16 a[200:201], v210 offset:40960
    ds_read_b64_tr_b16 a[202:203], v210 offset:45056
    v_rcp_f32 v204, v192
    v_rcp_f32 v205, v196
    s_waitcnt lgkmcnt(8)
    v_mfma_f32_16x16x32_bf16 v[0:3], a[160:163], v[176:179], v[0:3]
    ds_read_b64_tr_b16 a[172:173], v211 offset:32768
    ds_read_b64_tr_b16 a[174:175], v211 offset:36864
    v_mfma_f32_16x16x32_bf16 v[4:7], a[160:163], v[180:183], v[4:7]
    ds_read_b64_tr_b16 a[204:205], v211 offset:40960
    ds_read_b64_tr_b16 a[206:207], v211 offset:45056
    v_mfma_f32_16x16x32_bf16 v[0:3], a[192:195], v[184:187], v[0:3]
    s_waitcnt lgkmcnt(4)
    ds_read_b64_tr_b16 a[176:177], v212 offset:32768
    ds_read_b64_tr_b16 a[178:179], v212 offset:36864
    v_mfma_f32_16x16x32_bf16 v[4:7], a[192:195], v[188:191], v[4:7]
    ds_read_b64_tr_b16 a[208:209], v212 offset:40960
    ds_read_b64_tr_b16 a[210:211], v212 offset:45056
    v_mfma_f32_16x16x32_bf16 v[8:11], a[164:167], v[176:179], v[8:11]
    ds_read_b64_tr_b16 a[180:181], v213 offset:32768
    ds_read_b64_tr_b16 a[182:183], v213 offset:36864
    v_mfma_f32_16x16x32_bf16 v[12:15], a[164:167], v[180:183], v[12:15]
    ds_read_b64_tr_b16 a[212:213], v213 offset:40960
    ds_read_b64_tr_b16 a[214:215], v213 offset:45056
    v_mfma_f32_16x16x32_bf16 v[8:11], a[196:199], v[184:187], v[8:11]
    s_waitcnt lgkmcnt(4)
    ds_read_b64_tr_b16 a[184:185], v214 offset:32768
    ds_read_b64_tr_b16 a[186:187], v214 offset:36864
    v_mfma_f32_16x16x32_bf16 v[12:15], a[196:199], v[188:191], v[12:15]
    ds_read_b64_tr_b16 a[216:217], v214 offset:40960
    ds_read_b64_tr_b16 a[218:219], v214 offset:45056
    v_mfma_f32_16x16x32_bf16 v[16:19], a[168:171], v[176:179], v[16:19]
    ds_read_b64_tr_b16 a[188:189], v215 offset:32768
    ds_read_b64_tr_b16 a[190:191], v215 offset:36864
    v_mul_f32 v0, v204, v0
    v_mul_f32 v1, v204, v1
    v_mul_f32 v2, v204, v2
    v_mfma_f32_16x16x32_bf16 v[20:23], a[168:171], v[180:183], v[20:23]
    ds_read_b64_tr_b16 a[220:221], v215 offset:40960
    ds_read_b64_tr_b16 a[222:223], v215 offset:45056
    v_mul_f32 v3, v204, v3
    v_cvt_pk_bf16_f32 v64, v0, v1
    v_cvt_pk_bf16_f32 v65, v2, v3
    v_mfma_f32_16x16x32_bf16 v[16:19], a[200:203], v[184:187], v[16:19]
    s_waitcnt lgkmcnt(4)
    v_mul_f32 v4, v205, v4
    v_mul_f32 v5, v205, v5
    v_mul_f32 v6, v205, v6
    v_mfma_f32_16x16x32_bf16 v[20:23], a[200:203], v[188:191], v[20:23]
    v_mul_f32 v7, v205, v7
    v_cvt_pk_bf16_f32 v68, v4, v5
    v_cvt_pk_bf16_f32 v69, v6, v7
    v_mfma_f32_16x16x32_bf16 v[24:27], a[172:175], v[176:179], v[24:27]
    v_mul_f32 v8, v204, v8
    v_mul_f32 v9, v204, v9
    v_mul_f32 v10, v204, v10
    v_mfma_f32_16x16x32_bf16 v[28:31], a[172:175], v[180:183], v[28:31]
    v_mul_f32 v11, v204, v11
    v_cvt_pk_bf16_f32 v66, v8, v9
    v_cvt_pk_bf16_f32 v67, v10, v11
    v_mfma_f32_16x16x32_bf16 v[24:27], a[204:207], v[184:187], v[24:27]
    s_waitcnt lgkmcnt(0)
    v_mul_f32 v12, v205, v12
    v_mul_f32 v13, v205, v13
    v_mul_f32 v14, v205, v14
    v_mfma_f32_16x16x32_bf16 v[28:31], a[204:207], v[188:191], v[28:31]
    v_mul_f32 v15, v205, v15
    v_cvt_pk_bf16_f32 v70, v12, v13
    v_cvt_pk_bf16_f32 v71, v14, v15
    v_mfma_f32_16x16x32_bf16 v[32:35], a[176:179], v[176:179], v[32:35]
    buffer_store_dwordx4 v[64:67], v251, s[40:43], s56 offen offset:0 sc1
    v_mul_f32 v16, v204, v16
    v_mul_f32 v17, v204, v17
    v_mul_f32 v18, v204, v18
    v_mfma_f32_16x16x32_bf16 v[36:39], a[176:179], v[180:183], v[36:39]
    buffer_store_dwordx4 v[68:71], v251, s[40:43], s56 offen offset:1024 sc1
    v_mul_f32 v19, v204, v19
    v_cvt_pk_bf16_f32 v72, v16, v17
    v_cvt_pk_bf16_f32 v73, v18, v19
    v_mfma_f32_16x16x32_bf16 v[32:35], a[208:211], v[184:187], v[32:35]
    v_mul_f32 v20, v205, v20
    v_mul_f32 v21, v205, v21
    v_mul_f32 v22, v205, v22
    v_mfma_f32_16x16x32_bf16 v[36:39], a[208:211], v[188:191], v[36:39]
    v_mul_f32 v23, v205, v23
    v_cvt_pk_bf16_f32 v76, v20, v21
    v_cvt_pk_bf16_f32 v77, v22, v23
    v_mfma_f32_16x16x32_bf16 v[40:43], a[180:183], v[176:179], v[40:43]
    v_mul_f32 v24, v204, v24
    v_mul_f32 v25, v204, v25
    v_mul_f32 v26, v204, v26
    v_mfma_f32_16x16x32_bf16 v[44:47], a[180:183], v[180:183], v[44:47]
    v_mul_f32 v27, v204, v27
    v_cvt_pk_bf16_f32 v74, v24, v25
    v_cvt_pk_bf16_f32 v75, v26, v27
    v_mfma_f32_16x16x32_bf16 v[40:43], a[212:215], v[184:187], v[40:43]
    v_mul_f32 v28, v205, v28
    v_mul_f32 v29, v205, v29
    v_mul_f32 v30, v205, v30
    v_mfma_f32_16x16x32_bf16 v[44:47], a[212:215], v[188:191], v[44:47]
    v_mul_f32 v31, v205, v31
    v_cvt_pk_bf16_f32 v78, v28, v29
    v_cvt_pk_bf16_f32 v79, v30, v31
    v_mfma_f32_16x16x32_bf16 v[48:51], a[184:187], v[176:179], v[48:51]
    buffer_store_dwordx4 v[72:75], v251, s[40:43], s56 offen offset:2048 sc1
    v_mul_f32 v32, v204, v32
    v_mul_f32 v33, v204, v33
    v_mul_f32 v34, v204, v34
    v_mfma_f32_16x16x32_bf16 v[52:55], a[184:187], v[180:183], v[52:55]
    buffer_store_dwordx4 v[76:79], v251, s[40:43], s56 offen offset:3072 sc1
    v_mul_f32 v35, v204, v35
    v_cvt_pk_bf16_f32 v80, v32, v33
    v_cvt_pk_bf16_f32 v81, v34, v35
    v_mfma_f32_16x16x32_bf16 v[48:51], a[216:219], v[184:187], v[48:51]
    v_mul_f32 v36, v205, v36
    v_mul_f32 v37, v205, v37
    v_mul_f32 v38, v205, v38
    v_mfma_f32_16x16x32_bf16 v[52:55], a[216:219], v[188:191], v[52:55]
    v_mul_f32 v39, v205, v39
    v_cvt_pk_bf16_f32 v84, v36, v37
    v_cvt_pk_bf16_f32 v85, v38, v39
    v_mfma_f32_16x16x32_bf16 v[56:59], a[188:191], v[176:179], v[56:59]
    v_mul_f32 v40, v204, v40
    v_mul_f32 v41, v204, v41
    v_mul_f32 v42, v204, v42
    v_mfma_f32_16x16x32_bf16 v[60:63], a[188:191], v[180:183], v[60:63]
    v_mul_f32 v43, v204, v43
    v_cvt_pk_bf16_f32 v82, v40, v41
    v_cvt_pk_bf16_f32 v83, v42, v43
    v_mfma_f32_16x16x32_bf16 v[56:59], a[220:223], v[184:187], v[56:59]
    v_mul_f32 v44, v205, v44
    v_mul_f32 v45, v205, v45
    v_mul_f32 v46, v205, v46
    v_mfma_f32_16x16x32_bf16 v[60:63], a[220:223], v[188:191], v[60:63]
    v_mul_f32 v47, v205, v47
    v_cvt_pk_bf16_f32 v86, v44, v45
    v_cvt_pk_bf16_f32 v87, v46, v47
    buffer_store_dwordx4 v[80:83], v252, s[40:43], s56 offen offset:0 sc1
    buffer_store_dwordx4 v[84:87], v252, s[40:43], s56 offen offset:1024 sc1
    v_mul_f32 v48, v204, v48
    v_mul_f32 v49, v204, v49
    v_mul_f32 v50, v204, v50
    v_mul_f32 v51, v204, v51
    v_cvt_pk_bf16_f32 v88, v48, v49
    v_cvt_pk_bf16_f32 v89, v50, v51
    v_mul_f32 v52, v205, v52
    v_mul_f32 v53, v205, v53
    v_mul_f32 v54, v205, v54
    v_mul_f32 v55, v205, v55
    v_cvt_pk_bf16_f32 v92, v52, v53
    v_cvt_pk_bf16_f32 v93, v54, v55
    v_mul_f32 v56, v204, v56
    v_mul_f32 v57, v204, v57
    v_mul_f32 v58, v204, v58
    v_mul_f32 v59, v204, v59
    v_cvt_pk_bf16_f32 v90, v56, v57
    v_cvt_pk_bf16_f32 v91, v58, v59
    buffer_store_dwordx4 v[88:91], v252, s[40:43], s56 offen offset:2048 sc1
    v_mul_f32 v60, v205, v60
    v_mul_f32 v61, v205, v61
    v_mul_f32 v62, v205, v62
    v_mul_f32 v63, v205, v63
    v_cvt_pk_bf16_f32 v94, v60, v61
    v_cvt_pk_bf16_f32 v95, v62, v63
    buffer_store_dwordx4 v[92:95], v252, s[40:43], s56 offen offset:3072 sc1

    s_add_u32 m0, s60, 32768
    s_lshl_b32 s59, s6, 17
    buffer_load_dwordx4 v242, s[36:39], s59 offen offset:0 lds
    buffer_load_dwordx4 v243, s[36:39], s59 offen offset:1024 lds
    buffer_load_dwordx4 v244, s[36:39], s59 offen offset:2048 lds
    buffer_load_dwordx4 v245, s[36:39], s59 offen offset:3072 lds
    s_add_u32 m0, s60, 0
    s_lshl_b32 s59, s4, 17
    buffer_load_dwordx4 v242, s[36:39], s59 offen offset:0 lds
    buffer_load_dwordx4 v243, s[36:39], s59 offen offset:1024 lds
    buffer_load_dwordx4 v244, s[36:39], s59 offen offset:2048 lds
    buffer_load_dwordx4 v245, s[36:39], s59 offen offset:3072 lds
    s_mov_b32 s65, 0
    v_mov_b32 v208, 1
    v_mov_b32 v209, 1
    v_mov_b32 v210, 1
    v_mov_b32 v211, 1
    s_waitcnt vmcnt(8)
L_cnt:
    v_cmp_ne_u32 vcc, 1, v253
    s_cbranch_vccnz L_cnt2
L_cntok:
    s_barrier
    buffer_store_dwordx4 v[208:211], v247, s[40:43], 0 offen offset:0 sc1
    s_add_u32 m0, s60, 49152
    s_lshl_b32 s59, s7, 17
    buffer_load_dwordx4 v242, s[36:39], s59 offen offset:0 lds
    buffer_load_dwordx4 v243, s[36:39], s59 offen offset:1024 lds
    buffer_load_dwordx4 v244, s[36:39], s59 offen offset:2048 lds
    buffer_load_dwordx4 v245, s[36:39], s59 offen offset:3072 lds
    s_add_u32 m0, s60, 65536
    s_lshl_b32 s59, s8, 17
    buffer_load_dwordx4 v242, s[36:39], s59 offen offset:0 lds
    buffer_load_dwordx4 v243, s[36:39], s59 offen offset:1024 lds
    buffer_load_dwordx4 v244, s[36:39], s59 offen offset:2048 lds
    buffer_load_dwordx4 v245, s[36:39], s59 offen offset:3072 lds
    s_add_u32 m0, s60, 81920
    s_lshl_b32 s59, s9, 17
    buffer_load_dwordx4 v242, s[36:39], s59 offen offset:0 lds
    buffer_load_dwordx4 v243, s[36:39], s59 offen offset:1024 lds
    buffer_load_dwordx4 v244, s[36:39], s59 offen offset:2048 lds
    buffer_load_dwordx4 v245, s[36:39], s59 offen offset:3072 lds
    s_add_u32 m0, s60, 98304
    s_lshl_b32 s59, s10, 17
    buffer_load_dwordx4 v242, s[36:39], s59 offen offset:0 lds
    buffer_load_dwordx4 v243, s[36:39], s59 offen offset:1024 lds
    buffer_load_dwordx4 v244, s[36:39], s59 offen offset:2048 lds
    buffer_load_dwordx4 v245, s[36:39], s59 offen offset:3072 lds
    s_add_u32 m0, s60, 114688
    s_lshl_b32 s59, s11, 17
    buffer_load_dwordx4 v242, s[36:39], s59 offen offset:0 lds
    buffer_load_dwordx4 v243, s[36:39], s59 offen offset:1024 lds
    buffer_load_dwordx4 v244, s[36:39], s59 offen offset:2048 lds
    buffer_load_dwordx4 v245, s[36:39], s59 offen offset:3072 lds
    s_lshl_b32 s5, s5, 13
    s_add_u32 s5, s5, s66
    s_lshl_b32 s6, s6, 13
    s_add_u32 s6, s6, s66
    s_lshl_b32 s7, s7, 13
    s_add_u32 s7, s7, s66
    s_lshl_b32 s8, s8, 13
    s_add_u32 s8, s8, s66
    s_lshl_b32 s9, s9, 13
    s_add_u32 s9, s9, s66
    s_lshl_b32 s10, s10, 13
    s_add_u32 s10, s10, s66
    s_lshl_b32 s11, s11, 13
    s_add_u32 s11, s11, s66
    s_cmp_lg_u32 s48, 1
    s_cbranch_scc1 L_poll1_x
L_poll1:
    buffer_load_dword v200, v249, s[40:43], 0 offen offset:0 sc1
    s_add_u32 s65, s65, 1
    s_cmp_ge_u32 s65, 1048576
    s_cbranch_scc1 L_poll1_x
    s_waitcnt vmcnt(0)
    v_cmp_ne_u32 vcc, 1, v200
    s_cbranch_vccnz L_poll1
L_poll1_x:
    s_waitcnt vmcnt(0)
    s_barrier

    buffer_load_dwordx4 a[32:35], v251, s[40:43], s5 offen offset:0 sc1
    buffer_load_dwordx4 a[36:39], v251, s[40:43], s5 offen offset:1024 sc1
    buffer_load_dwordx4 a[40:43], v251, s[40:43], s5 offen offset:2048 sc1
    buffer_load_dwordx4 a[44:47], v251, s[40:43], s5 offen offset:3072 sc1
    buffer_load_dwordx4 a[48:51], v252, s[40:43], s5 offen offset:0 sc1
    buffer_load_dwordx4 a[52:55], v252, s[40:43], s5 offen offset:1024 sc1
    buffer_load_dwordx4 a[56:59], v252, s[40:43], s5 offen offset:2048 sc1
    buffer_load_dwordx4 a[60:63], v252, s[40:43], s5 offen offset:3072 sc1
    ds_read_b64_tr_b16 v[96:97], v216 offset:0
    ds_read_b64_tr_b16 v[98:99], v216 offset:2048
    ds_read_b64_tr_b16 v[100:101], v217 offset:0
    ds_read_b64_tr_b16 v[102:103], v217 offset:2048
    ds_read_b64_tr_b16 v[104:105], v218 offset:0
    ds_read_b64_tr_b16 v[106:107], v218 offset:2048
    ds_read_b64_tr_b16 v[108:109], v219 offset:0
    ds_read_b64_tr_b16 v[110:111], v219 offset:2048
    ds_read_b64_tr_b16 v[112:113], v216 offset:4096
    ds_read_b64_tr_b16 v[114:115], v216 offset:6144
    s_waitcnt lgkmcnt(0)
    v_mfma_f32_16x16x32_bf16 v[0:3], v[96:99], v[64:67], 0
    ds_read_b64_tr_b16 v[116:117], v217 offset:4096
    v_mfma_f32_16x16x32_bf16 v[16:19], v[96:99], v[68:71], 0
    s_xor_b32 s56, s51, 0
    ds_read_b64_tr_b16 v[118:119], v217 offset:6144
    v_mfma_f32_16x16x32_bf16 v[4:7], v[100:103], v[64:67], 0
    ds_read_b64_tr_b16 v[120:121], v218 offset:4096
    v_mfma_f32_16x16x32_bf16 v[20:23], v[100:103], v[68:71], 0
    s_lshl_b32 s56, s56, 14
    ds_read_b64_tr_b16 v[122:123], v218 offset:6144
    v_mfma_f32_16x16x32_bf16 v[8:11], v[104:107], v[64:67], 0
    ds_read_b64_tr_b16 v[124:125], v219 offset:4096
    v_mfma_f32_16x16x32_bf16 v[24:27], v[104:107], v[68:71], 0
    s_add_u32 s56, s56, s67
    ds_read_b64_tr_b16 v[126:127], v219 offset:6144
    v_mfma_f32_16x16x32_bf16 v[12:15], v[108:111], v[64:67], 0
    ds_read_b64_tr_b16 v[128:129], v216 offset:8192
    v_mfma_f32_16x16x32_bf16 v[28:31], v[108:111], v[68:71], 0
    s_xor_b32 s57, s51, 1
    ds_read_b64_tr_b16 v[130:131], v216 offset:10240
    v_mfma_f32_16x16x32_bf16 v[0:3], v[112:115], v[72:75], v[0:3]
    s_waitcnt lgkmcnt(4)
    ds_read_b64_tr_b16 v[132:133], v217 offset:8192
    v_mfma_f32_16x16x32_bf16 v[16:19], v[112:115], v[76:79], v[16:19]
    s_lshl_b32 s57, s57, 14
    ds_read_b64_tr_b16 v[134:135], v217 offset:10240
    v_mfma_f32_16x16x32_bf16 v[4:7], v[116:119], v[72:75], v[4:7]
    ds_read_b64_tr_b16 v[136:137], v218 offset:8192
    v_mfma_f32_16x16x32_bf16 v[20:23], v[116:119], v[76:79], v[20:23]
    s_add_u32 s57, s57, s67
    ds_read_b64_tr_b16 v[138:139], v218 offset:10240
    v_mfma_f32_16x16x32_bf16 v[8:11], v[120:123], v[72:75], v[8:11]
    s_waitcnt lgkmcnt(4)
    ds_read_b64_tr_b16 v[140:141], v219 offset:8192
    v_mfma_f32_16x16x32_bf16 v[24:27], v[120:123], v[76:79], v[24:27]
    s_xor_b32 s58, s51, 2
    ds_read_b64_tr_b16 v[142:143], v219 offset:10240
    v_mfma_f32_16x16x32_bf16 v[12:15], v[124:127], v[72:75], v[12:15]
    ds_read_b64_tr_b16 v[144:145], v216 offset:12288
    v_mfma_f32_16x16x32_bf16 v[28:31], v[124:127], v[76:79], v[28:31]
    s_lshl_b32 s58, s58, 14
    ds_read_b64_tr_b16 v[146:147], v216 offset:14336
    v_mfma_f32_16x16x32_bf16 v[0:3], v[128:131], v[80:83], v[0:3]
    s_waitcnt lgkmcnt(4)
    ds_read_b64_tr_b16 v[148:149], v217 offset:12288
    v_mfma_f32_16x16x32_bf16 v[16:19], v[128:131], v[84:87], v[16:19]
    s_add_u32 s58, s58, s67
    ds_read_b64_tr_b16 v[150:151], v217 offset:14336
    v_mfma_f32_16x16x32_bf16 v[4:7], v[132:135], v[80:83], v[4:7]
    ds_read_b64_tr_b16 v[152:153], v218 offset:12288
    v_mfma_f32_16x16x32_bf16 v[20:23], v[132:135], v[84:87], v[20:23]
    s_xor_b32 s59, s51, 3
    ds_read_b64_tr_b16 v[154:155], v218 offset:14336
    v_mfma_f32_16x16x32_bf16 v[8:11], v[136:139], v[80:83], v[8:11]
    s_waitcnt lgkmcnt(4)
    ds_read_b64_tr_b16 v[156:157], v219 offset:12288
    v_mfma_f32_16x16x32_bf16 v[24:27], v[136:139], v[84:87], v[24:27]
    s_lshl_b32 s59, s59, 14
    ds_read_b64_tr_b16 v[158:159], v219 offset:14336
    v_mfma_f32_16x16x32_bf16 v[12:15], v[140:143], v[80:83], v[12:15]
    ds_read_b64_tr_b16 v[96:97], v219 offset:16384
    v_mfma_f32_16x16x32_bf16 v[28:31], v[140:143], v[84:87], v[28:31]
    s_add_u32 s59, s59, s67
    ds_read_b64_tr_b16 v[98:99], v219 offset:18432
    v_mfma_f32_16x16x32_bf16 v[0:3], v[144:147], v[88:91], v[0:3]
    s_waitcnt lgkmcnt(4)
    ds_read_b64_tr_b16 v[100:101], v218 offset:16384
    v_mfma_f32_16x16x32_bf16 v[16:19], v[144:147], v[92:95], v[16:19]
    ds_read_b64_tr_b16 v[102:103], v218 offset:18432
    v_mfma_f32_16x16x32_bf16 v[4:7], v[148:151], v[88:91], v[4:7]
    ds_read_b64_tr_b16 v[104:105], v217 offset:16384
    ds_read_b64_tr_b16 v[106:107], v217 offset:18432
    v_mfma_f32_16x16x32_bf16 v[20:23], v[148:151], v[92:95], v[20:23]
    ds_read_b64_tr_b16 v[108:109], v216 offset:16384
    ds_read_b64_tr_b16 v[110:111], v216 offset:18432
    buffer_load_dwordx4 a[64:67], v251, s[40:43], s6 offen offset:0 sc1
    v_mfma_f32_16x16x32_bf16 v[8:11], v[152:155], v[88:91], v[8:11]
    s_waitcnt lgkmcnt(6)
    ds_read_b64_tr_b16 v[112:113], v219 offset:20480
    v_mfma_f32_16x16x32_bf16 v[24:27], v[152:155], v[92:95], v[24:27]
    ds_read_b64_tr_b16 v[114:115], v219 offset:22528
    v_mfma_f32_16x16x32_bf16 v[12:15], v[156:159], v[88:91], v[12:15]
    ds_read_b64_tr_b16 v[116:117], v218 offset:20480
    buffer_load_dwordx4 a[68:71], v251, s[40:43], s6 offen offset:1024 sc1
    v_mfma_f32_16x16x32_bf16 v[28:31], v[156:159], v[92:95], v[28:31]
    s_waitcnt vmcnt(8)
    ds_read_b64_tr_b16 v[118:119], v218 offset:22528
    v_mfma_f32_16x16x32_bf16 v[12:15], v[96:99], a[32:35], v[12:15]
    s_waitcnt lgkmcnt(4)
    ds_read_b64_tr_b16 v[120:121], v217 offset:20480
    ds_read_b64_tr_b16 v[122:123], v217 offset:22528
    v_mfma_f32_16x16x32_bf16 v[28:31], v[96:99], a[36:39], v[28:31]
    ds_read_b64_tr_b16 v[124:125], v216 offset:20480
    ds_read_b64_tr_b16 v[126:127], v216 offset:22528
    buffer_load_dwordx4 a[72:75], v251, s[40:43], s6 offen offset:2048 sc1
    v_mfma_f32_16x16x32_bf16 v[8:11], v[100:103], a[32:35], v[8:11]
    ds_read_b64_tr_b16 v[128:129], v219 offset:24576
    v_mfma_f32_16x16x32_bf16 v[24:27], v[100:103], a[36:39], v[24:27]
    ds_read_b64_tr_b16 v[130:131], v219 offset:26624
    v_mfma_f32_16x16x32_bf16 v[20:23], v[104:107], a[36:39], v[20:23]
    s_waitcnt lgkmcnt(6)
    ds_read_b64_tr_b16 v[132:133], v218 offset:24576
    buffer_load_dwordx4 a[76:79], v251, s[40:43], s6 offen offset:3072 sc1
    v_mfma_f32_16x16x32_bf16 v[16:19], v[108:111], a[36:39], v[16:19]
    s_waitcnt vmcnt(8)
    ds_read_b64_tr_b16 v[134:135], v218 offset:26624
    v_mfma_f32_16x16x32_bf16 v[12:15], v[112:115], a[40:43], v[12:15]
    ds_read_b64_tr_b16 v[136:137], v217 offset:24576
    ds_read_b64_tr_b16 v[138:139], v217 offset:26624
    v_mfma_f32_16x16x32_bf16 v[28:31], v[112:115], a[44:47], v[28:31]
    ds_read_b64_tr_b16 v[140:141], v216 offset:24576
    ds_read_b64_tr_b16 v[142:143], v216 offset:26624
    buffer_load_dwordx4 a[80:83], v252, s[40:43], s6 offen offset:0 sc1
    v_mfma_f32_16x16x32_bf16 v[8:11], v[116:119], a[40:43], v[8:11]
    s_waitcnt lgkmcnt(6)
    ds_read_b64_tr_b16 v[144:145], v219 offset:28672
    v_mfma_f32_16x16x32_bf16 v[24:27], v[116:119], a[44:47], v[24:27]
    ds_read_b64_tr_b16 v[146:147], v219 offset:30720
    v_mfma_f32_16x16x32_bf16 v[20:23], v[120:123], a[44:47], v[20:23]
    ds_read_b64_tr_b16 v[148:149], v218 offset:28672
    buffer_load_dwordx4 a[84:87], v252, s[40:43], s6 offen offset:1024 sc1
    v_mfma_f32_16x16x32_bf16 v[16:19], v[124:127], a[44:47], v[16:19]
    s_waitcnt vmcnt(8)
    ds_read_b64_tr_b16 v[150:151], v218 offset:30720
    v_mfma_f32_16x16x32_bf16 v[12:15], v[128:131], a[48:51], v[12:15]
    s_waitcnt lgkmcnt(4)
    ds_read_b64_tr_b16 v[152:153], v217 offset:28672
    ds_read_b64_tr_b16 v[154:155], v217 offset:30720
    v_mfma_f32_16x16x32_bf16 v[28:31], v[128:131], a[52:55], v[28:31]
    ds_read_b64_tr_b16 v[156:157], v216 offset:28672
    ds_read_b64_tr_b16 v[158:159], v216 offset:30720
    buffer_load_dwordx4 a[88:91], v252, s[40:43], s6 offen offset:2048 sc1
    v_mfma_f32_16x16x32_bf16 v[8:11], v[132:135], a[48:51], v[8:11]
    ds_read_b64_tr_b16 v[96:97], v219 offset:32768
    v_mfma_f32_16x16x32_bf16 v[24:27], v[132:135], a[52:55], v[24:27]
    ds_read_b64_tr_b16 v[98:99], v219 offset:34816
    v_mfma_f32_16x16x32_bf16 v[20:23], v[136:139], a[52:55], v[20:23]
    s_waitcnt lgkmcnt(6)
    ds_read_b64_tr_b16 v[100:101], v218 offset:32768
    buffer_load_dwordx4 a[92:95], v252, s[40:43], s6 offen offset:3072 sc1
    v_mfma_f32_16x16x32_bf16 v[16:19], v[140:143], a[52:55], v[16:19]
    s_waitcnt vmcnt(8)
    ds_read_b64_tr_b16 v[102:103], v218 offset:34816
    v_mfma_f32_16x16x32_bf16 v[12:15], v[144:147], a[56:59], v[12:15]
    ds_read_b64_tr_b16 v[104:105], v217 offset:32768
    ds_read_b64_tr_b16 v[106:107], v217 offset:34816
    v_mfma_f32_16x16x32_bf16 v[28:31], v[144:147], a[60:63], v[28:31]
    ds_read_b64_tr_b16 v[108:109], v216 offset:32768
    ds_read_b64_tr_b16 v[110:111], v216 offset:34816
    buffer_load_dwordx4 a[96:99], v251, s[40:43], s7 offen offset:0 sc1
    v_mfma_f32_16x16x32_bf16 v[8:11], v[148:151], a[56:59], v[8:11]
    s_waitcnt lgkmcnt(6)
    ds_read_b64_tr_b16 v[112:113], v219 offset:36864
    v_mfma_f32_16x16x32_bf16 v[24:27], v[148:151], a[60:63], v[24:27]
    ds_read_b64_tr_b16 v[114:115], v219 offset:38912
    v_mfma_f32_16x16x32_bf16 v[20:23], v[152:155], a[60:63], v[20:23]
    ds_read_b64_tr_b16 v[116:117], v218 offset:36864
    buffer_load_dwordx4 a[100:103], v251, s[40:43], s7 offen offset:1024 sc1
    v_mfma_f32_16x16x32_bf16 v[16:19], v[156:159], a[60:63], v[16:19]
    s_waitcnt vmcnt(8)
    ds_read_b64_tr_b16 v[118:119], v218 offset:38912
    v_mfma_f32_16x16x32_bf16 v[12:15], v[96:99], a[64:67], v[12:15]
    s_waitcnt lgkmcnt(4)
    ds_read_b64_tr_b16 v[120:121], v217 offset:36864
    ds_read_b64_tr_b16 v[122:123], v217 offset:38912
    v_mfma_f32_16x16x32_bf16 v[28:31], v[96:99], a[68:71], v[28:31]
    ds_read_b64_tr_b16 v[124:125], v216 offset:36864
    ds_read_b64_tr_b16 v[126:127], v216 offset:38912
    buffer_load_dwordx4 a[104:107], v251, s[40:43], s7 offen offset:2048 sc1
    v_mfma_f32_16x16x32_bf16 v[8:11], v[100:103], a[64:67], v[8:11]
    ds_read_b64_tr_b16 v[128:129], v219 offset:40960
    v_mfma_f32_16x16x32_bf16 v[24:27], v[100:103], a[68:71], v[24:27]
    ds_read_b64_tr_b16 v[130:131], v219 offset:43008
    v_mfma_f32_16x16x32_bf16 v[20:23], v[104:107], a[68:71], v[20:23]
    s_waitcnt lgkmcnt(6)
    ds_read_b64_tr_b16 v[132:133], v218 offset:40960
    buffer_load_dwordx4 a[108:111], v251, s[40:43], s7 offen offset:3072 sc1
    v_mfma_f32_16x16x32_bf16 v[16:19], v[108:111], a[68:71], v[16:19]
    s_waitcnt vmcnt(8)
    ds_read_b64_tr_b16 v[134:135], v218 offset:43008
    v_mfma_f32_16x16x32_bf16 v[12:15], v[112:115], a[72:75], v[12:15]
    ds_read_b64_tr_b16 v[136:137], v217 offset:40960
    ds_read_b64_tr_b16 v[138:139], v217 offset:43008
    v_mfma_f32_16x16x32_bf16 v[28:31], v[112:115], a[76:79], v[28:31]
    ds_read_b64_tr_b16 v[140:141], v216 offset:40960
    ds_read_b64_tr_b16 v[142:143], v216 offset:43008
    buffer_load_dwordx4 a[112:115], v252, s[40:43], s7 offen offset:0 sc1
    v_mfma_f32_16x16x32_bf16 v[8:11], v[116:119], a[72:75], v[8:11]
    s_waitcnt lgkmcnt(6)
    ds_read_b64_tr_b16 v[144:145], v219 offset:45056
    v_mfma_f32_16x16x32_bf16 v[24:27], v[116:119], a[76:79], v[24:27]
    ds_read_b64_tr_b16 v[146:147], v219 offset:47104
    v_mfma_f32_16x16x32_bf16 v[20:23], v[120:123], a[76:79], v[20:23]
    ds_read_b64_tr_b16 v[148:149], v218 offset:45056
    buffer_load_dwordx4 a[116:119], v252, s[40:43], s7 offen offset:1024 sc1
    v_mfma_f32_16x16x32_bf16 v[16:19], v[124:127], a[76:79], v[16:19]
    s_waitcnt vmcnt(8)
    ds_read_b64_tr_b16 v[150:151], v218 offset:47104
    v_mfma_f32_16x16x32_bf16 v[12:15], v[128:131], a[80:83], v[12:15]
    s_waitcnt lgkmcnt(4)
    ds_read_b64_tr_b16 v[152:153], v217 offset:45056
    ds_read_b64_tr_b16 v[154:155], v217 offset:47104
    v_mfma_f32_16x16x32_bf16 v[28:31], v[128:131], a[84:87], v[28:31]
    ds_read_b64_tr_b16 v[156:157], v216 offset:45056
    ds_read_b64_tr_b16 v[158:159], v216 offset:47104
    buffer_load_dwordx4 a[120:123], v252, s[40:43], s7 offen offset:2048 sc1
    v_mfma_f32_16x16x32_bf16 v[8:11], v[132:135], a[80:83], v[8:11]
    ds_read_b64_tr_b16 v[96:97], v219 offset:49152
    v_mfma_f32_16x16x32_bf16 v[24:27], v[132:135], a[84:87], v[24:27]
    ds_read_b64_tr_b16 v[98:99], v219 offset:51200
    v_mfma_f32_16x16x32_bf16 v[20:23], v[136:139], a[84:87], v[20:23]
    s_waitcnt lgkmcnt(6)
    ds_read_b64_tr_b16 v[100:101], v218 offset:49152
    buffer_load_dwordx4 a[124:127], v252, s[40:43], s7 offen offset:3072 sc1
    v_mfma_f32_16x16x32_bf16 v[16:19], v[140:143], a[84:87], v[16:19]
    s_waitcnt vmcnt(8)
    ds_read_b64_tr_b16 v[102:103], v218 offset:51200
    v_mfma_f32_16x16x32_bf16 v[12:15], v[144:147], a[88:91], v[12:15]
    ds_read_b64_tr_b16 v[104:105], v217 offset:49152
    ds_read_b64_tr_b16 v[106:107], v217 offset:51200
    v_mfma_f32_16x16x32_bf16 v[28:31], v[144:147], a[92:95], v[28:31]
    ds_read_b64_tr_b16 v[108:109], v216 offset:49152
    ds_read_b64_tr_b16 v[110:111], v216 offset:51200
    buffer_load_dwordx4 a[128:131], v251, s[40:43], s8 offen offset:0 sc1
    v_mfma_f32_16x16x32_bf16 v[8:11], v[148:151], a[88:91], v[8:11]
    s_waitcnt lgkmcnt(6)
    ds_read_b64_tr_b16 v[112:113], v219 offset:53248
    v_mfma_f32_16x16x32_bf16 v[24:27], v[148:151], a[92:95], v[24:27]
    ds_read_b64_tr_b16 v[114:115], v219 offset:55296
    v_mfma_f32_16x16x32_bf16 v[20:23], v[152:155], a[92:95], v[20:23]
    ds_read_b64_tr_b16 v[116:117], v218 offset:53248
    buffer_load_dwordx4 a[132:135], v251, s[40:43], s8 offen offset:1024 sc1
    v_mfma_f32_16x16x32_bf16 v[16:19], v[156:159], a[92:95], v[16:19]
    s_waitcnt vmcnt(8)
    ds_read_b64_tr_b16 v[118:119], v218 offset:55296
    v_mfma_f32_16x16x32_bf16 v[12:15], v[96:99], a[96:99], v[12:15]
    s_waitcnt lgkmcnt(4)
    ds_read_b64_tr_b16 v[120:121], v217 offset:53248
    ds_read_b64_tr_b16 v[122:123], v217 offset:55296
    v_mfma_f32_16x16x32_bf16 v[28:31], v[96:99], a[100:103], v[28:31]
    ds_read_b64_tr_b16 v[124:125], v216 offset:53248
    ds_read_b64_tr_b16 v[126:127], v216 offset:55296
    buffer_load_dwordx4 a[136:139], v251, s[40:43], s8 offen offset:2048 sc1
    v_mfma_f32_16x16x32_bf16 v[8:11], v[100:103], a[96:99], v[8:11]
    ds_read_b64_tr_b16 v[128:129], v219 offset:57344
    v_mfma_f32_16x16x32_bf16 v[24:27], v[100:103], a[100:103], v[24:27]
    ds_read_b64_tr_b16 v[130:131], v219 offset:59392
    v_mfma_f32_16x16x32_bf16 v[20:23], v[104:107], a[100:103], v[20:23]
    s_waitcnt lgkmcnt(6)
    ds_read_b64_tr_b16 v[132:133], v218 offset:57344
    buffer_load_dwordx4 a[140:143], v251, s[40:43], s8 offen offset:3072 sc1
    v_mfma_f32_16x16x32_bf16 v[16:19], v[108:111], a[100:103], v[16:19]
    s_waitcnt vmcnt(8)
    ds_read_b64_tr_b16 v[134:135], v218 offset:59392
    v_mfma_f32_16x16x32_bf16 v[12:15], v[112:115], a[104:107], v[12:15]
    ds_read_b64_tr_b16 v[136:137], v217 offset:57344
    ds_read_b64_tr_b16 v[138:139], v217 offset:59392
    v_mfma_f32_16x16x32_bf16 v[28:31], v[112:115], a[108:111], v[28:31]
    ds_read_b64_tr_b16 v[140:141], v216 offset:57344
    ds_read_b64_tr_b16 v[142:143], v216 offset:59392
    buffer_load_dwordx4 a[144:147], v252, s[40:43], s8 offen offset:0 sc1
    v_mfma_f32_16x16x32_bf16 v[8:11], v[116:119], a[104:107], v[8:11]
    s_waitcnt lgkmcnt(6)
    ds_read_b64_tr_b16 v[144:145], v219 offset:61440
    v_mfma_f32_16x16x32_bf16 v[24:27], v[116:119], a[108:111], v[24:27]
    ds_read_b64_tr_b16 v[146:147], v219 offset:63488
    v_mfma_f32_16x16x32_bf16 v[20:23], v[120:123], a[108:111], v[20:23]
    ds_read_b64_tr_b16 v[148:149], v218 offset:61440
    buffer_load_dwordx4 a[148:151], v252, s[40:43], s8 offen offset:1024 sc1
    v_mfma_f32_16x16x32_bf16 v[16:19], v[124:127], a[108:111], v[16:19]
    s_waitcnt vmcnt(8)
    ds_read_b64_tr_b16 v[150:151], v218 offset:63488
    v_mfma_f32_16x16x32_bf16 v[12:15], v[128:131], a[112:115], v[12:15]
    s_waitcnt lgkmcnt(4)
    ds_read_b64_tr_b16 v[152:153], v217 offset:61440
    ds_read_b64_tr_b16 v[154:155], v217 offset:63488
    v_mfma_f32_16x16x32_bf16 v[28:31], v[128:131], a[116:119], v[28:31]
    ds_read_b64_tr_b16 v[156:157], v216 offset:61440
    ds_read_b64_tr_b16 v[158:159], v216 offset:63488
    buffer_load_dwordx4 a[152:155], v252, s[40:43], s8 offen offset:2048 sc1
    v_mfma_f32_16x16x32_bf16 v[8:11], v[132:135], a[112:115], v[8:11]
    ds_read_b64_tr_b16 v[96:97], v223 offset:0
    v_mfma_f32_16x16x32_bf16 v[24:27], v[132:135], a[116:119], v[24:27]
    ds_read_b64_tr_b16 v[98:99], v223 offset:2048
    v_mfma_f32_16x16x32_bf16 v[20:23], v[136:139], a[116:119], v[20:23]
    s_waitcnt lgkmcnt(6)
    ds_read_b64_tr_b16 v[100:101], v222 offset:0
    buffer_load_dwordx4 a[156:159], v252, s[40:43], s8 offen offset:3072 sc1
    v_mfma_f32_16x16x32_bf16 v[16:19], v[140:143], a[116:119], v[16:19]
    s_waitcnt vmcnt(8)
    ds_read_b64_tr_b16 v[102:103], v222 offset:2048
    v_mfma_f32_16x16x32_bf16 v[12:15], v[144:147], a[120:123], v[12:15]
    ds_read_b64_tr_b16 v[104:105], v221 offset:0
    ds_read_b64_tr_b16 v[106:107], v221 offset:2048
    v_mfma_f32_16x16x32_bf16 v[28:31], v[144:147], a[124:127], v[28:31]
    ds_read_b64_tr_b16 v[108:109], v220 offset:0
    ds_read_b64_tr_b16 v[110:111], v220 offset:2048
    buffer_load_dwordx4 a[160:163], v251, s[40:43], s9 offen offset:0 sc1
    v_mfma_f32_16x16x32_bf16 v[8:11], v[148:151], a[120:123], v[8:11]
    s_waitcnt lgkmcnt(6)
    ds_read_b64_tr_b16 v[112:113], v223 offset:4096
    v_mfma_f32_16x16x32_bf16 v[24:27], v[148:151], a[124:127], v[24:27]
    ds_read_b64_tr_b16 v[114:115], v223 offset:6144
    v_mfma_f32_16x16x32_bf16 v[20:23], v[152:155], a[124:127], v[20:23]
    ds_read_b64_tr_b16 v[116:117], v222 offset:4096
    buffer_load_dwordx4 a[164:167], v251, s[40:43], s9 offen offset:1024 sc1
    v_mfma_f32_16x16x32_bf16 v[16:19], v[156:159], a[124:127], v[16:19]
    s_waitcnt vmcnt(8)
    ds_read_b64_tr_b16 v[118:119], v222 offset:6144
    v_mfma_f32_16x16x32_bf16 v[12:15], v[96:99], a[128:131], v[12:15]
    s_waitcnt lgkmcnt(4)
    ds_read_b64_tr_b16 v[120:121], v221 offset:4096
    ds_read_b64_tr_b16 v[122:123], v221 offset:6144
    v_mfma_f32_16x16x32_bf16 v[28:31], v[96:99], a[132:135], v[28:31]
    ds_read_b64_tr_b16 v[124:125], v220 offset:4096
    ds_read_b64_tr_b16 v[126:127], v220 offset:6144
    buffer_load_dwordx4 a[168:171], v251, s[40:43], s9 offen offset:2048 sc1
    v_mfma_f32_16x16x32_bf16 v[8:11], v[100:103], a[128:131], v[8:11]
    ds_read_b64_tr_b16 v[128:129], v223 offset:8192
    v_mfma_f32_16x16x32_bf16 v[24:27], v[100:103], a[132:135], v[24:27]
    ds_read_b64_tr_b16 v[130:131], v223 offset:10240
    v_mfma_f32_16x16x32_bf16 v[20:23], v[104:107], a[132:135], v[20:23]
    s_waitcnt lgkmcnt(6)
    ds_read_b64_tr_b16 v[132:133], v222 offset:8192
    buffer_load_dwordx4 a[172:175], v251, s[40:43], s9 offen offset:3072 sc1
    v_mfma_f32_16x16x32_bf16 v[16:19], v[108:111], a[132:135], v[16:19]
    s_waitcnt vmcnt(8)
    ds_read_b64_tr_b16 v[134:135], v222 offset:10240
    v_mfma_f32_16x16x32_bf16 v[12:15], v[112:115], a[136:139], v[12:15]
    ds_read_b64_tr_b16 v[136:137], v221 offset:8192
    ds_read_b64_tr_b16 v[138:139], v221 offset:10240
    v_mfma_f32_16x16x32_bf16 v[28:31], v[112:115], a[140:143], v[28:31]
    ds_read_b64_tr_b16 v[140:141], v220 offset:8192
    ds_read_b64_tr_b16 v[142:143], v220 offset:10240
    buffer_load_dwordx4 a[176:179], v252, s[40:43], s9 offen offset:0 sc1
    v_mfma_f32_16x16x32_bf16 v[8:11], v[116:119], a[136:139], v[8:11]
    s_waitcnt lgkmcnt(6)
    ds_read_b64_tr_b16 v[144:145], v223 offset:12288
    v_mfma_f32_16x16x32_bf16 v[24:27], v[116:119], a[140:143], v[24:27]
    ds_read_b64_tr_b16 v[146:147], v223 offset:14336
    v_mfma_f32_16x16x32_bf16 v[20:23], v[120:123], a[140:143], v[20:23]
    ds_read_b64_tr_b16 v[148:149], v222 offset:12288
    buffer_load_dwordx4 a[180:183], v252, s[40:43], s9 offen offset:1024 sc1
    v_mfma_f32_16x16x32_bf16 v[16:19], v[124:127], a[140:143], v[16:19]
    s_waitcnt vmcnt(8)
    ds_read_b64_tr_b16 v[150:151], v222 offset:14336
    v_mfma_f32_16x16x32_bf16 v[12:15], v[128:131], a[144:147], v[12:15]
    s_waitcnt lgkmcnt(4)
    ds_read_b64_tr_b16 v[152:153], v221 offset:12288
    ds_read_b64_tr_b16 v[154:155], v221 offset:14336
    v_mfma_f32_16x16x32_bf16 v[28:31], v[128:131], a[148:151], v[28:31]
    ds_read_b64_tr_b16 v[156:157], v220 offset:12288
    ds_read_b64_tr_b16 v[158:159], v220 offset:14336
    buffer_load_dwordx4 a[184:187], v252, s[40:43], s9 offen offset:2048 sc1
    v_mfma_f32_16x16x32_bf16 v[8:11], v[132:135], a[144:147], v[8:11]
    ds_read_b64_tr_b16 v[96:97], v223 offset:16384
    v_mfma_f32_16x16x32_bf16 v[24:27], v[132:135], a[148:151], v[24:27]
    ds_read_b64_tr_b16 v[98:99], v223 offset:18432
    v_mfma_f32_16x16x32_bf16 v[20:23], v[136:139], a[148:151], v[20:23]
    s_waitcnt lgkmcnt(6)
    ds_read_b64_tr_b16 v[100:101], v222 offset:16384
    buffer_load_dwordx4 a[188:191], v252, s[40:43], s9 offen offset:3072 sc1
    v_mfma_f32_16x16x32_bf16 v[16:19], v[140:143], a[148:151], v[16:19]
    s_waitcnt vmcnt(8)
    ds_read_b64_tr_b16 v[102:103], v222 offset:18432
    v_mfma_f32_16x16x32_bf16 v[12:15], v[144:147], a[152:155], v[12:15]
    ds_read_b64_tr_b16 v[104:105], v221 offset:16384
    ds_read_b64_tr_b16 v[106:107], v221 offset:18432
    v_mfma_f32_16x16x32_bf16 v[28:31], v[144:147], a[156:159], v[28:31]
    ds_read_b64_tr_b16 v[108:109], v220 offset:16384
    ds_read_b64_tr_b16 v[110:111], v220 offset:18432
    buffer_load_dwordx4 a[192:195], v251, s[40:43], s10 offen offset:0 sc1
    v_mfma_f32_16x16x32_bf16 v[8:11], v[148:151], a[152:155], v[8:11]
    s_waitcnt lgkmcnt(6)
    ds_read_b64_tr_b16 v[112:113], v223 offset:20480
    v_mfma_f32_16x16x32_bf16 v[24:27], v[148:151], a[156:159], v[24:27]
    ds_read_b64_tr_b16 v[114:115], v223 offset:22528
    v_mfma_f32_16x16x32_bf16 v[20:23], v[152:155], a[156:159], v[20:23]
    ds_read_b64_tr_b16 v[116:117], v222 offset:20480
    buffer_load_dwordx4 a[196:199], v251, s[40:43], s10 offen offset:1024 sc1
    v_mfma_f32_16x16x32_bf16 v[16:19], v[156:159], a[156:159], v[16:19]
    s_waitcnt vmcnt(8)
    ds_read_b64_tr_b16 v[118:119], v222 offset:22528
    v_mfma_f32_16x16x32_bf16 v[12:15], v[96:99], a[160:163], v[12:15]
    s_waitcnt lgkmcnt(4)
    ds_read_b64_tr_b16 v[120:121], v221 offset:20480
    ds_read_b64_tr_b16 v[122:123], v221 offset:22528
    v_mfma_f32_16x16x32_bf16 v[28:31], v[96:99], a[164:167], v[28:31]
    ds_read_b64_tr_b16 v[124:125], v220 offset:20480
    ds_read_b64_tr_b16 v[126:127], v220 offset:22528
    buffer_load_dwordx4 a[200:203], v251, s[40:43], s10 offen offset:2048 sc1
    v_mfma_f32_16x16x32_bf16 v[8:11], v[100:103], a[160:163], v[8:11]
    ds_read_b64_tr_b16 v[128:129], v223 offset:24576
    v_mfma_f32_16x16x32_bf16 v[24:27], v[100:103], a[164:167], v[24:27]
    ds_read_b64_tr_b16 v[130:131], v223 offset:26624
    v_mfma_f32_16x16x32_bf16 v[20:23], v[104:107], a[164:167], v[20:23]
    s_waitcnt lgkmcnt(6)
    ds_read_b64_tr_b16 v[132:133], v222 offset:24576
    buffer_load_dwordx4 a[204:207], v251, s[40:43], s10 offen offset:3072 sc1
    v_mfma_f32_16x16x32_bf16 v[16:19], v[108:111], a[164:167], v[16:19]
    s_waitcnt vmcnt(8)
    ds_read_b64_tr_b16 v[134:135], v222 offset:26624
    v_mfma_f32_16x16x32_bf16 v[12:15], v[112:115], a[168:171], v[12:15]
    ds_read_b64_tr_b16 v[136:137], v221 offset:24576
    ds_read_b64_tr_b16 v[138:139], v221 offset:26624
    v_mfma_f32_16x16x32_bf16 v[28:31], v[112:115], a[172:175], v[28:31]
    ds_read_b64_tr_b16 v[140:141], v220 offset:24576
    ds_read_b64_tr_b16 v[142:143], v220 offset:26624
    buffer_load_dwordx4 a[208:211], v252, s[40:43], s10 offen offset:0 sc1
    v_mfma_f32_16x16x32_bf16 v[8:11], v[116:119], a[168:171], v[8:11]
    s_waitcnt lgkmcnt(6)
    ds_read_b64_tr_b16 v[144:145], v223 offset:28672
    v_mfma_f32_16x16x32_bf16 v[24:27], v[116:119], a[172:175], v[24:27]
    ds_read_b64_tr_b16 v[146:147], v223 offset:30720
    v_mfma_f32_16x16x32_bf16 v[20:23], v[120:123], a[172:175], v[20:23]
    ds_read_b64_tr_b16 v[148:149], v222 offset:28672
    buffer_load_dwordx4 a[212:215], v252, s[40:43], s10 offen offset:1024 sc1
    v_mfma_f32_16x16x32_bf16 v[16:19], v[124:127], a[172:175], v[16:19]
    s_waitcnt vmcnt(8)
    ds_read_b64_tr_b16 v[150:151], v222 offset:30720
    v_mfma_f32_16x16x32_bf16 v[12:15], v[128:131], a[176:179], v[12:15]
    s_waitcnt lgkmcnt(4)
    ds_read_b64_tr_b16 v[152:153], v221 offset:28672
    ds_read_b64_tr_b16 v[154:155], v221 offset:30720
    v_mfma_f32_16x16x32_bf16 v[28:31], v[128:131], a[180:183], v[28:31]
    ds_read_b64_tr_b16 v[156:157], v220 offset:28672
    ds_read_b64_tr_b16 v[158:159], v220 offset:30720
    buffer_load_dwordx4 a[216:219], v252, s[40:43], s10 offen offset:2048 sc1
    v_mfma_f32_16x16x32_bf16 v[8:11], v[132:135], a[176:179], v[8:11]
    ds_read_b64_tr_b16 v[96:97], v223 offset:32768
    v_mfma_f32_16x16x32_bf16 v[24:27], v[132:135], a[180:183], v[24:27]
    ds_read_b64_tr_b16 v[98:99], v223 offset:34816
    v_mfma_f32_16x16x32_bf16 v[20:23], v[136:139], a[180:183], v[20:23]
    s_waitcnt lgkmcnt(6)
    ds_read_b64_tr_b16 v[100:101], v222 offset:32768
    buffer_load_dwordx4 a[220:223], v252, s[40:43], s10 offen offset:3072 sc1
    v_mfma_f32_16x16x32_bf16 v[16:19], v[140:143], a[180:183], v[16:19]
    s_waitcnt vmcnt(8)
    ds_read_b64_tr_b16 v[102:103], v222 offset:34816
    v_mfma_f32_16x16x32_bf16 v[12:15], v[144:147], a[184:187], v[12:15]
    ds_read_b64_tr_b16 v[104:105], v221 offset:32768
    ds_read_b64_tr_b16 v[106:107], v221 offset:34816
    v_mfma_f32_16x16x32_bf16 v[28:31], v[144:147], a[188:191], v[28:31]
    ds_read_b64_tr_b16 v[108:109], v220 offset:32768
    ds_read_b64_tr_b16 v[110:111], v220 offset:34816
    buffer_load_dwordx4 a[224:227], v251, s[40:43], s11 offen offset:0 sc1
    v_mfma_f32_16x16x32_bf16 v[8:11], v[148:151], a[184:187], v[8:11]
    s_waitcnt lgkmcnt(6)
    ds_read_b64_tr_b16 v[112:113], v223 offset:36864
    v_mfma_f32_16x16x32_bf16 v[24:27], v[148:151], a[188:191], v[24:27]
    ds_read_b64_tr_b16 v[114:115], v223 offset:38912
    v_mfma_f32_16x16x32_bf16 v[20:23], v[152:155], a[188:191], v[20:23]
    ds_read_b64_tr_b16 v[116:117], v222 offset:36864
    buffer_load_dwordx4 a[228:231], v251, s[40:43], s11 offen offset:1024 sc1
    v_mfma_f32_16x16x32_bf16 v[16:19], v[156:159], a[188:191], v[16:19]
    s_waitcnt vmcnt(8)
    ds_read_b64_tr_b16 v[118:119], v222 offset:38912
    v_mfma_f32_16x16x32_bf16 v[12:15], v[96:99], a[192:195], v[12:15]
    s_waitcnt lgkmcnt(4)
    ds_read_b64_tr_b16 v[120:121], v221 offset:36864
    ds_read_b64_tr_b16 v[122:123], v221 offset:38912
    v_mfma_f32_16x16x32_bf16 v[28:31], v[96:99], a[196:199], v[28:31]
    ds_read_b64_tr_b16 v[124:125], v220 offset:36864
    ds_read_b64_tr_b16 v[126:127], v220 offset:38912
    buffer_load_dwordx4 a[232:235], v251, s[40:43], s11 offen offset:2048 sc1
    v_mfma_f32_16x16x32_bf16 v[8:11], v[100:103], a[192:195], v[8:11]
    ds_read_b64_tr_b16 v[128:129], v223 offset:40960
    v_mfma_f32_16x16x32_bf16 v[24:27], v[100:103], a[196:199], v[24:27]
    ds_read_b64_tr_b16 v[130:131], v223 offset:43008
    v_mfma_f32_16x16x32_bf16 v[20:23], v[104:107], a[196:199], v[20:23]
    s_waitcnt lgkmcnt(6)
    ds_read_b64_tr_b16 v[132:133], v222 offset:40960
    buffer_load_dwordx4 a[236:239], v251, s[40:43], s11 offen offset:3072 sc1
    v_mfma_f32_16x16x32_bf16 v[16:19], v[108:111], a[196:199], v[16:19]
    s_waitcnt vmcnt(8)
    ds_read_b64_tr_b16 v[134:135], v222 offset:43008
    v_mfma_f32_16x16x32_bf16 v[12:15], v[112:115], a[200:203], v[12:15]
    ds_read_b64_tr_b16 v[136:137], v221 offset:40960
    ds_read_b64_tr_b16 v[138:139], v221 offset:43008
    v_mfma_f32_16x16x32_bf16 v[28:31], v[112:115], a[204:207], v[28:31]
    ds_read_b64_tr_b16 v[140:141], v220 offset:40960
    ds_read_b64_tr_b16 v[142:143], v220 offset:43008
    buffer_load_dwordx4 a[240:243], v252, s[40:43], s11 offen offset:0 sc1
    v_mfma_f32_16x16x32_bf16 v[8:11], v[116:119], a[200:203], v[8:11]
    s_waitcnt lgkmcnt(6)
    ds_read_b64_tr_b16 v[144:145], v223 offset:45056
    v_mfma_f32_16x16x32_bf16 v[24:27], v[116:119], a[204:207], v[24:27]
    ds_read_b64_tr_b16 v[146:147], v223 offset:47104
    v_mfma_f32_16x16x32_bf16 v[20:23], v[120:123], a[204:207], v[20:23]
    ds_read_b64_tr_b16 v[148:149], v222 offset:45056
    buffer_load_dwordx4 a[244:247], v252, s[40:43], s11 offen offset:1024 sc1
    v_mfma_f32_16x16x32_bf16 v[16:19], v[124:127], a[204:207], v[16:19]
    s_waitcnt vmcnt(8)
    ds_read_b64_tr_b16 v[150:151], v222 offset:47104
    v_mfma_f32_16x16x32_bf16 v[12:15], v[128:131], a[208:211], v[12:15]
    s_waitcnt lgkmcnt(4)
    ds_read_b64_tr_b16 v[152:153], v221 offset:45056
    ds_read_b64_tr_b16 v[154:155], v221 offset:47104
    v_mfma_f32_16x16x32_bf16 v[28:31], v[128:131], a[212:215], v[28:31]
    ds_read_b64_tr_b16 v[156:157], v220 offset:45056
    ds_read_b64_tr_b16 v[158:159], v220 offset:47104
    buffer_load_dwordx4 a[248:251], v252, s[40:43], s11 offen offset:2048 sc1
    v_mfma_f32_16x16x32_bf16 v[8:11], v[132:135], a[208:211], v[8:11]
    ds_read_b64_tr_b16 v[96:97], v223 offset:49152
    v_mfma_f32_16x16x32_bf16 v[24:27], v[132:135], a[212:215], v[24:27]
    ds_read_b64_tr_b16 v[98:99], v223 offset:51200
    v_mfma_f32_16x16x32_bf16 v[20:23], v[136:139], a[212:215], v[20:23]
    s_waitcnt lgkmcnt(6)
    ds_read_b64_tr_b16 v[100:101], v222 offset:49152
    buffer_load_dwordx4 a[252:255], v252, s[40:43], s11 offen offset:3072 sc1
    v_mfma_f32_16x16x32_bf16 v[16:19], v[140:143], a[212:215], v[16:19]
    s_waitcnt vmcnt(8)
    ds_read_b64_tr_b16 v[102:103], v222 offset:51200
    v_mfma_f32_16x16x32_bf16 v[12:15], v[144:147], a[216:219], v[12:15]
    ds_read_b64_tr_b16 v[104:105], v221 offset:49152
    ds_read_b64_tr_b16 v[106:107], v221 offset:51200
    v_mfma_f32_16x16x32_bf16 v[28:31], v[144:147], a[220:223], v[28:31]
    ds_read_b64_tr_b16 v[108:109], v220 offset:49152
    ds_read_b64_tr_b16 v[110:111], v220 offset:51200
    v_mfma_f32_16x16x32_bf16 v[8:11], v[148:151], a[216:219], v[8:11]
    s_waitcnt lgkmcnt(6)
    ds_read_b64_tr_b16 v[112:113], v223 offset:53248
    v_mfma_f32_16x16x32_bf16 v[24:27], v[148:151], a[220:223], v[24:27]
    ds_read_b64_tr_b16 v[114:115], v223 offset:55296
    v_mfma_f32_16x16x32_bf16 v[20:23], v[152:155], a[220:223], v[20:23]
    ds_read_b64_tr_b16 v[116:117], v222 offset:53248
    v_mfma_f32_16x16x32_bf16 v[16:19], v[156:159], a[220:223], v[16:19]
    s_waitcnt vmcnt(6)
    ds_read_b64_tr_b16 v[118:119], v222 offset:55296
    v_mfma_f32_16x16x32_bf16 v[12:15], v[96:99], a[224:227], v[12:15]
    s_waitcnt lgkmcnt(4)
    ds_read_b64_tr_b16 v[120:121], v221 offset:53248
    ds_read_b64_tr_b16 v[122:123], v221 offset:55296
    v_mfma_f32_16x16x32_bf16 v[28:31], v[96:99], a[228:231], v[28:31]
    ds_read_b64_tr_b16 v[124:125], v220 offset:53248
    ds_read_b64_tr_b16 v[126:127], v220 offset:55296
    v_mfma_f32_16x16x32_bf16 v[8:11], v[100:103], a[224:227], v[8:11]
    ds_read_b64_tr_b16 v[128:129], v223 offset:57344
    v_mfma_f32_16x16x32_bf16 v[24:27], v[100:103], a[228:231], v[24:27]
    ds_read_b64_tr_b16 v[130:131], v223 offset:59392
    v_mfma_f32_16x16x32_bf16 v[20:23], v[104:107], a[228:231], v[20:23]
    s_waitcnt lgkmcnt(6)
    ds_read_b64_tr_b16 v[132:133], v222 offset:57344
    v_mfma_f32_16x16x32_bf16 v[16:19], v[108:111], a[228:231], v[16:19]
    s_waitcnt vmcnt(4)
    ds_read_b64_tr_b16 v[134:135], v222 offset:59392
    v_mfma_f32_16x16x32_bf16 v[12:15], v[112:115], a[232:235], v[12:15]
    ds_read_b64_tr_b16 v[136:137], v221 offset:57344
    ds_read_b64_tr_b16 v[138:139], v221 offset:59392
    v_mfma_f32_16x16x32_bf16 v[28:31], v[112:115], a[236:239], v[28:31]
    ds_read_b64_tr_b16 v[140:141], v220 offset:57344
    ds_read_b64_tr_b16 v[142:143], v220 offset:59392
    v_mfma_f32_16x16x32_bf16 v[8:11], v[116:119], a[232:235], v[8:11]
    s_waitcnt lgkmcnt(6)
    ds_read_b64_tr_b16 v[144:145], v223 offset:61440
    v_mfma_f32_16x16x32_bf16 v[24:27], v[116:119], a[236:239], v[24:27]
    ds_read_b64_tr_b16 v[146:147], v223 offset:63488
    v_mfma_f32_16x16x32_bf16 v[20:23], v[120:123], a[236:239], v[20:23]
    ds_read_b64_tr_b16 v[148:149], v222 offset:61440
    v_mfma_f32_16x16x32_bf16 v[16:19], v[124:127], a[236:239], v[16:19]
    s_waitcnt vmcnt(2)
    ds_read_b64_tr_b16 v[150:151], v222 offset:63488
    v_mfma_f32_16x16x32_bf16 v[12:15], v[128:131], a[240:243], v[12:15]
    s_waitcnt lgkmcnt(4)
    ds_read_b64_tr_b16 v[152:153], v221 offset:61440
    ds_read_b64_tr_b16 v[154:155], v221 offset:63488
    v_mfma_f32_16x16x32_bf16 v[28:31], v[128:131], a[244:247], v[28:31]
    ds_read_b64_tr_b16 v[156:157], v220 offset:61440
    ds_read_b64_tr_b16 v[158:159], v220 offset:63488
    v_mfma_f32_16x16x32_bf16 v[8:11], v[132:135], a[240:243], v[8:11]
    ds_read_b64_tr_b16 v[96:97], v216 offset:16384
    ds_read_b64_tr_b16 v[98:99], v216 offset:18432
    v_mfma_f32_16x16x32_bf16 v[24:27], v[132:135], a[244:247], v[24:27]
    ds_read_b64_tr_b16 v[100:101], v217 offset:16384
    ds_read_b64_tr_b16 v[102:103], v217 offset:18432
    v_mfma_f32_16x16x32_bf16 v[20:23], v[136:139], a[244:247], v[20:23]
    s_waitcnt lgkmcnt(8)
    ds_read_b64_tr_b16 v[104:105], v216 offset:20480
    ds_read_b64_tr_b16 v[106:107], v216 offset:22528
    v_mfma_f32_16x16x32_bf16 v[16:19], v[140:143], a[244:247], v[16:19]
    s_waitcnt vmcnt(0)
    ds_read_b64_tr_b16 v[108:109], v217 offset:20480
    ds_read_b64_tr_b16 v[110:111], v217 offset:22528
    v_mfma_f32_16x16x32_bf16 v[12:15], v[144:147], a[248:251], v[12:15]
    v_mfma_f32_16x16x32_bf16 v[28:31], v[144:147], a[252:255], v[28:31]
    v_mfma_f32_16x16x32_bf16 v[8:11], v[148:151], a[248:251], v[8:11]
    s_waitcnt lgkmcnt(4)
    v_mfma_f32_16x16x32_bf16 v[24:27], v[148:151], a[252:255], v[24:27]
    ds_read_b64_tr_b16 v[112:113], v216 offset:24576
    ds_read_b64_tr_b16 v[114:115], v216 offset:26624
    v_mfma_f32_16x16x32_bf16 v[20:23], v[152:155], a[252:255], v[20:23]
    s_waitcnt lgkmcnt(2)
    ds_read_b64_tr_b16 v[116:117], v217 offset:24576
    ds_read_b64_tr_b16 v[118:119], v217 offset:26624
    v_cvt_pk_bf16_f32 v38, v12, v13
    v_cvt_pk_bf16_f32 v39, v14, v15
    v_mfma_f32_16x16x32_bf16 v[16:19], v[156:159], a[252:255], v[16:19]
    ds_read_b64_tr_b16 v[120:121], v216 offset:28672
    ds_read_b64_tr_b16 v[122:123], v216 offset:30720
    v_cvt_pk_bf16_f32 v46, v28, v29
    v_cvt_pk_bf16_f32 v47, v30, v31
    v_mfma_f32_16x16x32_bf16 v[0:3], v[96:99], a[32:35], v[0:3]
    ds_read_b64_tr_b16 v[124:125], v217 offset:28672
    ds_read_b64_tr_b16 v[126:127], v217 offset:30720
    v_cvt_pk_bf16_f32 v36, v8, v9
    v_cvt_pk_bf16_f32 v37, v10, v11
    v_mfma_f32_16x16x32_bf16 v[4:7], v[100:103], a[32:35], v[4:7]
    ds_read_b64_tr_b16 v[128:129], v216 offset:32768
    ds_read_b64_tr_b16 v[130:131], v216 offset:34816
    buffer_store_dwordx4 v[36:39], v251, s[40:43], s57 offen offset:1024 sc1
    v_cvt_pk_bf16_f32 v44, v24, v25
    v_cvt_pk_bf16_f32 v45, v26, v27
    v_mfma_f32_16x16x32_bf16 v[0:3], v[104:107], a[40:43], v[0:3]
    s_waitcnt lgkmcnt(8)
    ds_read_b64_tr_b16 v[132:133], v217 offset:32768
    ds_read_b64_tr_b16 v[134:135], v217 offset:34816
    buffer_store_dwordx4 v[44:47], v251, s[40:43], s59 offen offset:3072 sc1
    v_cvt_pk_bf16_f32 v42, v20, v21
    v_cvt_pk_bf16_f32 v43, v22, v23
    v_mfma_f32_16x16x32_bf16 v[4:7], v[108:111], a[40:43], v[4:7]
    ds_read_b64_tr_b16 v[136:137], v216 offset:36864
    ds_read_b64_tr_b16 v[138:139], v216 offset:38912
    v_cvt_pk_bf16_f32 v40, v16, v17
    v_cvt_pk_bf16_f32 v41, v18, v19
    v_mfma_f32_16x16x32_bf16 v[0:3], v[112:115], a[48:51], v[0:3]
    s_waitcnt lgkmcnt(8)
    ds_read_b64_tr_b16 v[140:141], v217 offset:36864
    ds_read_b64_tr_b16 v[142:143], v217 offset:38912
    buffer_store_dwordx4 v[40:43], v251, s[40:43], s58 offen offset:2048 sc1
    v_mfma_f32_16x16x32_bf16 v[4:7], v[116:119], a[48:51], v[4:7]
    ds_read_b64_tr_b16 v[144:145], v216 offset:40960
    ds_read_b64_tr_b16 v[146:147], v216 offset:43008
    v_mfma_f32_16x16x32_bf16 v[0:3], v[120:123], a[56:59], v[0:3]
    s_waitcnt lgkmcnt(8)
    ds_read_b64_tr_b16 v[148:149], v217 offset:40960
    ds_read_b64_tr_b16 v[150:151], v217 offset:43008
    v_mfma_f32_16x16x32_bf16 v[4:7], v[124:127], a[56:59], v[4:7]
    ds_read_b64_tr_b16 v[152:153], v216 offset:45056
    ds_read_b64_tr_b16 v[154:155], v216 offset:47104
    v_mfma_f32_16x16x32_bf16 v[0:3], v[128:131], a[64:67], v[0:3]
    s_waitcnt lgkmcnt(8)
    ds_read_b64_tr_b16 v[156:157], v217 offset:45056
    ds_read_b64_tr_b16 v[158:159], v217 offset:47104
    v_mfma_f32_16x16x32_bf16 v[4:7], v[132:135], a[64:67], v[4:7]
    ds_read_b64_tr_b16 v[96:97], v216 offset:49152
    ds_read_b64_tr_b16 v[98:99], v216 offset:51200
    v_mfma_f32_16x16x32_bf16 v[0:3], v[136:139], a[72:75], v[0:3]
    s_waitcnt lgkmcnt(8)
    ds_read_b64_tr_b16 v[100:101], v217 offset:49152
    ds_read_b64_tr_b16 v[102:103], v217 offset:51200
    v_mfma_f32_16x16x32_bf16 v[4:7], v[140:143], a[72:75], v[4:7]
    ds_read_b64_tr_b16 v[104:105], v216 offset:53248
    ds_read_b64_tr_b16 v[106:107], v216 offset:55296
    v_mfma_f32_16x16x32_bf16 v[0:3], v[144:147], a[80:83], v[0:3]
    s_waitcnt lgkmcnt(8)
    ds_read_b64_tr_b16 v[108:109], v217 offset:53248
    ds_read_b64_tr_b16 v[110:111], v217 offset:55296
    v_mfma_f32_16x16x32_bf16 v[4:7], v[148:151], a[80:83], v[4:7]
    ds_read_b64_tr_b16 v[112:113], v216 offset:57344
    ds_read_b64_tr_b16 v[114:115], v216 offset:59392
    v_mfma_f32_16x16x32_bf16 v[0:3], v[152:155], a[88:91], v[0:3]
    s_waitcnt lgkmcnt(8)
    ds_read_b64_tr_b16 v[116:117], v217 offset:57344
    ds_read_b64_tr_b16 v[118:119], v217 offset:59392
    v_mfma_f32_16x16x32_bf16 v[4:7], v[156:159], a[88:91], v[4:7]
    ds_read_b64_tr_b16 v[120:121], v216 offset:61440
    ds_read_b64_tr_b16 v[122:123], v216 offset:63488
    v_mfma_f32_16x16x32_bf16 v[0:3], v[96:99], a[96:99], v[0:3]
    s_waitcnt lgkmcnt(8)
    ds_read_b64_tr_b16 v[124:125], v217 offset:61440
    ds_read_b64_tr_b16 v[126:127], v217 offset:63488
    v_mfma_f32_16x16x32_bf16 v[4:7], v[100:103], a[96:99], v[4:7]
    ds_read_b64_tr_b16 v[128:129], v220 offset:0
    ds_read_b64_tr_b16 v[130:131], v220 offset:2048
    v_mfma_f32_16x16x32_bf16 v[0:3], v[104:107], a[104:107], v[0:3]
    s_waitcnt lgkmcnt(8)
    ds_read_b64_tr_b16 v[132:133], v221 offset:0
    ds_read_b64_tr_b16 v[134:135], v221 offset:2048
    v_mfma_f32_16x16x32_bf16 v[4:7], v[108:111], a[104:107], v[4:7]
    ds_read_b64_tr_b16 v[136:137], v220 offset:4096
    ds_read_b64_tr_b16 v[138:139], v220 offset:6144
    v_mfma_f32_16x16x32_bf16 v[0:3], v[112:115], a[112:115], v[0:3]
    s_waitcnt lgkmcnt(8)
    ds_read_b64_tr_b16 v[140:141], v221 offset:4096
    ds_read_b64_tr_b16 v[142:143], v221 offset:6144
    v_mfma_f32_16x16x32_bf16 v[4:7], v[116:119], a[112:115], v[4:7]
    ds_read_b64_tr_b16 v[144:145], v220 offset:8192
    ds_read_b64_tr_b16 v[146:147], v220 offset:10240
    v_mfma_f32_16x16x32_bf16 v[0:3], v[120:123], a[120:123], v[0:3]
    s_waitcnt lgkmcnt(8)
    ds_read_b64_tr_b16 v[148:149], v221 offset:8192
    ds_read_b64_tr_b16 v[150:151], v221 offset:10240
    v_mfma_f32_16x16x32_bf16 v[4:7], v[124:127], a[120:123], v[4:7]
    ds_read_b64_tr_b16 v[152:153], v220 offset:12288
    ds_read_b64_tr_b16 v[154:155], v220 offset:14336
    v_mfma_f32_16x16x32_bf16 v[0:3], v[128:131], a[128:131], v[0:3]
    s_waitcnt lgkmcnt(8)
    ds_read_b64_tr_b16 v[156:157], v221 offset:12288
    ds_read_b64_tr_b16 v[158:159], v221 offset:14336
    v_mfma_f32_16x16x32_bf16 v[4:7], v[132:135], a[128:131], v[4:7]
    ds_read_b64_tr_b16 v[96:97], v220 offset:16384
    ds_read_b64_tr_b16 v[98:99], v220 offset:18432
    v_mfma_f32_16x16x32_bf16 v[0:3], v[136:139], a[136:139], v[0:3]
    s_waitcnt lgkmcnt(8)
    ds_read_b64_tr_b16 v[100:101], v221 offset:16384
    ds_read_b64_tr_b16 v[102:103], v221 offset:18432
    v_mfma_f32_16x16x32_bf16 v[4:7], v[140:143], a[136:139], v[4:7]
    ds_read_b64_tr_b16 v[104:105], v220 offset:20480
    ds_read_b64_tr_b16 v[106:107], v220 offset:22528
    v_mfma_f32_16x16x32_bf16 v[0:3], v[144:147], a[144:147], v[0:3]
    s_waitcnt lgkmcnt(8)
    ds_read_b64_tr_b16 v[108:109], v221 offset:20480
    ds_read_b64_tr_b16 v[110:111], v221 offset:22528
    v_mfma_f32_16x16x32_bf16 v[4:7], v[148:151], a[144:147], v[4:7]
    ds_read_b64_tr_b16 v[112:113], v220 offset:24576
    ds_read_b64_tr_b16 v[114:115], v220 offset:26624
    v_mfma_f32_16x16x32_bf16 v[0:3], v[152:155], a[152:155], v[0:3]
    s_waitcnt lgkmcnt(8)
    ds_read_b64_tr_b16 v[116:117], v221 offset:24576
    ds_read_b64_tr_b16 v[118:119], v221 offset:26624
    v_mfma_f32_16x16x32_bf16 v[4:7], v[156:159], a[152:155], v[4:7]
    ds_read_b64_tr_b16 v[120:121], v220 offset:28672
    ds_read_b64_tr_b16 v[122:123], v220 offset:30720
    v_mfma_f32_16x16x32_bf16 v[0:3], v[96:99], a[160:163], v[0:3]
    s_waitcnt lgkmcnt(8)
    ds_read_b64_tr_b16 v[124:125], v221 offset:28672
    ds_read_b64_tr_b16 v[126:127], v221 offset:30720
    v_mfma_f32_16x16x32_bf16 v[4:7], v[100:103], a[160:163], v[4:7]
    ds_read_b64_tr_b16 v[128:129], v220 offset:32768
    ds_read_b64_tr_b16 v[130:131], v220 offset:34816
    v_mfma_f32_16x16x32_bf16 v[0:3], v[104:107], a[168:171], v[0:3]
    s_waitcnt lgkmcnt(8)
    s_waitcnt vmcnt(0)
    s_barrier
    buffer_store_dwordx4 v[208:211], v248, s[40:43], 0 offen offset:0 sc1
    ds_read_b64_tr_b16 v[132:133], v221 offset:32768
    ds_read_b64_tr_b16 v[134:135], v221 offset:34816
    v_mfma_f32_16x16x32_bf16 v[4:7], v[108:111], a[168:171], v[4:7]
    ds_read_b64_tr_b16 v[136:137], v220 offset:36864
    ds_read_b64_tr_b16 v[138:139], v220 offset:38912
    v_mfma_f32_16x16x32_bf16 v[0:3], v[112:115], a[176:179], v[0:3]
    s_waitcnt lgkmcnt(8)
    ds_read_b64_tr_b16 v[140:141], v221 offset:36864
    ds_read_b64_tr_b16 v[142:143], v221 offset:38912
    v_mfma_f32_16x16x32_bf16 v[4:7], v[116:119], a[176:179], v[4:7]
    ds_read_b64_tr_b16 v[144:145], v220 offset:40960
    ds_read_b64_tr_b16 v[146:147], v220 offset:43008
    v_mfma_f32_16x16x32_bf16 v[0:3], v[120:123], a[184:187], v[0:3]
    s_waitcnt lgkmcnt(8)
    ds_read_b64_tr_b16 v[148:149], v221 offset:40960
    ds_read_b64_tr_b16 v[150:151], v221 offset:43008
    v_mfma_f32_16x16x32_bf16 v[4:7], v[124:127], a[184:187], v[4:7]
    ds_read_b64_tr_b16 v[152:153], v220 offset:45056
    ds_read_b64_tr_b16 v[154:155], v220 offset:47104
    v_mfma_f32_16x16x32_bf16 v[0:3], v[128:131], a[192:195], v[0:3]
    s_waitcnt lgkmcnt(8)
    ds_read_b64_tr_b16 v[156:157], v221 offset:45056
    ds_read_b64_tr_b16 v[158:159], v221 offset:47104
    v_mfma_f32_16x16x32_bf16 v[4:7], v[132:135], a[192:195], v[4:7]
    ds_read_b64_tr_b16 v[96:97], v220 offset:49152
    ds_read_b64_tr_b16 v[98:99], v220 offset:51200
    v_mfma_f32_16x16x32_bf16 v[0:3], v[136:139], a[200:203], v[0:3]
    s_waitcnt lgkmcnt(8)
    ds_read_b64_tr_b16 v[100:101], v221 offset:49152
    ds_read_b64_tr_b16 v[102:103], v221 offset:51200
    v_mfma_f32_16x16x32_bf16 v[4:7], v[140:143], a[200:203], v[4:7]
    ds_read_b64_tr_b16 v[104:105], v220 offset:53248
    ds_read_b64_tr_b16 v[106:107], v220 offset:55296
    v_mfma_f32_16x16x32_bf16 v[0:3], v[144:147], a[208:211], v[0:3]
    s_waitcnt lgkmcnt(8)
    ds_read_b64_tr_b16 v[108:109], v221 offset:53248
    ds_read_b64_tr_b16 v[110:111], v221 offset:55296
    v_mfma_f32_16x16x32_bf16 v[4:7], v[148:151], a[208:211], v[4:7]
    ds_read_b64_tr_b16 v[112:113], v220 offset:57344
    ds_read_b64_tr_b16 v[114:115], v220 offset:59392
    v_mfma_f32_16x16x32_bf16 v[0:3], v[152:155], a[216:219], v[0:3]
    s_waitcnt lgkmcnt(8)
    ds_read_b64_tr_b16 v[116:117], v221 offset:57344
    ds_read_b64_tr_b16 v[118:119], v221 offset:59392
    v_mfma_f32_16x16x32_bf16 v[4:7], v[156:159], a[216:219], v[4:7]
    ds_read_b64_tr_b16 v[120:121], v220 offset:61440
    ds_read_b64_tr_b16 v[122:123], v220 offset:63488
    v_mfma_f32_16x16x32_bf16 v[0:3], v[96:99], a[224:227], v[0:3]
    s_waitcnt lgkmcnt(8)
    ds_read_b64_tr_b16 v[124:125], v221 offset:61440
    ds_read_b64_tr_b16 v[126:127], v221 offset:63488
    v_mfma_f32_16x16x32_bf16 v[4:7], v[100:103], a[224:227], v[4:7]
    v_mfma_f32_16x16x32_bf16 v[0:3], v[104:107], a[232:235], v[0:3]
    s_waitcnt lgkmcnt(6)
    v_mfma_f32_16x16x32_bf16 v[4:7], v[108:111], a[232:235], v[4:7]
    v_mfma_f32_16x16x32_bf16 v[0:3], v[112:115], a[240:243], v[0:3]
    s_waitcnt lgkmcnt(2)
    v_mfma_f32_16x16x32_bf16 v[4:7], v[116:119], a[240:243], v[4:7]
    v_mfma_f32_16x16x32_bf16 v[0:3], v[120:123], a[248:251], v[0:3]
    s_waitcnt lgkmcnt(0)
    v_mfma_f32_16x16x32_bf16 v[4:7], v[124:127], a[248:251], v[4:7]

    s_mov_b32 s57, 0xffff0000
    s_cmp_lg_u32 s48, 1
    s_cbranch_scc1 L_poll2_x
L_poll2:
    buffer_load_dword v200, v250, s[40:43], 0 offen offset:0 sc1
    s_add_u32 s65, s65, 1
    s_cmp_ge_u32 s65, 1048576
    s_cbranch_scc1 L_poll2_x
    s_waitcnt vmcnt(0)
    v_cmp_ne_u32 vcc, 1, v200
    s_cbranch_vccnz L_poll2
L_poll2_x:
    s_barrier
    buffer_load_dwordx4 v[160:163], v251, s[40:43], s56 offen offset:1024 sc1
    buffer_load_dwordx4 v[164:167], v251, s[40:43], s56 offen offset:2048 sc1
    buffer_load_dwordx4 v[168:171], v251, s[40:43], s56 offen offset:3072 sc1
    s_waitcnt vmcnt(2)
    v_lshlrev_b32 v176, 16, v160
    v_and_b32 v177, s57, v160
    v_lshlrev_b32 v178, 16, v161
    v_and_b32 v179, s57, v161
    v_lshlrev_b32 v180, 16, v162
    v_and_b32 v181, s57, v162
    v_lshlrev_b32 v182, 16, v163
    v_and_b32 v183, s57, v163
    v_add_f32 v0, v0, v176
    v_add_f32 v1, v1, v177
    v_add_f32 v2, v2, v178
    v_add_f32 v3, v3, v179
    v_add_f32 v4, v4, v180
    v_add_f32 v5, v5, v181
    v_add_f32 v6, v6, v182
    v_add_f32 v7, v7, v183
    s_waitcnt vmcnt(1)
    v_lshlrev_b32 v176, 16, v164
    v_and_b32 v177, s57, v164
    v_lshlrev_b32 v178, 16, v165
    v_and_b32 v179, s57, v165
    v_lshlrev_b32 v180, 16, v166
    v_and_b32 v181, s57, v166
    v_lshlrev_b32 v182, 16, v167
    v_and_b32 v183, s57, v167
    v_add_f32 v0, v0, v176
    v_add_f32 v1, v1, v177
    v_add_f32 v2, v2, v178
    v_add_f32 v3, v3, v179
    v_add_f32 v4, v4, v180
    v_add_f32 v5, v5, v181
    v_add_f32 v6, v6, v182
    v_add_f32 v7, v7, v183
    s_waitcnt vmcnt(0)
    v_lshlrev_b32 v176, 16, v168
    v_and_b32 v177, s57, v168
    v_lshlrev_b32 v178, 16, v169
    v_and_b32 v179, s57, v169
    v_lshlrev_b32 v180, 16, v170
    v_and_b32 v181, s57, v170
    v_lshlrev_b32 v182, 16, v171
    v_and_b32 v183, s57, v171
    v_add_f32 v0, v0, v176
    v_add_f32 v1, v1, v177
    v_add_f32 v2, v2, v178
    v_add_f32 v3, v3, v179
    v_add_f32 v4, v4, v180
    v_add_f32 v5, v5, v181
    v_add_f32 v6, v6, v182
    v_add_f32 v7, v7, v183
    v_cvt_pk_bf16_f32 v8, v0, v1
    v_cvt_pk_bf16_f32 v9, v2, v3
    v_cvt_pk_bf16_f32 v10, v4, v5
    v_cvt_pk_bf16_f32 v11, v6, v7
    buffer_store_dwordx2 v[8:9], v254, s[44:47], 0 offen offset:0
    buffer_store_dwordx2 v[10:11], v254, s[44:47], 0 offen offset:32
    s_endpgm
L_cold:

L_rare1:
    v_max3_f32 v200, v200, v91, 0
    v_max3_f32 v201, v201, v95, 0
    v_mov_b32 v202, v200
    v_mov_b32 v203, v201
    s_nop 0
    v_permlane16_swap_b32 v200, v202
    v_permlane16_swap_b32 v201, v203
    v_max_f32 v200, v200, v202
    v_max_f32 v201, v201, v203
    v_mov_b32 v202, v200
    v_mov_b32 v203, v201
    s_nop 0
    v_permlane32_swap_b32 v200, v202
    v_permlane32_swap_b32 v201, v203
    v_max_f32 v200, v200, v202
    v_max_f32 v201, v201, v203
    v_exp_f32 v204, -v200
    v_exp_f32 v205, -v201
    v_sub_f32 v64, v64, v200
    v_sub_f32 v65, v65, v200
    v_sub_f32 v66, v66, v200
    v_sub_f32 v67, v67, v200
    v_sub_f32 v68, v68, v201
    v_sub_f32 v69, v69, v201
    v_sub_f32 v70, v70, v201
    v_sub_f32 v71, v71, v201
    v_sub_f32 v72, v72, v200
    v_sub_f32 v73, v73, v200
    v_sub_f32 v74, v74, v200
    v_sub_f32 v75, v75, v200
    v_sub_f32 v76, v76, v201
    v_sub_f32 v77, v77, v201
    v_sub_f32 v78, v78, v201
    v_sub_f32 v79, v79, v201
    v_sub_f32 v80, v80, v200
    v_sub_f32 v81, v81, v200
    v_sub_f32 v82, v82, v200
    v_sub_f32 v83, v83, v200
    v_sub_f32 v84, v84, v201
    v_sub_f32 v85, v85, v201
    v_sub_f32 v86, v86, v201
    v_sub_f32 v87, v87, v201
    v_sub_f32 v88, v88, v200
    v_sub_f32 v89, v89, v200
    v_sub_f32 v90, v90, v200
    v_sub_f32 v91, v91, v200
    v_sub_f32 v92, v92, v201
    v_sub_f32 v93, v93, v201
    v_sub_f32 v94, v94, v201
    v_sub_f32 v95, v95, v201
    v_sub_f32 v208, v208, v200
    v_sub_f32 v209, v209, v200
    v_sub_f32 v210, v210, v200
    v_sub_f32 v211, v211, v200
    v_sub_f32 v212, v212, v201
    v_sub_f32 v213, v213, v201
    v_sub_f32 v214, v214, v201
    v_sub_f32 v215, v215, v201
    v_sub_f32 v0, v0, v200
    v_sub_f32 v1, v1, v200
    v_sub_f32 v2, v2, v200
    v_sub_f32 v3, v3, v200
    v_sub_f32 v4, v4, v201
    v_sub_f32 v5, v5, v201
    v_sub_f32 v6, v6, v201
    v_sub_f32 v7, v7, v201
    v_accvgpr_write_b32 a226, v204
    v_accvgpr_write_b32 a227, v205
    s_bitset1_b32 s13, 1
    s_nop 1
    s_branch L_back1

L_rare2:
    v_max3_f32 v200, v200, v27, 0
    v_max3_f32 v201, v201, v31, 0
    v_mov_b32 v202, v200
    v_mov_b32 v203, v201
    s_nop 0
    v_permlane16_swap_b32 v200, v202
    v_permlane16_swap_b32 v201, v203
    v_max_f32 v200, v200, v202
    v_max_f32 v201, v201, v203
    v_mov_b32 v202, v200
    v_mov_b32 v203, v201
    s_nop 0
    v_permlane32_swap_b32 v200, v202
    v_permlane32_swap_b32 v201, v203
    v_max_f32 v200, v200, v202
    v_max_f32 v201, v201, v203
    v_exp_f32 v204, -v200
    v_exp_f32 v205, -v201
    v_sub_f32 v0, v0, v200
    v_sub_f32 v1, v1, v200
    v_sub_f32 v2, v2, v200
    v_sub_f32 v3, v3, v200
    v_sub_f32 v4, v4, v201
    v_sub_f32 v5, v5, v201
    v_sub_f32 v6, v6, v201
    v_sub_f32 v7, v7, v201
    v_sub_f32 v8, v8, v200
    v_sub_f32 v9, v9, v200
    v_sub_f32 v10, v10, v200
    v_sub_f32 v11, v11, v200
    v_sub_f32 v12, v12, v201
    v_sub_f32 v13, v13, v201
    v_sub_f32 v14, v14, v201
    v_sub_f32 v15, v15, v201
    v_sub_f32 v16, v16, v200
    v_sub_f32 v17, v17, v200
    v_sub_f32 v18, v18, v200
    v_sub_f32 v19, v19, v200
    v_sub_f32 v20, v20, v201
    v_sub_f32 v21, v21, v201
    v_sub_f32 v22, v22, v201
    v_sub_f32 v23, v23, v201
    v_sub_f32 v24, v24, v200
    v_sub_f32 v25, v25, v200
    v_sub_f32 v26, v26, v200
    v_sub_f32 v27, v27, v200
    v_sub_f32 v28, v28, v201
    v_sub_f32 v29, v29, v201
    v_sub_f32 v30, v30, v201
    v_sub_f32 v31, v31, v201
    v_sub_f32 v208, v208, v200
    v_sub_f32 v209, v209, v200
    v_sub_f32 v210, v210, v200
    v_sub_f32 v211, v211, v200
    v_sub_f32 v212, v212, v201
    v_sub_f32 v213, v213, v201
    v_sub_f32 v214, v214, v201
    v_sub_f32 v215, v215, v201
    v_sub_f32 v64, v64, v200
    v_sub_f32 v65, v65, v200
    v_sub_f32 v66, v66, v200
    v_sub_f32 v67, v67, v200
    v_sub_f32 v68, v68, v201
    v_sub_f32 v69, v69, v201
    v_sub_f32 v70, v70, v201
    v_sub_f32 v71, v71, v201
    v_accvgpr_write_b32 a228, v204
    v_accvgpr_write_b32 a229, v205
    s_bitset1_b32 s13, 2
    s_nop 1
    s_branch L_back2

L_rare3:
    v_max3_f32 v200, v200, v91, 0
    v_max3_f32 v201, v201, v95, 0
    v_mov_b32 v202, v200
    v_mov_b32 v203, v201
    s_nop 0
    v_permlane16_swap_b32 v200, v202
    v_permlane16_swap_b32 v201, v203
    v_max_f32 v200, v200, v202
    v_max_f32 v201, v201, v203
    v_mov_b32 v202, v200
    v_mov_b32 v203, v201
    s_nop 0
    v_permlane32_swap_b32 v200, v202
    v_permlane32_swap_b32 v201, v203
    v_max_f32 v200, v200, v202
    v_max_f32 v201, v201, v203
    v_exp_f32 v204, -v200
    v_exp_f32 v205, -v201
    v_sub_f32 v64, v64, v200
    v_sub_f32 v65, v65, v200
    v_sub_f32 v66, v66, v200
    v_sub_f32 v67, v67, v200
    v_sub_f32 v68, v68, v201
    v_sub_f32 v69, v69, v201
    v_sub_f32 v70, v70, v201
    v_sub_f32 v71, v71, v201
    v_sub_f32 v72, v72, v200
    v_sub_f32 v73, v73, v200
    v_sub_f32 v74, v74, v200
    v_sub_f32 v75, v75, v200
    v_sub_f32 v76, v76, v201
    v_sub_f32 v77, v77, v201
    v_sub_f32 v78, v78, v201
    v_sub_f32 v79, v79, v201
    v_sub_f32 v80, v80, v200
    v_sub_f32 v81, v81, v200
    v_sub_f32 v82, v82, v200
    v_sub_f32 v83, v83, v200
    v_sub_f32 v84, v84, v201
    v_sub_f32 v85, v85, v201
    v_sub_f32 v86, v86, v201
    v_sub_f32 v87, v87, v201
    v_sub_f32 v88, v88, v200
    v_sub_f32 v89, v89, v200
    v_sub_f32 v90, v90, v200
    v_sub_f32 v91, v91, v200
    v_sub_f32 v92, v92, v201
    v_sub_f32 v93, v93, v201
    v_sub_f32 v94, v94, v201
    v_sub_f32 v95, v95, v201
    v_sub_f32 v208, v208, v200
    v_sub_f32 v209, v209, v200
    v_sub_f32 v210, v210, v200
    v_sub_f32 v211, v211, v200
    v_sub_f32 v212, v212, v201
    v_sub_f32 v213, v213, v201
    v_sub_f32 v214, v214, v201
    v_sub_f32 v215, v215, v201
    v_sub_f32 v0, v0, v200
    v_sub_f32 v1, v1, v200
    v_sub_f32 v2, v2, v200
    v_sub_f32 v3, v3, v200
    v_sub_f32 v4, v4, v201
    v_sub_f32 v5, v5, v201
    v_sub_f32 v6, v6, v201
    v_sub_f32 v7, v7, v201
    v_accvgpr_write_b32 a230, v204
    v_accvgpr_write_b32 a231, v205
    s_bitset1_b32 s13, 3
    s_nop 1
    s_branch L_back3

L_rare4:
    v_max3_f32 v200, v200, v27, 0
    v_max3_f32 v201, v201, v31, 0
    v_mov_b32 v202, v200
    v_mov_b32 v203, v201
    s_nop 0
    v_permlane16_swap_b32 v200, v202
    v_permlane16_swap_b32 v201, v203
    v_max_f32 v200, v200, v202
    v_max_f32 v201, v201, v203
    v_mov_b32 v202, v200
    v_mov_b32 v203, v201
    s_nop 0
    v_permlane32_swap_b32 v200, v202
    v_permlane32_swap_b32 v201, v203
    v_max_f32 v200, v200, v202
    v_max_f32 v201, v201, v203
    v_exp_f32 v204, -v200
    v_exp_f32 v205, -v201
    v_sub_f32 v0, v0, v200
    v_sub_f32 v1, v1, v200
    v_sub_f32 v2, v2, v200
    v_sub_f32 v3, v3, v200
    v_sub_f32 v4, v4, v201
    v_sub_f32 v5, v5, v201
    v_sub_f32 v6, v6, v201
    v_sub_f32 v7, v7, v201
    v_sub_f32 v8, v8, v200
    v_sub_f32 v9, v9, v200
    v_sub_f32 v10, v10, v200
    v_sub_f32 v11, v11, v200
    v_sub_f32 v12, v12, v201
    v_sub_f32 v13, v13, v201
    v_sub_f32 v14, v14, v201
    v_sub_f32 v15, v15, v201
    v_sub_f32 v16, v16, v200
    v_sub_f32 v17, v17, v200
    v_sub_f32 v18, v18, v200
    v_sub_f32 v19, v19, v200
    v_sub_f32 v20, v20, v201
    v_sub_f32 v21, v21, v201
    v_sub_f32 v22, v22, v201
    v_sub_f32 v23, v23, v201
    v_sub_f32 v24, v24, v200
    v_sub_f32 v25, v25, v200
    v_sub_f32 v26, v26, v200
    v_sub_f32 v27, v27, v200
    v_sub_f32 v28, v28, v201
    v_sub_f32 v29, v29, v201
    v_sub_f32 v30, v30, v201
    v_sub_f32 v31, v31, v201
    v_sub_f32 v208, v208, v200
    v_sub_f32 v209, v209, v200
    v_sub_f32 v210, v210, v200
    v_sub_f32 v211, v211, v200
    v_sub_f32 v212, v212, v201
    v_sub_f32 v213, v213, v201
    v_sub_f32 v214, v214, v201
    v_sub_f32 v215, v215, v201
    v_sub_f32 v64, v64, v200
    v_sub_f32 v65, v65, v200
    v_sub_f32 v66, v66, v200
    v_sub_f32 v67, v67, v200
    v_sub_f32 v68, v68, v201
    v_sub_f32 v69, v69, v201
    v_sub_f32 v70, v70, v201
    v_sub_f32 v71, v71, v201
    v_accvgpr_write_b32 a232, v204
    v_accvgpr_write_b32 a233, v205
    s_bitset1_b32 s13, 4
    s_nop 1
    s_branch L_back4

L_rare5:
    v_max3_f32 v200, v200, v91, 0
    v_max3_f32 v201, v201, v95, 0
    v_mov_b32 v202, v200
    v_mov_b32 v203, v201
    s_nop 0
    v_permlane16_swap_b32 v200, v202
    v_permlane16_swap_b32 v201, v203
    v_max_f32 v200, v200, v202
    v_max_f32 v201, v201, v203
    v_mov_b32 v202, v200
    v_mov_b32 v203, v201
    s_nop 0
    v_permlane32_swap_b32 v200, v202
    v_permlane32_swap_b32 v201, v203
    v_max_f32 v200, v200, v202
    v_max_f32 v201, v201, v203
    v_exp_f32 v204, -v200
    v_exp_f32 v205, -v201
    v_sub_f32 v64, v64, v200
    v_sub_f32 v65, v65, v200
    v_sub_f32 v66, v66, v200
    v_sub_f32 v67, v67, v200
    v_sub_f32 v68, v68, v201
    v_sub_f32 v69, v69, v201
    v_sub_f32 v70, v70, v201
    v_sub_f32 v71, v71, v201
    v_sub_f32 v72, v72, v200
    v_sub_f32 v73, v73, v200
    v_sub_f32 v74, v74, v200
    v_sub_f32 v75, v75, v200
    v_sub_f32 v76, v76, v201
    v_sub_f32 v77, v77, v201
    v_sub_f32 v78, v78, v201
    v_sub_f32 v79, v79, v201
    v_sub_f32 v80, v80, v200
    v_sub_f32 v81, v81, v200
    v_sub_f32 v82, v82, v200
    v_sub_f32 v83, v83, v200
    v_sub_f32 v84, v84, v201
    v_sub_f32 v85, v85, v201
    v_sub_f32 v86, v86, v201
    v_sub_f32 v87, v87, v201
    v_sub_f32 v88, v88, v200
    v_sub_f32 v89, v89, v200
    v_sub_f32 v90, v90, v200
    v_sub_f32 v91, v91, v200
    v_sub_f32 v92, v92, v201
    v_sub_f32 v93, v93, v201
    v_sub_f32 v94, v94, v201
    v_sub_f32 v95, v95, v201
    v_sub_f32 v208, v208, v200
    v_sub_f32 v209, v209, v200
    v_sub_f32 v210, v210, v200
    v_sub_f32 v211, v211, v200
    v_sub_f32 v212, v212, v201
    v_sub_f32 v213, v213, v201
    v_sub_f32 v214, v214, v201
    v_sub_f32 v215, v215, v201
    v_sub_f32 v0, v0, v200
    v_sub_f32 v1, v1, v200
    v_sub_f32 v2, v2, v200
    v_sub_f32 v3, v3, v200
    v_sub_f32 v4, v4, v201
    v_sub_f32 v5, v5, v201
    v_sub_f32 v6, v6, v201
    v_sub_f32 v7, v7, v201
    v_accvgpr_write_b32 a234, v204
    v_accvgpr_write_b32 a235, v205
    s_bitset1_b32 s13, 5
    s_nop 1
    s_branch L_back5

L_rare6:
    v_max3_f32 v200, v200, v27, 0
    v_max3_f32 v201, v201, v31, 0
    v_mov_b32 v202, v200
    v_mov_b32 v203, v201
    s_nop 0
    v_permlane16_swap_b32 v200, v202
    v_permlane16_swap_b32 v201, v203
    v_max_f32 v200, v200, v202
    v_max_f32 v201, v201, v203
    v_mov_b32 v202, v200
    v_mov_b32 v203, v201
    s_nop 0
    v_permlane32_swap_b32 v200, v202
    v_permlane32_swap_b32 v201, v203
    v_max_f32 v200, v200, v202
    v_max_f32 v201, v201, v203
    v_exp_f32 v204, -v200
    v_exp_f32 v205, -v201
    v_sub_f32 v0, v0, v200
    v_sub_f32 v1, v1, v200
    v_sub_f32 v2, v2, v200
    v_sub_f32 v3, v3, v200
    v_sub_f32 v4, v4, v201
    v_sub_f32 v5, v5, v201
    v_sub_f32 v6, v6, v201
    v_sub_f32 v7, v7, v201
    v_sub_f32 v8, v8, v200
    v_sub_f32 v9, v9, v200
    v_sub_f32 v10, v10, v200
    v_sub_f32 v11, v11, v200
    v_sub_f32 v12, v12, v201
    v_sub_f32 v13, v13, v201
    v_sub_f32 v14, v14, v201
    v_sub_f32 v15, v15, v201
    v_sub_f32 v16, v16, v200
    v_sub_f32 v17, v17, v200
    v_sub_f32 v18, v18, v200
    v_sub_f32 v19, v19, v200
    v_sub_f32 v20, v20, v201
    v_sub_f32 v21, v21, v201
    v_sub_f32 v22, v22, v201
    v_sub_f32 v23, v23, v201
    v_sub_f32 v24, v24, v200
    v_sub_f32 v25, v25, v200
    v_sub_f32 v26, v26, v200
    v_sub_f32 v27, v27, v200
    v_sub_f32 v28, v28, v201
    v_sub_f32 v29, v29, v201
    v_sub_f32 v30, v30, v201
    v_sub_f32 v31, v31, v201
    v_sub_f32 v208, v208, v200
    v_sub_f32 v209, v209, v200
    v_sub_f32 v210, v210, v200
    v_sub_f32 v211, v211, v200
    v_sub_f32 v212, v212, v201
    v_sub_f32 v213, v213, v201
    v_sub_f32 v214, v214, v201
    v_sub_f32 v215, v215, v201
    v_sub_f32 v64, v64, v200
    v_sub_f32 v65, v65, v200
    v_sub_f32 v66, v66, v200
    v_sub_f32 v67, v67, v200
    v_sub_f32 v68, v68, v201
    v_sub_f32 v69, v69, v201
    v_sub_f32 v70, v70, v201
    v_sub_f32 v71, v71, v201
    v_accvgpr_write_b32 a236, v204
    v_accvgpr_write_b32 a237, v205
    s_bitset1_b32 s13, 6
    s_nop 1
    s_branch L_back6

L_rare7:
    v_max3_f32 v200, v200, v91, 0
    v_max3_f32 v201, v201, v95, 0
    v_mov_b32 v202, v200
    v_mov_b32 v203, v201
    s_nop 0
    v_permlane16_swap_b32 v200, v202
    v_permlane16_swap_b32 v201, v203
    v_max_f32 v200, v200, v202
    v_max_f32 v201, v201, v203
    v_mov_b32 v202, v200
    v_mov_b32 v203, v201
    s_nop 0
    v_permlane32_swap_b32 v200, v202
    v_permlane32_swap_b32 v201, v203
    v_max_f32 v200, v200, v202
    v_max_f32 v201, v201, v203
    v_exp_f32 v204, -v200
    v_exp_f32 v205, -v201
    v_sub_f32 v64, v64, v200
    v_sub_f32 v65, v65, v200
    v_sub_f32 v66, v66, v200
    v_sub_f32 v67, v67, v200
    v_sub_f32 v68, v68, v201
    v_sub_f32 v69, v69, v201
    v_sub_f32 v70, v70, v201
    v_sub_f32 v71, v71, v201
    v_sub_f32 v72, v72, v200
    v_sub_f32 v73, v73, v200
    v_sub_f32 v74, v74, v200
    v_sub_f32 v75, v75, v200
    v_sub_f32 v76, v76, v201
    v_sub_f32 v77, v77, v201
    v_sub_f32 v78, v78, v201
    v_sub_f32 v79, v79, v201
    v_sub_f32 v80, v80, v200
    v_sub_f32 v81, v81, v200
    v_sub_f32 v82, v82, v200
    v_sub_f32 v83, v83, v200
    v_sub_f32 v84, v84, v201
    v_sub_f32 v85, v85, v201
    v_sub_f32 v86, v86, v201
    v_sub_f32 v87, v87, v201
    v_sub_f32 v88, v88, v200
    v_sub_f32 v89, v89, v200
    v_sub_f32 v90, v90, v200
    v_sub_f32 v91, v91, v200
    v_sub_f32 v92, v92, v201
    v_sub_f32 v93, v93, v201
    v_sub_f32 v94, v94, v201
    v_sub_f32 v95, v95, v201
    v_sub_f32 v208, v208, v200
    v_sub_f32 v209, v209, v200
    v_sub_f32 v210, v210, v200
    v_sub_f32 v211, v211, v200
    v_sub_f32 v212, v212, v201
    v_sub_f32 v213, v213, v201
    v_sub_f32 v214, v214, v201
    v_sub_f32 v215, v215, v201
    v_sub_f32 v0, v0, v200
    v_sub_f32 v1, v1, v200
    v_sub_f32 v2, v2, v200
    v_sub_f32 v3, v3, v200
    v_sub_f32 v4, v4, v201
    v_sub_f32 v5, v5, v201
    v_sub_f32 v6, v6, v201
    v_sub_f32 v7, v7, v201
    v_accvgpr_write_b32 a238, v204
    v_accvgpr_write_b32 a239, v205
    s_bitset1_b32 s13, 7
    s_nop 1
    s_branch L_back7

L_rare8:
    v_max3_f32 v200, v200, v27, 0
    v_max3_f32 v201, v201, v31, 0
    v_mov_b32 v202, v200
    v_mov_b32 v203, v201
    s_nop 0
    v_permlane16_swap_b32 v200, v202
    v_permlane16_swap_b32 v201, v203
    v_max_f32 v200, v200, v202
    v_max_f32 v201, v201, v203
    v_mov_b32 v202, v200
    v_mov_b32 v203, v201
    s_nop 0
    v_permlane32_swap_b32 v200, v202
    v_permlane32_swap_b32 v201, v203
    v_max_f32 v200, v200, v202
    v_max_f32 v201, v201, v203
    v_exp_f32 v204, -v200
    v_exp_f32 v205, -v201
    v_sub_f32 v0, v0, v200
    v_sub_f32 v1, v1, v200
    v_sub_f32 v2, v2, v200
    v_sub_f32 v3, v3, v200
    v_sub_f32 v4, v4, v201
    v_sub_f32 v5, v5, v201
    v_sub_f32 v6, v6, v201
    v_sub_f32 v7, v7, v201
    v_sub_f32 v8, v8, v200
    v_sub_f32 v9, v9, v200
    v_sub_f32 v10, v10, v200
    v_sub_f32 v11, v11, v200
    v_sub_f32 v12, v12, v201
    v_sub_f32 v13, v13, v201
    v_sub_f32 v14, v14, v201
    v_sub_f32 v15, v15, v201
    v_sub_f32 v16, v16, v200
    v_sub_f32 v17, v17, v200
    v_sub_f32 v18, v18, v200
    v_sub_f32 v19, v19, v200
    v_sub_f32 v20, v20, v201
    v_sub_f32 v21, v21, v201
    v_sub_f32 v22, v22, v201
    v_sub_f32 v23, v23, v201
    v_sub_f32 v24, v24, v200
    v_sub_f32 v25, v25, v200
    v_sub_f32 v26, v26, v200
    v_sub_f32 v27, v27, v200
    v_sub_f32 v28, v28, v201
    v_sub_f32 v29, v29, v201
    v_sub_f32 v30, v30, v201
    v_sub_f32 v31, v31, v201
    v_sub_f32 v208, v208, v200
    v_sub_f32 v209, v209, v200
    v_sub_f32 v210, v210, v200
    v_sub_f32 v211, v211, v200
    v_sub_f32 v212, v212, v201
    v_sub_f32 v213, v213, v201
    v_sub_f32 v214, v214, v201
    v_sub_f32 v215, v215, v201
    v_sub_f32 v64, v64, v200
    v_sub_f32 v65, v65, v200
    v_sub_f32 v66, v66, v200
    v_sub_f32 v67, v67, v200
    v_sub_f32 v68, v68, v201
    v_sub_f32 v69, v69, v201
    v_sub_f32 v70, v70, v201
    v_sub_f32 v71, v71, v201
    v_accvgpr_write_b32 a240, v204
    v_accvgpr_write_b32 a241, v205
    s_bitset1_b32 s13, 8
    s_nop 1
    s_branch L_back8

L_rare9:
    v_max3_f32 v200, v200, v91, 0
    v_max3_f32 v201, v201, v95, 0
    v_mov_b32 v202, v200
    v_mov_b32 v203, v201
    s_nop 0
    v_permlane16_swap_b32 v200, v202
    v_permlane16_swap_b32 v201, v203
    v_max_f32 v200, v200, v202
    v_max_f32 v201, v201, v203
    v_mov_b32 v202, v200
    v_mov_b32 v203, v201
    s_nop 0
    v_permlane32_swap_b32 v200, v202
    v_permlane32_swap_b32 v201, v203
    v_max_f32 v200, v200, v202
    v_max_f32 v201, v201, v203
    v_exp_f32 v204, -v200
    v_exp_f32 v205, -v201
    v_sub_f32 v64, v64, v200
    v_sub_f32 v65, v65, v200
    v_sub_f32 v66, v66, v200
    v_sub_f32 v67, v67, v200
    v_sub_f32 v68, v68, v201
    v_sub_f32 v69, v69, v201
    v_sub_f32 v70, v70, v201
    v_sub_f32 v71, v71, v201
    v_sub_f32 v72, v72, v200
    v_sub_f32 v73, v73, v200
    v_sub_f32 v74, v74, v200
    v_sub_f32 v75, v75, v200
    v_sub_f32 v76, v76, v201
    v_sub_f32 v77, v77, v201
    v_sub_f32 v78, v78, v201
    v_sub_f32 v79, v79, v201
    v_sub_f32 v80, v80, v200
    v_sub_f32 v81, v81, v200
    v_sub_f32 v82, v82, v200
    v_sub_f32 v83, v83, v200
    v_sub_f32 v84, v84, v201
    v_sub_f32 v85, v85, v201
    v_sub_f32 v86, v86, v201
    v_sub_f32 v87, v87, v201
    v_sub_f32 v88, v88, v200
    v_sub_f32 v89, v89, v200
    v_sub_f32 v90, v90, v200
    v_sub_f32 v91, v91, v200
    v_sub_f32 v92, v92, v201
    v_sub_f32 v93, v93, v201
    v_sub_f32 v94, v94, v201
    v_sub_f32 v95, v95, v201
    v_sub_f32 v208, v208, v200
    v_sub_f32 v209, v209, v200
    v_sub_f32 v210, v210, v200
    v_sub_f32 v211, v211, v200
    v_sub_f32 v212, v212, v201
    v_sub_f32 v213, v213, v201
    v_sub_f32 v214, v214, v201
    v_sub_f32 v215, v215, v201
    v_sub_f32 v0, v0, v200
    v_sub_f32 v1, v1, v200
    v_sub_f32 v2, v2, v200
    v_sub_f32 v3, v3, v200
    v_sub_f32 v4, v4, v201
    v_sub_f32 v5, v5, v201
    v_sub_f32 v6, v6, v201
    v_sub_f32 v7, v7, v201
    v_accvgpr_write_b32 a242, v204
    v_accvgpr_write_b32 a243, v205
    s_bitset1_b32 s13, 9
    s_nop 1
    s_branch L_back9

L_rare10:
    v_max3_f32 v200, v200, v27, 0
    v_max3_f32 v201, v201, v31, 0
    v_mov_b32 v202, v200
    v_mov_b32 v203, v201
    s_nop 0
    v_permlane16_swap_b32 v200, v202
    v_permlane16_swap_b32 v201, v203
    v_max_f32 v200, v200, v202
    v_max_f32 v201, v201, v203
    v_mov_b32 v202, v200
    v_mov_b32 v203, v201
    s_nop 0
    v_permlane32_swap_b32 v200, v202
    v_permlane32_swap_b32 v201, v203
    v_max_f32 v200, v200, v202
    v_max_f32 v201, v201, v203
    v_exp_f32 v204, -v200
    v_exp_f32 v205, -v201
    v_sub_f32 v0, v0, v200
    v_sub_f32 v1, v1, v200
    v_sub_f32 v2, v2, v200
    v_sub_f32 v3, v3, v200
    v_sub_f32 v4, v4, v201
    v_sub_f32 v5, v5, v201
    v_sub_f32 v6, v6, v201
    v_sub_f32 v7, v7, v201
    v_sub_f32 v8, v8, v200
    v_sub_f32 v9, v9, v200
    v_sub_f32 v10, v10, v200
    v_sub_f32 v11, v11, v200
    v_sub_f32 v12, v12, v201
    v_sub_f32 v13, v13, v201
    v_sub_f32 v14, v14, v201
    v_sub_f32 v15, v15, v201
    v_sub_f32 v16, v16, v200
    v_sub_f32 v17, v17, v200
    v_sub_f32 v18, v18, v200
    v_sub_f32 v19, v19, v200
    v_sub_f32 v20, v20, v201
    v_sub_f32 v21, v21, v201
    v_sub_f32 v22, v22, v201
    v_sub_f32 v23, v23, v201
    v_sub_f32 v24, v24, v200
    v_sub_f32 v25, v25, v200
    v_sub_f32 v26, v26, v200
    v_sub_f32 v27, v27, v200
    v_sub_f32 v28, v28, v201
    v_sub_f32 v29, v29, v201
    v_sub_f32 v30, v30, v201
    v_sub_f32 v31, v31, v201
    v_sub_f32 v208, v208, v200
    v_sub_f32 v209, v209, v200
    v_sub_f32 v210, v210, v200
    v_sub_f32 v211, v211, v200
    v_sub_f32 v212, v212, v201
    v_sub_f32 v213, v213, v201
    v_sub_f32 v214, v214, v201
    v_sub_f32 v215, v215, v201
    v_sub_f32 v64, v64, v200
    v_sub_f32 v65, v65, v200
    v_sub_f32 v66, v66, v200
    v_sub_f32 v67, v67, v200
    v_sub_f32 v68, v68, v201
    v_sub_f32 v69, v69, v201
    v_sub_f32 v70, v70, v201
    v_sub_f32 v71, v71, v201
    v_accvgpr_write_b32 a244, v204
    v_accvgpr_write_b32 a245, v205
    s_bitset1_b32 s13, 10
    s_nop 1
    s_branch L_back10

L_rare11:
    v_max3_f32 v200, v200, v91, 0
    v_max3_f32 v201, v201, v95, 0
    v_mov_b32 v202, v200
    v_mov_b32 v203, v201
    s_nop 0
    v_permlane16_swap_b32 v200, v202
    v_permlane16_swap_b32 v201, v203
    v_max_f32 v200, v200, v202
    v_max_f32 v201, v201, v203
    v_mov_b32 v202, v200
    v_mov_b32 v203, v201
    s_nop 0
    v_permlane32_swap_b32 v200, v202
    v_permlane32_swap_b32 v201, v203
    v_max_f32 v200, v200, v202
    v_max_f32 v201, v201, v203
    v_exp_f32 v204, -v200
    v_exp_f32 v205, -v201
    v_sub_f32 v64, v64, v200
    v_sub_f32 v65, v65, v200
    v_sub_f32 v66, v66, v200
    v_sub_f32 v67, v67, v200
    v_sub_f32 v68, v68, v201
    v_sub_f32 v69, v69, v201
    v_sub_f32 v70, v70, v201
    v_sub_f32 v71, v71, v201
    v_sub_f32 v72, v72, v200
    v_sub_f32 v73, v73, v200
    v_sub_f32 v74, v74, v200
    v_sub_f32 v75, v75, v200
    v_sub_f32 v76, v76, v201
    v_sub_f32 v77, v77, v201
    v_sub_f32 v78, v78, v201
    v_sub_f32 v79, v79, v201
    v_sub_f32 v80, v80, v200
    v_sub_f32 v81, v81, v200
    v_sub_f32 v82, v82, v200
    v_sub_f32 v83, v83, v200
    v_sub_f32 v84, v84, v201
    v_sub_f32 v85, v85, v201
    v_sub_f32 v86, v86, v201
    v_sub_f32 v87, v87, v201
    v_sub_f32 v88, v88, v200
    v_sub_f32 v89, v89, v200
    v_sub_f32 v90, v90, v200
    v_sub_f32 v91, v91, v200
    v_sub_f32 v92, v92, v201
    v_sub_f32 v93, v93, v201
    v_sub_f32 v94, v94, v201
    v_sub_f32 v95, v95, v201
    v_sub_f32 v208, v208, v200
    v_sub_f32 v209, v209, v200
    v_sub_f32 v210, v210, v200
    v_sub_f32 v211, v211, v200
    v_sub_f32 v212, v212, v201
    v_sub_f32 v213, v213, v201
    v_sub_f32 v214, v214, v201
    v_sub_f32 v215, v215, v201
    v_sub_f32 v0, v0, v200
    v_sub_f32 v1, v1, v200
    v_sub_f32 v2, v2, v200
    v_sub_f32 v3, v3, v200
    v_sub_f32 v4, v4, v201
    v_sub_f32 v5, v5, v201
    v_sub_f32 v6, v6, v201
    v_sub_f32 v7, v7, v201
    v_accvgpr_write_b32 a246, v204
    v_accvgpr_write_b32 a247, v205
    s_bitset1_b32 s13, 11
    s_nop 1
    s_branch L_back11

L_rare12:
    v_max3_f32 v200, v200, v27, 0
    v_max3_f32 v201, v201, v31, 0
    v_mov_b32 v202, v200
    v_mov_b32 v203, v201
    s_nop 0
    v_permlane16_swap_b32 v200, v202
    v_permlane16_swap_b32 v201, v203
    v_max_f32 v200, v200, v202
    v_max_f32 v201, v201, v203
    v_mov_b32 v202, v200
    v_mov_b32 v203, v201
    s_nop 0
    v_permlane32_swap_b32 v200, v202
    v_permlane32_swap_b32 v201, v203
    v_max_f32 v200, v200, v202
    v_max_f32 v201, v201, v203
    v_exp_f32 v204, -v200
    v_exp_f32 v205, -v201
    v_sub_f32 v0, v0, v200
    v_sub_f32 v1, v1, v200
    v_sub_f32 v2, v2, v200
    v_sub_f32 v3, v3, v200
    v_sub_f32 v4, v4, v201
    v_sub_f32 v5, v5, v201
    v_sub_f32 v6, v6, v201
    v_sub_f32 v7, v7, v201
    v_sub_f32 v8, v8, v200
    v_sub_f32 v9, v9, v200
    v_sub_f32 v10, v10, v200
    v_sub_f32 v11, v11, v200
    v_sub_f32 v12, v12, v201
    v_sub_f32 v13, v13, v201
    v_sub_f32 v14, v14, v201
    v_sub_f32 v15, v15, v201
    v_sub_f32 v16, v16, v200
    v_sub_f32 v17, v17, v200
    v_sub_f32 v18, v18, v200
    v_sub_f32 v19, v19, v200
    v_sub_f32 v20, v20, v201
    v_sub_f32 v21, v21, v201
    v_sub_f32 v22, v22, v201
    v_sub_f32 v23, v23, v201
    v_sub_f32 v24, v24, v200
    v_sub_f32 v25, v25, v200
    v_sub_f32 v26, v26, v200
    v_sub_f32 v27, v27, v200
    v_sub_f32 v28, v28, v201
    v_sub_f32 v29, v29, v201
    v_sub_f32 v30, v30, v201
    v_sub_f32 v31, v31, v201
    v_sub_f32 v208, v208, v200
    v_sub_f32 v209, v209, v200
    v_sub_f32 v210, v210, v200
    v_sub_f32 v211, v211, v200
    v_sub_f32 v212, v212, v201
    v_sub_f32 v213, v213, v201
    v_sub_f32 v214, v214, v201
    v_sub_f32 v215, v215, v201
    v_sub_f32 v64, v64, v200
    v_sub_f32 v65, v65, v200
    v_sub_f32 v66, v66, v200
    v_sub_f32 v67, v67, v200
    v_sub_f32 v68, v68, v201
    v_sub_f32 v69, v69, v201
    v_sub_f32 v70, v70, v201
    v_sub_f32 v71, v71, v201
    v_accvgpr_write_b32 a248, v204
    v_accvgpr_write_b32 a249, v205
    s_bitset1_b32 s13, 12
    s_nop 1
    s_branch L_back12

L_rare13:
    v_max3_f32 v200, v200, v91, 0
    v_max3_f32 v201, v201, v95, 0
    v_mov_b32 v202, v200
    v_mov_b32 v203, v201
    s_nop 0
    v_permlane16_swap_b32 v200, v202
    v_permlane16_swap_b32 v201, v203
    v_max_f32 v200, v200, v202
    v_max_f32 v201, v201, v203
    v_mov_b32 v202, v200
    v_mov_b32 v203, v201
    s_nop 0
    v_permlane32_swap_b32 v200, v202
    v_permlane32_swap_b32 v201, v203
    v_max_f32 v200, v200, v202
    v_max_f32 v201, v201, v203
    v_exp_f32 v204, -v200
    v_exp_f32 v205, -v201
    v_sub_f32 v64, v64, v200
    v_sub_f32 v65, v65, v200
    v_sub_f32 v66, v66, v200
    v_sub_f32 v67, v67, v200
    v_sub_f32 v68, v68, v201
    v_sub_f32 v69, v69, v201
    v_sub_f32 v70, v70, v201
    v_sub_f32 v71, v71, v201
    v_sub_f32 v72, v72, v200
    v_sub_f32 v73, v73, v200
    v_sub_f32 v74, v74, v200
    v_sub_f32 v75, v75, v200
    v_sub_f32 v76, v76, v201
    v_sub_f32 v77, v77, v201
    v_sub_f32 v78, v78, v201
    v_sub_f32 v79, v79, v201
    v_sub_f32 v80, v80, v200
    v_sub_f32 v81, v81, v200
    v_sub_f32 v82, v82, v200
    v_sub_f32 v83, v83, v200
    v_sub_f32 v84, v84, v201
    v_sub_f32 v85, v85, v201
    v_sub_f32 v86, v86, v201
    v_sub_f32 v87, v87, v201
    v_sub_f32 v88, v88, v200
    v_sub_f32 v89, v89, v200
    v_sub_f32 v90, v90, v200
    v_sub_f32 v91, v91, v200
    v_sub_f32 v92, v92, v201
    v_sub_f32 v93, v93, v201
    v_sub_f32 v94, v94, v201
    v_sub_f32 v95, v95, v201
    v_sub_f32 v208, v208, v200
    v_sub_f32 v209, v209, v200
    v_sub_f32 v210, v210, v200
    v_sub_f32 v211, v211, v200
    v_sub_f32 v212, v212, v201
    v_sub_f32 v213, v213, v201
    v_sub_f32 v214, v214, v201
    v_sub_f32 v215, v215, v201
    v_sub_f32 v0, v0, v200
    v_sub_f32 v1, v1, v200
    v_sub_f32 v2, v2, v200
    v_sub_f32 v3, v3, v200
    v_sub_f32 v4, v4, v201
    v_sub_f32 v5, v5, v201
    v_sub_f32 v6, v6, v201
    v_sub_f32 v7, v7, v201
    v_accvgpr_write_b32 a250, v204
    v_accvgpr_write_b32 a251, v205
    s_bitset1_b32 s13, 13
    s_nop 1
    s_branch L_back13

L_rare14:
    v_max3_f32 v200, v200, v27, 0
    v_max3_f32 v201, v201, v31, 0
    v_mov_b32 v202, v200
    v_mov_b32 v203, v201
    s_nop 0
    v_permlane16_swap_b32 v200, v202
    v_permlane16_swap_b32 v201, v203
    v_max_f32 v200, v200, v202
    v_max_f32 v201, v201, v203
    v_mov_b32 v202, v200
    v_mov_b32 v203, v201
    s_nop 0
    v_permlane32_swap_b32 v200, v202
    v_permlane32_swap_b32 v201, v203
    v_max_f32 v200, v200, v202
    v_max_f32 v201, v201, v203
    v_exp_f32 v204, -v200
    v_exp_f32 v205, -v201
    v_sub_f32 v0, v0, v200
    v_sub_f32 v1, v1, v200
    v_sub_f32 v2, v2, v200
    v_sub_f32 v3, v3, v200
    v_sub_f32 v4, v4, v201
    v_sub_f32 v5, v5, v201
    v_sub_f32 v6, v6, v201
    v_sub_f32 v7, v7, v201
    v_sub_f32 v8, v8, v200
    v_sub_f32 v9, v9, v200
    v_sub_f32 v10, v10, v200
    v_sub_f32 v11, v11, v200
    v_sub_f32 v12, v12, v201
    v_sub_f32 v13, v13, v201
    v_sub_f32 v14, v14, v201
    v_sub_f32 v15, v15, v201
    v_sub_f32 v16, v16, v200
    v_sub_f32 v17, v17, v200
    v_sub_f32 v18, v18, v200
    v_sub_f32 v19, v19, v200
    v_sub_f32 v20, v20, v201
    v_sub_f32 v21, v21, v201
    v_sub_f32 v22, v22, v201
    v_sub_f32 v23, v23, v201
    v_sub_f32 v24, v24, v200
    v_sub_f32 v25, v25, v200
    v_sub_f32 v26, v26, v200
    v_sub_f32 v27, v27, v200
    v_sub_f32 v28, v28, v201
    v_sub_f32 v29, v29, v201
    v_sub_f32 v30, v30, v201
    v_sub_f32 v31, v31, v201
    v_sub_f32 v208, v208, v200
    v_sub_f32 v209, v209, v200
    v_sub_f32 v210, v210, v200
    v_sub_f32 v211, v211, v200
    v_sub_f32 v212, v212, v201
    v_sub_f32 v213, v213, v201
    v_sub_f32 v214, v214, v201
    v_sub_f32 v215, v215, v201
    v_sub_f32 v64, v64, v200
    v_sub_f32 v65, v65, v200
    v_sub_f32 v66, v66, v200
    v_sub_f32 v67, v67, v200
    v_sub_f32 v68, v68, v201
    v_sub_f32 v69, v69, v201
    v_sub_f32 v70, v70, v201
    v_sub_f32 v71, v71, v201
    v_accvgpr_write_b32 a252, v204
    v_accvgpr_write_b32 a253, v205
    s_bitset1_b32 s13, 14
    s_nop 1
    s_branch L_back14

L_rare15:
    v_max3_f32 v200, v200, v91, 0
    v_max3_f32 v201, v201, v95, 0
    v_mov_b32 v202, v200
    v_mov_b32 v203, v201
    s_nop 0
    v_permlane16_swap_b32 v200, v202
    v_permlane16_swap_b32 v201, v203
    v_max_f32 v200, v200, v202
    v_max_f32 v201, v201, v203
    v_mov_b32 v202, v200
    v_mov_b32 v203, v201
    s_nop 0
    v_permlane32_swap_b32 v200, v202
    v_permlane32_swap_b32 v201, v203
    v_max_f32 v200, v200, v202
    v_max_f32 v201, v201, v203
    v_exp_f32 v204, -v200
    v_exp_f32 v205, -v201
    v_sub_f32 v64, v64, v200
    v_sub_f32 v65, v65, v200
    v_sub_f32 v66, v66, v200
    v_sub_f32 v67, v67, v200
    v_sub_f32 v68, v68, v201
    v_sub_f32 v69, v69, v201
    v_sub_f32 v70, v70, v201
    v_sub_f32 v71, v71, v201
    v_sub_f32 v72, v72, v200
    v_sub_f32 v73, v73, v200
    v_sub_f32 v74, v74, v200
    v_sub_f32 v75, v75, v200
    v_sub_f32 v76, v76, v201
    v_sub_f32 v77, v77, v201
    v_sub_f32 v78, v78, v201
    v_sub_f32 v79, v79, v201
    v_sub_f32 v80, v80, v200
    v_sub_f32 v81, v81, v200
    v_sub_f32 v82, v82, v200
    v_sub_f32 v83, v83, v200
    v_sub_f32 v84, v84, v201
    v_sub_f32 v85, v85, v201
    v_sub_f32 v86, v86, v201
    v_sub_f32 v87, v87, v201
    v_sub_f32 v88, v88, v200
    v_sub_f32 v89, v89, v200
    v_sub_f32 v90, v90, v200
    v_sub_f32 v91, v91, v200
    v_sub_f32 v92, v92, v201
    v_sub_f32 v93, v93, v201
    v_sub_f32 v94, v94, v201
    v_sub_f32 v95, v95, v201
    v_accvgpr_write_b32 a254, v204
    v_accvgpr_write_b32 a255, v205
    s_bitset1_b32 s13, 15
    s_nop 1
    s_branch L_back15

L_resc1:
    v_accvgpr_read_b32 v204, a226
    v_accvgpr_read_b32 v205, a227
    v_mul_f32 v192, v192, v204
    v_mul_f32 v193, v193, v204
    v_mul_f32 v194, v194, v204
    v_mul_f32 v195, v195, v204
    v_mul_f32 v196, v196, v205
    v_mul_f32 v197, v197, v205
    v_mul_f32 v198, v198, v205
    v_mul_f32 v199, v199, v205
    v_mul_f32 v0, v0, v204
    v_mul_f32 v1, v1, v204
    v_mul_f32 v2, v2, v204
    v_mul_f32 v3, v3, v204
    v_mul_f32 v4, v4, v205
    v_mul_f32 v5, v5, v205
    v_mul_f32 v6, v6, v205
    v_mul_f32 v7, v7, v205
    v_mul_f32 v8, v8, v204
    v_mul_f32 v9, v9, v204
    v_mul_f32 v10, v10, v204
    v_mul_f32 v11, v11, v204
    v_mul_f32 v12, v12, v205
    v_mul_f32 v13, v13, v205
    v_mul_f32 v14, v14, v205
    v_mul_f32 v15, v15, v205
    v_mul_f32 v16, v16, v204
    v_mul_f32 v17, v17, v204
    v_mul_f32 v18, v18, v204
    v_mul_f32 v19, v19, v204
    v_mul_f32 v20, v20, v205
    v_mul_f32 v21, v21, v205
    v_mul_f32 v22, v22, v205
    v_mul_f32 v23, v23, v205
    v_mul_f32 v24, v24, v204
    v_mul_f32 v25, v25, v204
    v_mul_f32 v26, v26, v204
    v_mul_f32 v27, v27, v204
    v_mul_f32 v28, v28, v205
    v_mul_f32 v29, v29, v205
    v_mul_f32 v30, v30, v205
    v_mul_f32 v31, v31, v205
    v_mul_f32 v32, v32, v204
    v_mul_f32 v33, v33, v204
    v_mul_f32 v34, v34, v204
    v_mul_f32 v35, v35, v204
    v_mul_f32 v36, v36, v205
    v_mul_f32 v37, v37, v205
    v_mul_f32 v38, v38, v205
    v_mul_f32 v39, v39, v205
    v_mul_f32 v40, v40, v204
    v_mul_f32 v41, v41, v204
    v_mul_f32 v42, v42, v204
    v_mul_f32 v43, v43, v204
    v_mul_f32 v44, v44, v205
    v_mul_f32 v45, v45, v205
    v_mul_f32 v46, v46, v205
    v_mul_f32 v47, v47, v205
    v_mul_f32 v48, v48, v204
    v_mul_f32 v49, v49, v204
    v_mul_f32 v50, v50, v204
    v_mul_f32 v51, v51, v204
    v_mul_f32 v52, v52, v205
    v_mul_f32 v53, v53, v205
    v_mul_f32 v54, v54, v205
    v_mul_f32 v55, v55, v205
    v_mul_f32 v56, v56, v204
    v_mul_f32 v57, v57, v204
    v_mul_f32 v58, v58, v204
    v_mul_f32 v59, v59, v204
    v_mul_f32 v60, v60, v205
    v_mul_f32 v61, v61, v205
    v_mul_f32 v62, v62, v205
    v_mul_f32 v63, v63, v205
    s_nop 1
    s_branch L_rback1

L_resc2:
    v_accvgpr_read_b32 v204, a228
    v_accvgpr_read_b32 v205, a229
    v_mul_f32 v192, v192, v204
    v_mul_f32 v193, v193, v204
    v_mul_f32 v194, v194, v204
    v_mul_f32 v195, v195, v204
    v_mul_f32 v196, v196, v205
    v_mul_f32 v197, v197, v205
    v_mul_f32 v198, v198, v205
    v_mul_f32 v199, v199, v205
    v_mul_f32 v0, v0, v204
    v_mul_f32 v1, v1, v204
    v_mul_f32 v2, v2, v204
    v_mul_f32 v3, v3, v204
    v_mul_f32 v4, v4, v205
    v_mul_f32 v5, v5, v205
    v_mul_f32 v6, v6, v205
    v_mul_f32 v7, v7, v205
    v_mul_f32 v8, v8, v204
    v_mul_f32 v9, v9, v204
    v_mul_f32 v10, v10, v204
    v_mul_f32 v11, v11, v204
    v_mul_f32 v12, v12, v205
    v_mul_f32 v13, v13, v205
    v_mul_f32 v14, v14, v205
    v_mul_f32 v15, v15, v205
    v_mul_f32 v16, v16, v204
    v_mul_f32 v17, v17, v204
    v_mul_f32 v18, v18, v204
    v_mul_f32 v19, v19, v204
    v_mul_f32 v20, v20, v205
    v_mul_f32 v21, v21, v205
    v_mul_f32 v22, v22, v205
    v_mul_f32 v23, v23, v205
    v_mul_f32 v24, v24, v204
    v_mul_f32 v25, v25, v204
    v_mul_f32 v26, v26, v204
    v_mul_f32 v27, v27, v204
    v_mul_f32 v28, v28, v205
    v_mul_f32 v29, v29, v205
    v_mul_f32 v30, v30, v205
    v_mul_f32 v31, v31, v205
    v_mul_f32 v32, v32, v204
    v_mul_f32 v33, v33, v204
    v_mul_f32 v34, v34, v204
    v_mul_f32 v35, v35, v204
    v_mul_f32 v36, v36, v205
    v_mul_f32 v37, v37, v205
    v_mul_f32 v38, v38, v205
    v_mul_f32 v39, v39, v205
    v_mul_f32 v40, v40, v204
    v_mul_f32 v41, v41, v204
    v_mul_f32 v42, v42, v204
    v_mul_f32 v43, v43, v204
    v_mul_f32 v44, v44, v205
    v_mul_f32 v45, v45, v205
    v_mul_f32 v46, v46, v205
    v_mul_f32 v47, v47, v205
    v_mul_f32 v48, v48, v204
    v_mul_f32 v49, v49, v204
    v_mul_f32 v50, v50, v204
    v_mul_f32 v51, v51, v204
    v_mul_f32 v52, v52, v205
    v_mul_f32 v53, v53, v205
    v_mul_f32 v54, v54, v205
    v_mul_f32 v55, v55, v205
    v_mul_f32 v56, v56, v204
    v_mul_f32 v57, v57, v204
    v_mul_f32 v58, v58, v204
    v_mul_f32 v59, v59, v204
    v_mul_f32 v60, v60, v205
    v_mul_f32 v61, v61, v205
    v_mul_f32 v62, v62, v205
    v_mul_f32 v63, v63, v205
    s_nop 1
    s_branch L_rback2

L_resc3:
    v_accvgpr_read_b32 v204, a230
    v_accvgpr_read_b32 v205, a231
    v_mul_f32 v192, v192, v204
    v_mul_f32 v193, v193, v204
    v_mul_f32 v194, v194, v204
    v_mul_f32 v195, v195, v204
    v_mul_f32 v196, v196, v205
    v_mul_f32 v197, v197, v205
    v_mul_f32 v198, v198, v205
    v_mul_f32 v199, v199, v205
    v_mul_f32 v0, v0, v204
    v_mul_f32 v1, v1, v204
    v_mul_f32 v2, v2, v204
    v_mul_f32 v3, v3, v204
    v_mul_f32 v4, v4, v205
    v_mul_f32 v5, v5, v205
    v_mul_f32 v6, v6, v205
    v_mul_f32 v7, v7, v205
    v_mul_f32 v8, v8, v204
    v_mul_f32 v9, v9, v204
    v_mul_f32 v10, v10, v204
    v_mul_f32 v11, v11, v204
    v_mul_f32 v12, v12, v205
    v_mul_f32 v13, v13, v205
    v_mul_f32 v14, v14, v205
    v_mul_f32 v15, v15, v205
    v_mul_f32 v16, v16, v204
    v_mul_f32 v17, v17, v204
    v_mul_f32 v18, v18, v204
    v_mul_f32 v19, v19, v204
    v_mul_f32 v20, v20, v205
    v_mul_f32 v21, v21, v205
    v_mul_f32 v22, v22, v205
    v_mul_f32 v23, v23, v205
    v_mul_f32 v24, v24, v204
    v_mul_f32 v25, v25, v204
    v_mul_f32 v26, v26, v204
    v_mul_f32 v27, v27, v204
    v_mul_f32 v28, v28, v205
    v_mul_f32 v29, v29, v205
    v_mul_f32 v30, v30, v205
    v_mul_f32 v31, v31, v205
    v_mul_f32 v32, v32, v204
    v_mul_f32 v33, v33, v204
    v_mul_f32 v34, v34, v204
    v_mul_f32 v35, v35, v204
    v_mul_f32 v36, v36, v205
    v_mul_f32 v37, v37, v205
    v_mul_f32 v38, v38, v205
    v_mul_f32 v39, v39, v205
    v_mul_f32 v40, v40, v204
    v_mul_f32 v41, v41, v204
    v_mul_f32 v42, v42, v204
    v_mul_f32 v43, v43, v204
    v_mul_f32 v44, v44, v205
    v_mul_f32 v45, v45, v205
    v_mul_f32 v46, v46, v205
    v_mul_f32 v47, v47, v205
    v_mul_f32 v48, v48, v204
    v_mul_f32 v49, v49, v204
    v_mul_f32 v50, v50, v204
    v_mul_f32 v51, v51, v204
    v_mul_f32 v52, v52, v205
    v_mul_f32 v53, v53, v205
    v_mul_f32 v54, v54, v205
    v_mul_f32 v55, v55, v205
    v_mul_f32 v56, v56, v204
    v_mul_f32 v57, v57, v204
    v_mul_f32 v58, v58, v204
    v_mul_f32 v59, v59, v204
    v_mul_f32 v60, v60, v205
    v_mul_f32 v61, v61, v205
    v_mul_f32 v62, v62, v205
    v_mul_f32 v63, v63, v205
    s_nop 1
    s_branch L_rback3

L_resc4:
    v_accvgpr_read_b32 v204, a232
    v_accvgpr_read_b32 v205, a233
    v_mul_f32 v192, v192, v204
    v_mul_f32 v193, v193, v204
    v_mul_f32 v194, v194, v204
    v_mul_f32 v195, v195, v204
    v_mul_f32 v196, v196, v205
    v_mul_f32 v197, v197, v205
    v_mul_f32 v198, v198, v205
    v_mul_f32 v199, v199, v205
    v_mul_f32 v0, v0, v204
    v_mul_f32 v1, v1, v204
    v_mul_f32 v2, v2, v204
    v_mul_f32 v3, v3, v204
    v_mul_f32 v4, v4, v205
    v_mul_f32 v5, v5, v205
    v_mul_f32 v6, v6, v205
    v_mul_f32 v7, v7, v205
    v_mul_f32 v8, v8, v204
    v_mul_f32 v9, v9, v204
    v_mul_f32 v10, v10, v204
    v_mul_f32 v11, v11, v204
    v_mul_f32 v12, v12, v205
    v_mul_f32 v13, v13, v205
    v_mul_f32 v14, v14, v205
    v_mul_f32 v15, v15, v205
    v_mul_f32 v16, v16, v204
    v_mul_f32 v17, v17, v204
    v_mul_f32 v18, v18, v204
    v_mul_f32 v19, v19, v204
    v_mul_f32 v20, v20, v205
    v_mul_f32 v21, v21, v205
    v_mul_f32 v22, v22, v205
    v_mul_f32 v23, v23, v205
    v_mul_f32 v24, v24, v204
    v_mul_f32 v25, v25, v204
    v_mul_f32 v26, v26, v204
    v_mul_f32 v27, v27, v204
    v_mul_f32 v28, v28, v205
    v_mul_f32 v29, v29, v205
    v_mul_f32 v30, v30, v205
    v_mul_f32 v31, v31, v205
    v_mul_f32 v32, v32, v204
    v_mul_f32 v33, v33, v204
    v_mul_f32 v34, v34, v204
    v_mul_f32 v35, v35, v204
    v_mul_f32 v36, v36, v205
    v_mul_f32 v37, v37, v205
    v_mul_f32 v38, v38, v205
    v_mul_f32 v39, v39, v205
    v_mul_f32 v40, v40, v204
    v_mul_f32 v41, v41, v204
    v_mul_f32 v42, v42, v204
    v_mul_f32 v43, v43, v204
    v_mul_f32 v44, v44, v205
    v_mul_f32 v45, v45, v205
    v_mul_f32 v46, v46, v205
    v_mul_f32 v47, v47, v205
    v_mul_f32 v48, v48, v204
    v_mul_f32 v49, v49, v204
    v_mul_f32 v50, v50, v204
    v_mul_f32 v51, v51, v204
    v_mul_f32 v52, v52, v205
    v_mul_f32 v53, v53, v205
    v_mul_f32 v54, v54, v205
    v_mul_f32 v55, v55, v205
    v_mul_f32 v56, v56, v204
    v_mul_f32 v57, v57, v204
    v_mul_f32 v58, v58, v204
    v_mul_f32 v59, v59, v204
    v_mul_f32 v60, v60, v205
    v_mul_f32 v61, v61, v205
    v_mul_f32 v62, v62, v205
    v_mul_f32 v63, v63, v205
    s_nop 1
    s_branch L_rback4

L_resc5:
    v_accvgpr_read_b32 v204, a234
    v_accvgpr_read_b32 v205, a235
    v_mul_f32 v192, v192, v204
    v_mul_f32 v193, v193, v204
    v_mul_f32 v194, v194, v204
    v_mul_f32 v195, v195, v204
    v_mul_f32 v196, v196, v205
    v_mul_f32 v197, v197, v205
    v_mul_f32 v198, v198, v205
    v_mul_f32 v199, v199, v205
    v_mul_f32 v0, v0, v204
    v_mul_f32 v1, v1, v204
    v_mul_f32 v2, v2, v204
    v_mul_f32 v3, v3, v204
    v_mul_f32 v4, v4, v205
    v_mul_f32 v5, v5, v205
    v_mul_f32 v6, v6, v205
    v_mul_f32 v7, v7, v205
    v_mul_f32 v8, v8, v204
    v_mul_f32 v9, v9, v204
    v_mul_f32 v10, v10, v204
    v_mul_f32 v11, v11, v204
    v_mul_f32 v12, v12, v205
    v_mul_f32 v13, v13, v205
    v_mul_f32 v14, v14, v205
    v_mul_f32 v15, v15, v205
    v_mul_f32 v16, v16, v204
    v_mul_f32 v17, v17, v204
    v_mul_f32 v18, v18, v204
    v_mul_f32 v19, v19, v204
    v_mul_f32 v20, v20, v205
    v_mul_f32 v21, v21, v205
    v_mul_f32 v22, v22, v205
    v_mul_f32 v23, v23, v205
    v_mul_f32 v24, v24, v204
    v_mul_f32 v25, v25, v204
    v_mul_f32 v26, v26, v204
    v_mul_f32 v27, v27, v204
    v_mul_f32 v28, v28, v205
    v_mul_f32 v29, v29, v205
    v_mul_f32 v30, v30, v205
    v_mul_f32 v31, v31, v205
    v_mul_f32 v32, v32, v204
    v_mul_f32 v33, v33, v204
    v_mul_f32 v34, v34, v204
    v_mul_f32 v35, v35, v204
    v_mul_f32 v36, v36, v205
    v_mul_f32 v37, v37, v205
    v_mul_f32 v38, v38, v205
    v_mul_f32 v39, v39, v205
    v_mul_f32 v40, v40, v204
    v_mul_f32 v41, v41, v204
    v_mul_f32 v42, v42, v204
    v_mul_f32 v43, v43, v204
    v_mul_f32 v44, v44, v205
    v_mul_f32 v45, v45, v205
    v_mul_f32 v46, v46, v205
    v_mul_f32 v47, v47, v205
    v_mul_f32 v48, v48, v204
    v_mul_f32 v49, v49, v204
    v_mul_f32 v50, v50, v204
    v_mul_f32 v51, v51, v204
    v_mul_f32 v52, v52, v205
    v_mul_f32 v53, v53, v205
    v_mul_f32 v54, v54, v205
    v_mul_f32 v55, v55, v205
    v_mul_f32 v56, v56, v204
    v_mul_f32 v57, v57, v204
    v_mul_f32 v58, v58, v204
    v_mul_f32 v59, v59, v204
    v_mul_f32 v60, v60, v205
    v_mul_f32 v61, v61, v205
    v_mul_f32 v62, v62, v205
    v_mul_f32 v63, v63, v205
    s_nop 1
    s_branch L_rback5

L_resc6:
    v_accvgpr_read_b32 v204, a236
    v_accvgpr_read_b32 v205, a237
    v_mul_f32 v192, v192, v204
    v_mul_f32 v193, v193, v204
    v_mul_f32 v194, v194, v204
    v_mul_f32 v195, v195, v204
    v_mul_f32 v196, v196, v205
    v_mul_f32 v197, v197, v205
    v_mul_f32 v198, v198, v205
    v_mul_f32 v199, v199, v205
    v_mul_f32 v0, v0, v204
    v_mul_f32 v1, v1, v204
    v_mul_f32 v2, v2, v204
    v_mul_f32 v3, v3, v204
    v_mul_f32 v4, v4, v205
    v_mul_f32 v5, v5, v205
    v_mul_f32 v6, v6, v205
    v_mul_f32 v7, v7, v205
    v_mul_f32 v8, v8, v204
    v_mul_f32 v9, v9, v204
    v_mul_f32 v10, v10, v204
    v_mul_f32 v11, v11, v204
    v_mul_f32 v12, v12, v205
    v_mul_f32 v13, v13, v205
    v_mul_f32 v14, v14, v205
    v_mul_f32 v15, v15, v205
    v_mul_f32 v16, v16, v204
    v_mul_f32 v17, v17, v204
    v_mul_f32 v18, v18, v204
    v_mul_f32 v19, v19, v204
    v_mul_f32 v20, v20, v205
    v_mul_f32 v21, v21, v205
    v_mul_f32 v22, v22, v205
    v_mul_f32 v23, v23, v205
    v_mul_f32 v24, v24, v204
    v_mul_f32 v25, v25, v204
    v_mul_f32 v26, v26, v204
    v_mul_f32 v27, v27, v204
    v_mul_f32 v28, v28, v205
    v_mul_f32 v29, v29, v205
    v_mul_f32 v30, v30, v205
    v_mul_f32 v31, v31, v205
    v_mul_f32 v32, v32, v204
    v_mul_f32 v33, v33, v204
    v_mul_f32 v34, v34, v204
    v_mul_f32 v35, v35, v204
    v_mul_f32 v36, v36, v205
    v_mul_f32 v37, v37, v205
    v_mul_f32 v38, v38, v205
    v_mul_f32 v39, v39, v205
    v_mul_f32 v40, v40, v204
    v_mul_f32 v41, v41, v204
    v_mul_f32 v42, v42, v204
    v_mul_f32 v43, v43, v204
    v_mul_f32 v44, v44, v205
    v_mul_f32 v45, v45, v205
    v_mul_f32 v46, v46, v205
    v_mul_f32 v47, v47, v205
    v_mul_f32 v48, v48, v204
    v_mul_f32 v49, v49, v204
    v_mul_f32 v50, v50, v204
    v_mul_f32 v51, v51, v204
    v_mul_f32 v52, v52, v205
    v_mul_f32 v53, v53, v205
    v_mul_f32 v54, v54, v205
    v_mul_f32 v55, v55, v205
    v_mul_f32 v56, v56, v204
    v_mul_f32 v57, v57, v204
    v_mul_f32 v58, v58, v204
    v_mul_f32 v59, v59, v204
    v_mul_f32 v60, v60, v205
    v_mul_f32 v61, v61, v205
    v_mul_f32 v62, v62, v205
    v_mul_f32 v63, v63, v205
    s_nop 1
    s_branch L_rback6

L_resc7:
    v_accvgpr_read_b32 v204, a238
    v_accvgpr_read_b32 v205, a239
    v_mul_f32 v192, v192, v204
    v_mul_f32 v193, v193, v204
    v_mul_f32 v194, v194, v204
    v_mul_f32 v195, v195, v204
    v_mul_f32 v196, v196, v205
    v_mul_f32 v197, v197, v205
    v_mul_f32 v198, v198, v205
    v_mul_f32 v199, v199, v205
    v_mul_f32 v0, v0, v204
    v_mul_f32 v1, v1, v204
    v_mul_f32 v2, v2, v204
    v_mul_f32 v3, v3, v204
    v_mul_f32 v4, v4, v205
    v_mul_f32 v5, v5, v205
    v_mul_f32 v6, v6, v205
    v_mul_f32 v7, v7, v205
    v_mul_f32 v8, v8, v204
    v_mul_f32 v9, v9, v204
    v_mul_f32 v10, v10, v204
    v_mul_f32 v11, v11, v204
    v_mul_f32 v12, v12, v205
    v_mul_f32 v13, v13, v205
    v_mul_f32 v14, v14, v205
    v_mul_f32 v15, v15, v205
    v_mul_f32 v16, v16, v204
    v_mul_f32 v17, v17, v204
    v_mul_f32 v18, v18, v204
    v_mul_f32 v19, v19, v204
    v_mul_f32 v20, v20, v205
    v_mul_f32 v21, v21, v205
    v_mul_f32 v22, v22, v205
    v_mul_f32 v23, v23, v205
    v_mul_f32 v24, v24, v204
    v_mul_f32 v25, v25, v204
    v_mul_f32 v26, v26, v204
    v_mul_f32 v27, v27, v204
    v_mul_f32 v28, v28, v205
    v_mul_f32 v29, v29, v205
    v_mul_f32 v30, v30, v205
    v_mul_f32 v31, v31, v205
    v_mul_f32 v32, v32, v204
    v_mul_f32 v33, v33, v204
    v_mul_f32 v34, v34, v204
    v_mul_f32 v35, v35, v204
    v_mul_f32 v36, v36, v205
    v_mul_f32 v37, v37, v205
    v_mul_f32 v38, v38, v205
    v_mul_f32 v39, v39, v205
    v_mul_f32 v40, v40, v204
    v_mul_f32 v41, v41, v204
    v_mul_f32 v42, v42, v204
    v_mul_f32 v43, v43, v204
    v_mul_f32 v44, v44, v205
    v_mul_f32 v45, v45, v205
    v_mul_f32 v46, v46, v205
    v_mul_f32 v47, v47, v205
    v_mul_f32 v48, v48, v204
    v_mul_f32 v49, v49, v204
    v_mul_f32 v50, v50, v204
    v_mul_f32 v51, v51, v204
    v_mul_f32 v52, v52, v205
    v_mul_f32 v53, v53, v205
    v_mul_f32 v54, v54, v205
    v_mul_f32 v55, v55, v205
    v_mul_f32 v56, v56, v204
    v_mul_f32 v57, v57, v204
    v_mul_f32 v58, v58, v204
    v_mul_f32 v59, v59, v204
    v_mul_f32 v60, v60, v205
    v_mul_f32 v61, v61, v205
    v_mul_f32 v62, v62, v205
    v_mul_f32 v63, v63, v205
    s_nop 1
    s_branch L_rback7

L_resc8:
    v_accvgpr_read_b32 v204, a240
    v_accvgpr_read_b32 v205, a241
    v_mul_f32 v192, v192, v204
    v_mul_f32 v193, v193, v204
    v_mul_f32 v194, v194, v204
    v_mul_f32 v195, v195, v204
    v_mul_f32 v196, v196, v205
    v_mul_f32 v197, v197, v205
    v_mul_f32 v198, v198, v205
    v_mul_f32 v199, v199, v205
    v_mul_f32 v0, v0, v204
    v_mul_f32 v1, v1, v204
    v_mul_f32 v2, v2, v204
    v_mul_f32 v3, v3, v204
    v_mul_f32 v4, v4, v205
    v_mul_f32 v5, v5, v205
    v_mul_f32 v6, v6, v205
    v_mul_f32 v7, v7, v205
    v_mul_f32 v8, v8, v204
    v_mul_f32 v9, v9, v204
    v_mul_f32 v10, v10, v204
    v_mul_f32 v11, v11, v204
    v_mul_f32 v12, v12, v205
    v_mul_f32 v13, v13, v205
    v_mul_f32 v14, v14, v205
    v_mul_f32 v15, v15, v205
    v_mul_f32 v16, v16, v204
    v_mul_f32 v17, v17, v204
    v_mul_f32 v18, v18, v204
    v_mul_f32 v19, v19, v204
    v_mul_f32 v20, v20, v205
    v_mul_f32 v21, v21, v205
    v_mul_f32 v22, v22, v205
    v_mul_f32 v23, v23, v205
    v_mul_f32 v24, v24, v204
    v_mul_f32 v25, v25, v204
    v_mul_f32 v26, v26, v204
    v_mul_f32 v27, v27, v204
    v_mul_f32 v28, v28, v205
    v_mul_f32 v29, v29, v205
    v_mul_f32 v30, v30, v205
    v_mul_f32 v31, v31, v205
    v_mul_f32 v32, v32, v204
    v_mul_f32 v33, v33, v204
    v_mul_f32 v34, v34, v204
    v_mul_f32 v35, v35, v204
    v_mul_f32 v36, v36, v205
    v_mul_f32 v37, v37, v205
    v_mul_f32 v38, v38, v205
    v_mul_f32 v39, v39, v205
    v_mul_f32 v40, v40, v204
    v_mul_f32 v41, v41, v204
    v_mul_f32 v42, v42, v204
    v_mul_f32 v43, v43, v204
    v_mul_f32 v44, v44, v205
    v_mul_f32 v45, v45, v205
    v_mul_f32 v46, v46, v205
    v_mul_f32 v47, v47, v205
    v_mul_f32 v48, v48, v204
    v_mul_f32 v49, v49, v204
    v_mul_f32 v50, v50, v204
    v_mul_f32 v51, v51, v204
    v_mul_f32 v52, v52, v205
    v_mul_f32 v53, v53, v205
    v_mul_f32 v54, v54, v205
    v_mul_f32 v55, v55, v205
    v_mul_f32 v56, v56, v204
    v_mul_f32 v57, v57, v204
    v_mul_f32 v58, v58, v204
    v_mul_f32 v59, v59, v204
    v_mul_f32 v60, v60, v205
    v_mul_f32 v61, v61, v205
    v_mul_f32 v62, v62, v205
    v_mul_f32 v63, v63, v205
    s_nop 1
    s_branch L_rback8

L_resc9:
    v_accvgpr_read_b32 v204, a242
    v_accvgpr_read_b32 v205, a243
    v_mul_f32 v192, v192, v204
    v_mul_f32 v193, v193, v204
    v_mul_f32 v194, v194, v204
    v_mul_f32 v195, v195, v204
    v_mul_f32 v196, v196, v205
    v_mul_f32 v197, v197, v205
    v_mul_f32 v198, v198, v205
    v_mul_f32 v199, v199, v205
    v_mul_f32 v0, v0, v204
    v_mul_f32 v1, v1, v204
    v_mul_f32 v2, v2, v204
    v_mul_f32 v3, v3, v204
    v_mul_f32 v4, v4, v205
    v_mul_f32 v5, v5, v205
    v_mul_f32 v6, v6, v205
    v_mul_f32 v7, v7, v205
    v_mul_f32 v8, v8, v204
    v_mul_f32 v9, v9, v204
    v_mul_f32 v10, v10, v204
    v_mul_f32 v11, v11, v204
    v_mul_f32 v12, v12, v205
    v_mul_f32 v13, v13, v205
    v_mul_f32 v14, v14, v205
    v_mul_f32 v15, v15, v205
    v_mul_f32 v16, v16, v204
    v_mul_f32 v17, v17, v204
    v_mul_f32 v18, v18, v204
    v_mul_f32 v19, v19, v204
    v_mul_f32 v20, v20, v205
    v_mul_f32 v21, v21, v205
    v_mul_f32 v22, v22, v205
    v_mul_f32 v23, v23, v205
    v_mul_f32 v24, v24, v204
    v_mul_f32 v25, v25, v204
    v_mul_f32 v26, v26, v204
    v_mul_f32 v27, v27, v204
    v_mul_f32 v28, v28, v205
    v_mul_f32 v29, v29, v205
    v_mul_f32 v30, v30, v205
    v_mul_f32 v31, v31, v205
    v_mul_f32 v32, v32, v204
    v_mul_f32 v33, v33, v204
    v_mul_f32 v34, v34, v204
    v_mul_f32 v35, v35, v204
    v_mul_f32 v36, v36, v205
    v_mul_f32 v37, v37, v205
    v_mul_f32 v38, v38, v205
    v_mul_f32 v39, v39, v205
    v_mul_f32 v40, v40, v204
    v_mul_f32 v41, v41, v204
    v_mul_f32 v42, v42, v204
    v_mul_f32 v43, v43, v204
    v_mul_f32 v44, v44, v205
    v_mul_f32 v45, v45, v205
    v_mul_f32 v46, v46, v205
    v_mul_f32 v47, v47, v205
    v_mul_f32 v48, v48, v204
    v_mul_f32 v49, v49, v204
    v_mul_f32 v50, v50, v204
    v_mul_f32 v51, v51, v204
    v_mul_f32 v52, v52, v205
    v_mul_f32 v53, v53, v205
    v_mul_f32 v54, v54, v205
    v_mul_f32 v55, v55, v205
    v_mul_f32 v56, v56, v204
    v_mul_f32 v57, v57, v204
    v_mul_f32 v58, v58, v204
    v_mul_f32 v59, v59, v204
    v_mul_f32 v60, v60, v205
    v_mul_f32 v61, v61, v205
    v_mul_f32 v62, v62, v205
    v_mul_f32 v63, v63, v205
    s_nop 1
    s_branch L_rback9

L_resc10:
    v_accvgpr_read_b32 v204, a244
    v_accvgpr_read_b32 v205, a245
    v_mul_f32 v192, v192, v204
    v_mul_f32 v193, v193, v204
    v_mul_f32 v194, v194, v204
    v_mul_f32 v195, v195, v204
    v_mul_f32 v196, v196, v205
    v_mul_f32 v197, v197, v205
    v_mul_f32 v198, v198, v205
    v_mul_f32 v199, v199, v205
    v_mul_f32 v0, v0, v204
    v_mul_f32 v1, v1, v204
    v_mul_f32 v2, v2, v204
    v_mul_f32 v3, v3, v204
    v_mul_f32 v4, v4, v205
    v_mul_f32 v5, v5, v205
    v_mul_f32 v6, v6, v205
    v_mul_f32 v7, v7, v205
    v_mul_f32 v8, v8, v204
    v_mul_f32 v9, v9, v204
    v_mul_f32 v10, v10, v204
    v_mul_f32 v11, v11, v204
    v_mul_f32 v12, v12, v205
    v_mul_f32 v13, v13, v205
    v_mul_f32 v14, v14, v205
    v_mul_f32 v15, v15, v205
    v_mul_f32 v16, v16, v204
    v_mul_f32 v17, v17, v204
    v_mul_f32 v18, v18, v204
    v_mul_f32 v19, v19, v204
    v_mul_f32 v20, v20, v205
    v_mul_f32 v21, v21, v205
    v_mul_f32 v22, v22, v205
    v_mul_f32 v23, v23, v205
    v_mul_f32 v24, v24, v204
    v_mul_f32 v25, v25, v204
    v_mul_f32 v26, v26, v204
    v_mul_f32 v27, v27, v204
    v_mul_f32 v28, v28, v205
    v_mul_f32 v29, v29, v205
    v_mul_f32 v30, v30, v205
    v_mul_f32 v31, v31, v205
    v_mul_f32 v32, v32, v204
    v_mul_f32 v33, v33, v204
    v_mul_f32 v34, v34, v204
    v_mul_f32 v35, v35, v204
    v_mul_f32 v36, v36, v205
    v_mul_f32 v37, v37, v205
    v_mul_f32 v38, v38, v205
    v_mul_f32 v39, v39, v205
    v_mul_f32 v40, v40, v204
    v_mul_f32 v41, v41, v204
    v_mul_f32 v42, v42, v204
    v_mul_f32 v43, v43, v204
    v_mul_f32 v44, v44, v205
    v_mul_f32 v45, v45, v205
    v_mul_f32 v46, v46, v205
    v_mul_f32 v47, v47, v205
    v_mul_f32 v48, v48, v204
    v_mul_f32 v49, v49, v204
    v_mul_f32 v50, v50, v204
    v_mul_f32 v51, v51, v204
    v_mul_f32 v52, v52, v205
    v_mul_f32 v53, v53, v205
    v_mul_f32 v54, v54, v205
    v_mul_f32 v55, v55, v205
    v_mul_f32 v56, v56, v204
    v_mul_f32 v57, v57, v204
    v_mul_f32 v58, v58, v204
    v_mul_f32 v59, v59, v204
    v_mul_f32 v60, v60, v205
    v_mul_f32 v61, v61, v205
    v_mul_f32 v62, v62, v205
    v_mul_f32 v63, v63, v205
    s_nop 1
    s_branch L_rback10

L_resc11:
    v_accvgpr_read_b32 v204, a246
    v_accvgpr_read_b32 v205, a247
    v_mul_f32 v192, v192, v204
    v_mul_f32 v193, v193, v204
    v_mul_f32 v194, v194, v204
    v_mul_f32 v195, v195, v204
    v_mul_f32 v196, v196, v205
    v_mul_f32 v197, v197, v205
    v_mul_f32 v198, v198, v205
    v_mul_f32 v199, v199, v205
    v_mul_f32 v0, v0, v204
    v_mul_f32 v1, v1, v204
    v_mul_f32 v2, v2, v204
    v_mul_f32 v3, v3, v204
    v_mul_f32 v4, v4, v205
    v_mul_f32 v5, v5, v205
    v_mul_f32 v6, v6, v205
    v_mul_f32 v7, v7, v205
    v_mul_f32 v8, v8, v204
    v_mul_f32 v9, v9, v204
    v_mul_f32 v10, v10, v204
    v_mul_f32 v11, v11, v204
    v_mul_f32 v12, v12, v205
    v_mul_f32 v13, v13, v205
    v_mul_f32 v14, v14, v205
    v_mul_f32 v15, v15, v205
    v_mul_f32 v16, v16, v204
    v_mul_f32 v17, v17, v204
    v_mul_f32 v18, v18, v204
    v_mul_f32 v19, v19, v204
    v_mul_f32 v20, v20, v205
    v_mul_f32 v21, v21, v205
    v_mul_f32 v22, v22, v205
    v_mul_f32 v23, v23, v205
    v_mul_f32 v24, v24, v204
    v_mul_f32 v25, v25, v204
    v_mul_f32 v26, v26, v204
    v_mul_f32 v27, v27, v204
    v_mul_f32 v28, v28, v205
    v_mul_f32 v29, v29, v205
    v_mul_f32 v30, v30, v205
    v_mul_f32 v31, v31, v205
    v_mul_f32 v32, v32, v204
    v_mul_f32 v33, v33, v204
    v_mul_f32 v34, v34, v204
    v_mul_f32 v35, v35, v204
    v_mul_f32 v36, v36, v205
    v_mul_f32 v37, v37, v205
    v_mul_f32 v38, v38, v205
    v_mul_f32 v39, v39, v205
    v_mul_f32 v40, v40, v204
    v_mul_f32 v41, v41, v204
    v_mul_f32 v42, v42, v204
    v_mul_f32 v43, v43, v204
    v_mul_f32 v44, v44, v205
    v_mul_f32 v45, v45, v205
    v_mul_f32 v46, v46, v205
    v_mul_f32 v47, v47, v205
    v_mul_f32 v48, v48, v204
    v_mul_f32 v49, v49, v204
    v_mul_f32 v50, v50, v204
    v_mul_f32 v51, v51, v204
    v_mul_f32 v52, v52, v205
    v_mul_f32 v53, v53, v205
    v_mul_f32 v54, v54, v205
    v_mul_f32 v55, v55, v205
    v_mul_f32 v56, v56, v204
    v_mul_f32 v57, v57, v204
    v_mul_f32 v58, v58, v204
    v_mul_f32 v59, v59, v204
    v_mul_f32 v60, v60, v205
    v_mul_f32 v61, v61, v205
    v_mul_f32 v62, v62, v205
    v_mul_f32 v63, v63, v205
    s_nop 1
    s_branch L_rback11

L_resc12:
    v_accvgpr_read_b32 v204, a248
    v_accvgpr_read_b32 v205, a249
    v_mul_f32 v192, v192, v204
    v_mul_f32 v193, v193, v204
    v_mul_f32 v194, v194, v204
    v_mul_f32 v195, v195, v204
    v_mul_f32 v196, v196, v205
    v_mul_f32 v197, v197, v205
    v_mul_f32 v198, v198, v205
    v_mul_f32 v199, v199, v205
    v_mul_f32 v0, v0, v204
    v_mul_f32 v1, v1, v204
    v_mul_f32 v2, v2, v204
    v_mul_f32 v3, v3, v204
    v_mul_f32 v4, v4, v205
    v_mul_f32 v5, v5, v205
    v_mul_f32 v6, v6, v205
    v_mul_f32 v7, v7, v205
    v_mul_f32 v8, v8, v204
    v_mul_f32 v9, v9, v204
    v_mul_f32 v10, v10, v204
    v_mul_f32 v11, v11, v204
    v_mul_f32 v12, v12, v205
    v_mul_f32 v13, v13, v205
    v_mul_f32 v14, v14, v205
    v_mul_f32 v15, v15, v205
    v_mul_f32 v16, v16, v204
    v_mul_f32 v17, v17, v204
    v_mul_f32 v18, v18, v204
    v_mul_f32 v19, v19, v204
    v_mul_f32 v20, v20, v205
    v_mul_f32 v21, v21, v205
    v_mul_f32 v22, v22, v205
    v_mul_f32 v23, v23, v205
    v_mul_f32 v24, v24, v204
    v_mul_f32 v25, v25, v204
    v_mul_f32 v26, v26, v204
    v_mul_f32 v27, v27, v204
    v_mul_f32 v28, v28, v205
    v_mul_f32 v29, v29, v205
    v_mul_f32 v30, v30, v205
    v_mul_f32 v31, v31, v205
    v_mul_f32 v32, v32, v204
    v_mul_f32 v33, v33, v204
    v_mul_f32 v34, v34, v204
    v_mul_f32 v35, v35, v204
    v_mul_f32 v36, v36, v205
    v_mul_f32 v37, v37, v205
    v_mul_f32 v38, v38, v205
    v_mul_f32 v39, v39, v205
    v_mul_f32 v40, v40, v204
    v_mul_f32 v41, v41, v204
    v_mul_f32 v42, v42, v204
    v_mul_f32 v43, v43, v204
    v_mul_f32 v44, v44, v205
    v_mul_f32 v45, v45, v205
    v_mul_f32 v46, v46, v205
    v_mul_f32 v47, v47, v205
    v_mul_f32 v48, v48, v204
    v_mul_f32 v49, v49, v204
    v_mul_f32 v50, v50, v204
    v_mul_f32 v51, v51, v204
    v_mul_f32 v52, v52, v205
    v_mul_f32 v53, v53, v205
    v_mul_f32 v54, v54, v205
    v_mul_f32 v55, v55, v205
    v_mul_f32 v56, v56, v204
    v_mul_f32 v57, v57, v204
    v_mul_f32 v58, v58, v204
    v_mul_f32 v59, v59, v204
    v_mul_f32 v60, v60, v205
    v_mul_f32 v61, v61, v205
    v_mul_f32 v62, v62, v205
    v_mul_f32 v63, v63, v205
    s_nop 1
    s_branch L_rback12

L_resc13:
    v_accvgpr_read_b32 v204, a250
    v_accvgpr_read_b32 v205, a251
    v_mul_f32 v192, v192, v204
    v_mul_f32 v193, v193, v204
    v_mul_f32 v194, v194, v204
    v_mul_f32 v195, v195, v204
    v_mul_f32 v196, v196, v205
    v_mul_f32 v197, v197, v205
    v_mul_f32 v198, v198, v205
    v_mul_f32 v199, v199, v205
    v_mul_f32 v0, v0, v204
    v_mul_f32 v1, v1, v204
    v_mul_f32 v2, v2, v204
    v_mul_f32 v3, v3, v204
    v_mul_f32 v4, v4, v205
    v_mul_f32 v5, v5, v205
    v_mul_f32 v6, v6, v205
    v_mul_f32 v7, v7, v205
    v_mul_f32 v8, v8, v204
    v_mul_f32 v9, v9, v204
    v_mul_f32 v10, v10, v204
    v_mul_f32 v11, v11, v204
    v_mul_f32 v12, v12, v205
    v_mul_f32 v13, v13, v205
    v_mul_f32 v14, v14, v205
    v_mul_f32 v15, v15, v205
    v_mul_f32 v16, v16, v204
    v_mul_f32 v17, v17, v204
    v_mul_f32 v18, v18, v204
    v_mul_f32 v19, v19, v204
    v_mul_f32 v20, v20, v205
    v_mul_f32 v21, v21, v205
    v_mul_f32 v22, v22, v205
    v_mul_f32 v23, v23, v205
    v_mul_f32 v24, v24, v204
    v_mul_f32 v25, v25, v204
    v_mul_f32 v26, v26, v204
    v_mul_f32 v27, v27, v204
    v_mul_f32 v28, v28, v205
    v_mul_f32 v29, v29, v205
    v_mul_f32 v30, v30, v205
    v_mul_f32 v31, v31, v205
    v_mul_f32 v32, v32, v204
    v_mul_f32 v33, v33, v204
    v_mul_f32 v34, v34, v204
    v_mul_f32 v35, v35, v204
    v_mul_f32 v36, v36, v205
    v_mul_f32 v37, v37, v205
    v_mul_f32 v38, v38, v205
    v_mul_f32 v39, v39, v205
    v_mul_f32 v40, v40, v204
    v_mul_f32 v41, v41, v204
    v_mul_f32 v42, v42, v204
    v_mul_f32 v43, v43, v204
    v_mul_f32 v44, v44, v205
    v_mul_f32 v45, v45, v205
    v_mul_f32 v46, v46, v205
    v_mul_f32 v47, v47, v205
    v_mul_f32 v48, v48, v204
    v_mul_f32 v49, v49, v204
    v_mul_f32 v50, v50, v204
    v_mul_f32 v51, v51, v204
    v_mul_f32 v52, v52, v205
    v_mul_f32 v53, v53, v205
    v_mul_f32 v54, v54, v205
    v_mul_f32 v55, v55, v205
    v_mul_f32 v56, v56, v204
    v_mul_f32 v57, v57, v204
    v_mul_f32 v58, v58, v204
    v_mul_f32 v59, v59, v204
    v_mul_f32 v60, v60, v205
    v_mul_f32 v61, v61, v205
    v_mul_f32 v62, v62, v205
    v_mul_f32 v63, v63, v205
    s_nop 1
    s_branch L_rback13

L_resc14:
    v_accvgpr_read_b32 v204, a252
    v_accvgpr_read_b32 v205, a253
    v_mul_f32 v192, v192, v204
    v_mul_f32 v193, v193, v204
    v_mul_f32 v194, v194, v204
    v_mul_f32 v195, v195, v204
    v_mul_f32 v196, v196, v205
    v_mul_f32 v197, v197, v205
    v_mul_f32 v198, v198, v205
    v_mul_f32 v199, v199, v205
    v_mul_f32 v0, v0, v204
    v_mul_f32 v1, v1, v204
    v_mul_f32 v2, v2, v204
    v_mul_f32 v3, v3, v204
    v_mul_f32 v4, v4, v205
    v_mul_f32 v5, v5, v205
    v_mul_f32 v6, v6, v205
    v_mul_f32 v7, v7, v205
    v_mul_f32 v8, v8, v204
    v_mul_f32 v9, v9, v204
    v_mul_f32 v10, v10, v204
    v_mul_f32 v11, v11, v204
    v_mul_f32 v12, v12, v205
    v_mul_f32 v13, v13, v205
    v_mul_f32 v14, v14, v205
    v_mul_f32 v15, v15, v205
    v_mul_f32 v16, v16, v204
    v_mul_f32 v17, v17, v204
    v_mul_f32 v18, v18, v204
    v_mul_f32 v19, v19, v204
    v_mul_f32 v20, v20, v205
    v_mul_f32 v21, v21, v205
    v_mul_f32 v22, v22, v205
    v_mul_f32 v23, v23, v205
    v_mul_f32 v24, v24, v204
    v_mul_f32 v25, v25, v204
    v_mul_f32 v26, v26, v204
    v_mul_f32 v27, v27, v204
    v_mul_f32 v28, v28, v205
    v_mul_f32 v29, v29, v205
    v_mul_f32 v30, v30, v205
    v_mul_f32 v31, v31, v205
    v_mul_f32 v32, v32, v204
    v_mul_f32 v33, v33, v204
    v_mul_f32 v34, v34, v204
    v_mul_f32 v35, v35, v204
    v_mul_f32 v36, v36, v205
    v_mul_f32 v37, v37, v205
    v_mul_f32 v38, v38, v205
    v_mul_f32 v39, v39, v205
    v_mul_f32 v40, v40, v204
    v_mul_f32 v41, v41, v204
    v_mul_f32 v42, v42, v204
    v_mul_f32 v43, v43, v204
    v_mul_f32 v44, v44, v205
    v_mul_f32 v45, v45, v205
    v_mul_f32 v46, v46, v205
    v_mul_f32 v47, v47, v205
    v_mul_f32 v48, v48, v204
    v_mul_f32 v49, v49, v204
    v_mul_f32 v50, v50, v204
    v_mul_f32 v51, v51, v204
    v_mul_f32 v52, v52, v205
    v_mul_f32 v53, v53, v205
    v_mul_f32 v54, v54, v205
    v_mul_f32 v55, v55, v205
    v_mul_f32 v56, v56, v204
    v_mul_f32 v57, v57, v204
    v_mul_f32 v58, v58, v204
    v_mul_f32 v59, v59, v204
    v_mul_f32 v60, v60, v205
    v_mul_f32 v61, v61, v205
    v_mul_f32 v62, v62, v205
    v_mul_f32 v63, v63, v205
    s_nop 1
    s_branch L_rback14

L_resc15:
    v_accvgpr_read_b32 v204, a254
    v_accvgpr_read_b32 v205, a255
    v_mul_f32 v192, v192, v204
    v_mul_f32 v193, v193, v204
    v_mul_f32 v194, v194, v204
    v_mul_f32 v195, v195, v204
    v_mul_f32 v196, v196, v205
    v_mul_f32 v197, v197, v205
    v_mul_f32 v198, v198, v205
    v_mul_f32 v199, v199, v205
    v_mul_f32 v0, v0, v204
    v_mul_f32 v1, v1, v204
    v_mul_f32 v2, v2, v204
    v_mul_f32 v3, v3, v204
    v_mul_f32 v4, v4, v205
    v_mul_f32 v5, v5, v205
    v_mul_f32 v6, v6, v205
    v_mul_f32 v7, v7, v205
    v_mul_f32 v8, v8, v204
    v_mul_f32 v9, v9, v204
    v_mul_f32 v10, v10, v204
    v_mul_f32 v11, v11, v204
    v_mul_f32 v12, v12, v205
    v_mul_f32 v13, v13, v205
    v_mul_f32 v14, v14, v205
    v_mul_f32 v15, v15, v205
    v_mul_f32 v16, v16, v204
    v_mul_f32 v17, v17, v204
    v_mul_f32 v18, v18, v204
    v_mul_f32 v19, v19, v204
    v_mul_f32 v20, v20, v205
    v_mul_f32 v21, v21, v205
    v_mul_f32 v22, v22, v205
    v_mul_f32 v23, v23, v205
    v_mul_f32 v24, v24, v204
    v_mul_f32 v25, v25, v204
    v_mul_f32 v26, v26, v204
    v_mul_f32 v27, v27, v204
    v_mul_f32 v28, v28, v205
    v_mul_f32 v29, v29, v205
    v_mul_f32 v30, v30, v205
    v_mul_f32 v31, v31, v205
    v_mul_f32 v32, v32, v204
    v_mul_f32 v33, v33, v204
    v_mul_f32 v34, v34, v204
    v_mul_f32 v35, v35, v204
    v_mul_f32 v36, v36, v205
    v_mul_f32 v37, v37, v205
    v_mul_f32 v38, v38, v205
    v_mul_f32 v39, v39, v205
    v_mul_f32 v40, v40, v204
    v_mul_f32 v41, v41, v204
    v_mul_f32 v42, v42, v204
    v_mul_f32 v43, v43, v204
    v_mul_f32 v44, v44, v205
    v_mul_f32 v45, v45, v205
    v_mul_f32 v46, v46, v205
    v_mul_f32 v47, v47, v205
    v_mul_f32 v48, v48, v204
    v_mul_f32 v49, v49, v204
    v_mul_f32 v50, v50, v204
    v_mul_f32 v51, v51, v204
    v_mul_f32 v52, v52, v205
    v_mul_f32 v53, v53, v205
    v_mul_f32 v54, v54, v205
    v_mul_f32 v55, v55, v205
    v_mul_f32 v56, v56, v204
    v_mul_f32 v57, v57, v204
    v_mul_f32 v58, v58, v204
    v_mul_f32 v59, v59, v204
    v_mul_f32 v60, v60, v205
    v_mul_f32 v61, v61, v205
    v_mul_f32 v62, v62, v205
    v_mul_f32 v63, v63, v205
    s_nop 1
    s_branch L_rback15

L_cnt2:
    buffer_load_dword v253, v255, s[16:19], 0 offen offset:0 sc1
    s_add_u32 s65, s65, 1
    s_cmp_lt_u32 s65, 1048576
    s_waitcnt vmcnt(0)
    s_cbranch_scc1 L_cnt
    s_branch L_cntok
L_end:
    s_endpgm
.section .rodata,"a"
.p2align 6
.amdhsa_kernel standalone__mha_block_cached__near_ridge_kernel
  .amdhsa_next_free_vgpr 512
  .amdhsa_next_free_sgpr 102
  .amdhsa_accum_offset 256
  .amdhsa_group_segment_fixed_size 0
  .amdhsa_kernarg_size 64
  .amdhsa_user_sgpr_count 2
  .amdhsa_user_sgpr_kernarg_segment_ptr 1
  .amdhsa_system_sgpr_workgroup_id_x 1
.end_amdhsa_kernel
```
